```python
import torch

def _softmax(x, axis=-1):
    return torch.softmax(x, dim=axis)

def _gelu(x):
    return torch.nn.functional.gelu(x, approximate='tanh')

def _silu(x):
    return torch.nn.functional.silu(x)

def _sigmoid(x):
    return torch.sigmoid(x)

def _layernorm(x, axis=-1, eps=1e-05):
    m = x.mean(dim=axis, keepdim=True)
    v = x.var(dim=axis, keepdim=True, unbiased=False)
    return (x - m) / torch.sqrt(v + eps)

def _scatter_add(tgt, idx, src, axis=0):
    return tgt.clone().index_add_(axis, idx, src)

def _segment_sum(src, seg, n):
    out = torch.zeros((n,) + src.shape[1:], dtype=src.dtype)
    return out.index_add_(0, seg, src)

def _pad(x, pw):
    flat = tuple((v for pair in reversed(pw) for v in pair))
    return torch.nn.functional.pad(x, flat)
kernel_name = 'adaLN_cond__sliding_block_cached__mixer_gmlp__prompt'

def setup_inputs():

    _w = lambda a: (lambda t: t.to(torch.bfloat16) if t.is_floating_point() else t)(torch.as_tensor(a))

    def _A_setup():
        B, Sq, D = (1, 2048, 512)
        Hq, Hkv, Sk, Dh = (32, 8, 2048, 128)
        assert Hq % Hkv == 0, (Hq, Hkv)
        return {'x': _w((lambda *s: torch.randn(*s, dtype=torch.bfloat16) * 0.1)(B, Sq, D)), 'k_cache': _w((lambda *s: torch.randn(*s, dtype=torch.bfloat16) * 0.8)(B, Hkv, Sk, Dh)), 'v_cache': _w((lambda *s: torch.randn(*s, dtype=torch.bfloat16) * 1.6)(B, Hkv, Sk, Dh)), 'wq': _w((lambda *s: torch.randn(*s, dtype=torch.bfloat16) * 0.8)(D, Hq * Dh) * D ** (-0.5)), 'wo': _w((lambda *s: torch.randn(*s, dtype=torch.bfloat16) * 1.6)(Hq * Dh, D) * (Hq * Dh) ** (-0.5))}
    _A_in = _A_setup()

    def _B_setup():
        B, S, D, F = (1, 2048, 512, 1792)
        Fh = F // 2
        return {'x': _w((lambda *s: torch.randn(*s, dtype=torch.bfloat16) * 0.1)(B, S, D)), 'w_in': _w((lambda *s: torch.randn(*s, dtype=torch.bfloat16) * 1.6)(D, 2 * Fh)), 'w_sp': _w(0.01 * (lambda *s: torch.randn(*s, dtype=torch.bfloat16) * 1.6)(S, S)), 'b_sp': _w(1.0 + 0.01 * (lambda *s: torch.randn(*s, dtype=torch.bfloat16) * 0.2)(S)), 'w_out': _w((lambda *s: torch.randn(*s, dtype=torch.bfloat16) * 0.2)(Fh, D))}
    _B_in = _B_setup()
    return {'A_x': _A_in['x'], 'A_k_cache': _A_in['k_cache'], 'A_v_cache': _A_in['v_cache'], 'A_wq': _A_in['wq'], 'A_wo': _A_in['wo'], 'B_x': _B_in['x'], 'B_w_in': _B_in['w_in'], 'B_w_sp': _B_in['w_sp'], 'B_b_sp': _B_in['b_sp'], 'B_w_out': _B_in['w_out'], 'c': _w((lambda *s: torch.randn(*s, dtype=torch.bfloat16) * 0.8)(1, 512) * 8.0), 'w_mod': _w((lambda *s: torch.randn(*s, dtype=torch.bfloat16) * 0.8)(512, 6 * 512) * 512 ** (-0.5) * 8.0)}

def reference(A_x, A_k_cache, A_v_cache, A_wq, A_wo, B_x, B_w_in, B_w_sp, B_b_sp, B_w_out, c, w_mod):

    def _A_ref(x, k_cache, v_cache, wq, wo):
        B, Sq, D = x.shape
        Hq, Dh = (32, 128)
        Hkv, Sk = (k_cache.shape[1], k_cache.shape[2])
        W = min(4096, max(256, Sk // 4))
        rep = Hq // Hkv
        q = (lambda x, *d: x.permute(*d))((x @ wq).reshape(B, Sq, Hq, Dh), 0, 2, 1, 3)
        k = (lambda x, n, axis: torch.repeat_interleave(x, n, dim=axis))(k_cache[:, :, Sk - W:, :], rep, axis=1)
        v = (lambda x, n, axis: torch.repeat_interleave(x, n, dim=axis))(v_cache[:, :, Sk - W:, :], rep, axis=1)
        scores = torch.einsum('bhqd,bhkd->bhqk', q, k) * Dh ** (-0.5)
        p = _softmax(scores, axis=-1)
        o = torch.einsum('bhqk,bhkd->bhqd', p, v)
        return (lambda x, *d: x.permute(*d))(o, 0, 2, 1, 3).reshape(B, Sq, Hq * Dh) @ wo

    def _B_ref(x, w_in, w_sp, b_sp, w_out):
        B, S, D = x.shape
        F = w_in.shape[-1]
        Fh = F // 2
        z = _gelu(torch.einsum('bsd,df->bsf', x, w_in))
        z1 = z[..., :Fh].clone()
        z2 = _layernorm(z[..., Fh:], axis=-1)
        g = torch.einsum('ts,bsf->btf', w_sp, z2) + b_sp[None, :, None]
        return torch.einsum('bsf,fd->bsd', z1 * g, w_out)
    x = A_x
    mod = (_silu(c) @ w_mod).reshape(c.shape[0], 6, 1, -1)
    sa, ca, ga, sb, cb, gb = (mod[:, 0].clone(), mod[:, 1].clone(), mod[:, 2].clone(), mod[:, 3].clone(), mod[:, 4].clone(), mod[:, 5].clone())
    h = _layernorm(x, axis=-1) * (1 + ca) + sa
    x = x + ga * _A_ref(h, A_k_cache, A_v_cache, A_wq, A_wo)
    h = _layernorm(x, axis=-1) * (1 + cb) + sb
    x = x + gb * _B_ref(h, B_w_in, B_w_sp, B_b_sp, B_w_out)
    return x
```

```asm
; @launch kernel=adaLN_cond__sliding_block_cached__mixer_gmlp__prompt_kernel grid=(256,1,1) block=(512,1,1) lds=163840
.amdgcn_target "amdgcn-amd-amdhsa--gfx950"
.text
.globl adaLN_cond__sliding_block_cached__mixer_gmlp__prompt_kernel
.p2align 8
.type adaLN_cond__sliding_block_cached__mixer_gmlp__prompt_kernel,@function
adaLN_cond__sliding_block_cached__mixer_gmlp__prompt_kernel:
    s_cmp_ge_u32 s2, 256
    s_cbranch_scc1 L_k2_end
    s_load_dwordx2 s[4:5], s[0:1], 112
    s_mov_b32 s6, 268435456
    s_mov_b32 s7, 0x20000
    s_load_dwordx2 s[8:9], s[0:1], 0
    s_mov_b32 s10, 2097152
    s_mov_b32 s11, 0x20000
    s_load_dwordx2 s[36:37], s[0:1], 56
    s_mov_b32 s38, 8388608
    s_mov_b32 s39, 0x20000
    v_and_b32 v1, 63, v0
    v_lshrrev_b32 v9, 6, v0
    s_nop 0
    v_readfirstlane_b32 s12, v9
    s_and_b32 s13, s2, 3
    s_lshl_b32 s13, s13, 1
    s_bfe_u32 s15, s2, 65539
    s_add_u32 s13, s13, s15
    s_bfe_u32 s14, s2, 65538
    s_lshl_b32 s14, s14, 4
    s_lshr_b32 s33, s2, 4
    s_add_u32 s14, s14, s33
    v_lshlrev_b32 v1, 4, v1
    s_load_dwordx2 s[16:17], s[0:1], 88
    s_mov_b32 s18, 3145728
    s_mov_b32 s19, 0x20000
    s_load_dwordx2 s[20:21], s[0:1], 80
    s_mov_b32 s22, 1024
    s_mov_b32 s23, 0x20000
    s_and_b32 s47, s2, 31
    s_lshr_b32 s48, s2, 5
    s_cmp_lt_u32 s12, 4
    s_cbranch_scc0 L_r1_n0
    s_mov_b32 s40, 24
    s_mov_b32 s42, 4194304
    s_mov_b32 s44, 8192
    s_mov_b32 s46, 4
    s_lshl_b32 s49, s48, 2
    s_add_u32 s49, s49, s12
    s_lshl_b32 s45, s47, 17
    s_lshl_b32 s50, s49, 8
    s_add_u32 s45, s45, s50
    s_lshl_b32 s52, s49, 17
    s_lshl_b32 s50, s47, 11
    s_add_u32 s52, s52, s50
    s_add_u32 s52, s52, 1048576
    s_mov_b32 s53, 1024
    s_mov_b32 s54, 65536
    s_branch L_r1_done
L_r1_n0:
    s_cmp_eq_u32 s12, 4
    s_cbranch_scc0 L_r1_n1
    s_mov_b32 s40, 16
    s_mov_b32 s42, 4194304
    s_mov_b32 s44, 256
    s_mov_b32 s46, 4
    s_lshl_b32 s45, s48, 19
    s_lshl_b32 s50, s47, 12
    s_add_u32 s45, s45, s50
    s_add_u32 s45, s45, 393216
    s_lshl_b32 s52, s2, 12
    s_add_u32 s52, s52, 13631488
    s_mov_b32 s53, 1024
    s_mov_b32 s54, 2048
    s_branch L_r1_done
L_r1_n1:
    s_cmp_eq_u32 s12, 5
    s_cbranch_scc0 L_r1_n2
    s_mov_b32 s40, 8
    s_mov_b32 s42, 4194304
    s_mov_b32 s44, 256
    s_mov_b32 s46, 3
    s_lshl_b32 s45, s48, 19
    s_lshr_b32 s50, s47, 1
    s_lshl_b32 s50, s50, 13
    s_add_u32 s45, s45, s50
    s_and_b32 s50, s2, 1
    s_lshl_b32 s50, s50, 7
    s_add_u32 s45, s45, s50
    s_add_u32 s45, s45, 393216
    s_lshl_b32 s52, s2, 12
    s_add_u32 s52, s52, 12582912
    s_mov_b32 s53, 1024
    s_mov_b32 s54, 2048
    s_branch L_r1_done
L_r1_n2:
    s_mov_b32 s40, 8
    s_mov_b32 s42, 0
    s_mov_b32 s44, 256
    s_mov_b32 s46, 4
    s_mov_b32 s45, 0
    s_mov_b32 s52, 268435456
    s_mov_b32 s53, 0
    s_mov_b32 s54, 0
L_r1_done:
    s_load_dwordx2 s[28:29], s[0:1], s40
    s_mov_b32 s30, s42
    s_mov_b32 s31, 0x20000
    v_lshrrev_b32 v2, 4, v1
    v_lshrrev_b32 v5, s46, v2
    v_mul_lo_u32 v5, v5, s44
    s_lshl_b32 s41, 1, s46
    s_sub_u32 s41, s41, 1
    v_and_b32 v2, s41, v2
    v_lshl_add_u32 v5, v2, 4, v5
    s_sub_u32 s41, 6, s46
    s_lshl_b32 s41, s44, s41
    s_lshl_b32 s43, s12, 12
    s_add_u32 s43, s43, 0
    s_mul_i32 s26, s2, 1366
    s_lshr_b32 s26, s26, 16
    s_mul_i32 s27, s26, 48
    s_sub_u32 s27, s2, s27
    s_lshl_b32 s32, s26, 7
    s_lshl_b32 s33, s12, 4
    s_add_u32 s32, s32, s33
    v_lshrrev_b32 v2, 7, v1
    v_add_u32 v2, s32, v2
    v_mul_u32_u24 v3, 6144, v2
    v_and_b32 v4, 0x70, v1
    v_add_u32 v3, v3, v4
    v_lshlrev_b32 v2, 1, v2
    s_lshl_b32 s33, s27, 7
    s_add_u32 s34, s33, 49152
    s_waitcnt lgkmcnt(0)
    buffer_load_ushort v56, v2, s[20:23], 0 offen
    buffer_load_ushort v57, v2, s[20:23], 0 offen offset:16
    buffer_load_dwordx4 v[48:51], v3, s[16:19], s33 offen nt
    buffer_load_dwordx4 v[52:55], v3, s[16:19], s34 offen nt
    s_add_u32 m0, s43, 0
    s_nop 0
    buffer_load_dwordx4 v5, s[28:31], s45 offen nt lds
    s_add_u32 s45, s45, s41
    s_add_u32 m0, s43, 1024
    s_nop 0
    buffer_load_dwordx4 v5, s[28:31], s45 offen nt lds
    s_add_u32 s45, s45, s41
    s_add_u32 m0, s43, 2048
    s_nop 0
    buffer_load_dwordx4 v5, s[28:31], s45 offen nt lds
    s_add_u32 s45, s45, s41
    s_add_u32 m0, s43, 3072
    s_nop 0
    buffer_load_dwordx4 v5, s[28:31], s45 offen nt lds
    s_add_u32 s24, s4, 51511296
    s_addc_u32 s25, s5, 0
    s_load_dword s100, s[24:25], 0
    s_lshl_b32 s33, s2, 13
    s_lshl_b32 s34, s12, 10
    s_add_u32 s33, s33, s34
    v_lshlrev_b32 v2, 3, v1
    v_and_b32 v2, 0x380, v2
    buffer_load_dword v58, v2, s[8:11], s33 offen
    s_getpc_b64 s[32:33]
L_pc0:
    s_add_u32 s32, s32, L_q_phase-L_pc0
    s_addc_u32 s33, s33, 0
    s_lshr_b32 s34, s2, 3
    s_mul_i32 s34, s34, ((L_code_end-L_q_phase)/4096+1)*128
    v_and_b32 v2, 63, v0
    v_lshlrev_b32 v2, 7, v2
    v_min_u32 v2, ((L_code_end-L_q_phase)/4096)*128, v2
    v_add_u32 v2, s34, v2
    v_min_u32 v2, L_code_end-L_q_phase-4, v2
    global_load_dword v59, v2, s[32:33]
    s_cmp_lt_u32 s12, 4
    s_cbranch_scc0 L_r2_n0
    s_mov_b32 s40, 32
    s_mov_b32 s42, 4194304
    s_mov_b32 s44, 1024
    s_mov_b32 s46, 4
    s_lshl_b32 s45, s2, 14
    s_lshl_b32 s50, s12, 8
    s_add_u32 s45, s45, s50
    s_lshl_b32 s55, s48, 19
    s_lshl_b32 s50, s12, 17
    s_add_u32 s55, s55, s50
    s_lshl_b32 s50, s47, 10
    s_add_u32 s55, s55, s50
    s_add_u32 s55, s55, 5242880
    s_mov_b32 s56, 32768
    s_mov_b32 s57, 65536
    s_branch L_r2_done
L_r2_n0:
    s_cmp_ge_u32 s2, 224
    s_cselect_b32 s49, 7, s12
    s_cmp_lt_u32 s49, 6
    s_cbranch_scc0 L_r2_n1
    s_mov_b32 s40, 48
    s_mov_b32 s42, 1835008
    s_mov_b32 s44, 3584
    s_mov_b32 s46, 3
    s_lshl_b32 s49, s2, 1
    s_add_u32 s49, s49, s12
    s_sub_u32 s49, s49, 4
    s_and_b32 s50, s49, 15
    s_lshr_b32 s49, s49, 4
    s_mul_i32 s45, s50, 114688
    s_lshl_b32 s55, s49, 7
    s_add_u32 s45, s45, s55
    s_lshl_b32 s55, s49, 16
    s_lshl_b32 s50, s50, 10
    s_add_u32 s55, s55, s50
    s_add_u32 s55, s55, 9437184
    s_mov_b32 s56, 16384
    s_mov_b32 s57, 32768
    s_branch L_r2_done
L_r2_n1:
    s_cmp_eq_u32 s49, 6
    s_cbranch_scc0 L_r2_n2
    s_mov_b32 s40, 72
    s_mov_b32 s42, 917504
    s_mov_b32 s44, 1024
    s_mov_b32 s46, 3
    s_lshr_b32 s50, s2, 3
    s_and_b32 s49, s2, 7
    s_lshl_b32 s45, s50, 15
    s_lshl_b32 s55, s49, 7
    s_add_u32 s45, s45, s55
    s_mul_i32 s55, s49, 114688
    s_lshl_b32 s50, s50, 10
    s_add_u32 s55, s55, s50
    s_add_u32 s55, s55, 11534336
    s_mov_b32 s56, 28672
    s_mov_b32 s57, 57344
    s_branch L_r2_done
L_r2_n2:
    s_mov_b32 s40, 8
    s_mov_b32 s42, 0
    s_mov_b32 s44, 256
    s_mov_b32 s46, 4
    s_mov_b32 s45, 0
    s_mov_b32 s55, 268435456
    s_mov_b32 s56, 0
    s_mov_b32 s57, 0
L_r2_done:
    s_load_dwordx2 s[28:29], s[0:1], s40
    s_mov_b32 s30, s42
    s_mov_b32 s31, 0x20000
    v_lshrrev_b32 v2, 4, v1
    v_lshrrev_b32 v85, s46, v2
    v_mul_lo_u32 v85, v85, s44
    s_lshl_b32 s41, 1, s46
    s_sub_u32 s41, s41, 1
    v_and_b32 v2, s41, v2
    v_lshl_add_u32 v85, v2, 4, v85
    s_sub_u32 s41, 6, s46
    s_lshl_b32 s41, s44, s41
    s_lshl_b32 s43, s12, 12
    s_add_u32 s43, s43, 98304
    s_waitcnt lgkmcnt(0)
    s_mov_b32 s48, s28
    s_mov_b32 s49, s29
    v_lshrrev_b32 v2, 4, v1
    v_bfe_u32 v3, v2, 2, 2
    v_lshrrev_b32 v4, 5, v2
    v_lshl_add_u32 v82, v4, 3, v3
    v_lshlrev_b32 v82, 8, v82
    v_bfe_u32 v4, v2, 4, 1
    v_lshl_add_u32 v82, v4, 5, v82
    v_and_b32 v4, 1, v2
    v_lshl_add_u32 v82, v4, 4, v82
    v_bfe_u32 v4, v2, 1, 1
    v_lshl_add_u32 v82, v4, 3, v82
    s_lshl_b32 s33, s12, 12
    v_add_u32 v82, s33, v82
    v_lshrrev_b32 v4, 4, v2
    v_lshl_add_u32 v83, v4, 3, v3
    v_lshlrev_b32 v83, 7, v83
    v_and_b32 v4, 3, v2
    v_lshl_add_u32 v83, v4, 3, v83
    v_add_u32 v83, s33, v83
    v_and_b32 v84, 0x13, v2
    v_and_b32 v4, 4, v2
    v_lshl_or_b32 v84, v4, 1, v84
    v_bfe_u32 v4, v2, 3, 1
    v_lshl_or_b32 v84, v4, 2, v84
    v_lshlrev_b32 v84, 7, v84
    v_lshrrev_b32 v4, 5, v2
    v_lshl_add_u32 v84, v4, 4, v84
    v_add_u32 v84, s33, v84
    s_mul_i32 s51, s100, 0x9e3779b1
    s_add_u32 s51, s51, 0x7f4a7c15
    s_mov_b32 s28, 0xffff0000
    s_mov_b32 s29, 0xbfb8aa3b
    s_waitcnt vmcnt(9)
    v_lshlrev_b32 v56, 16, v56
    v_mul_f32 v63, s29, v56
    v_exp_f32 v63, v63
    s_nop 0
    v_add_f32 v63, 1.0, v63
    v_rcp_f32 v63, v63
    s_nop 0
    v_mul_f32 v56, v56, v63
    v_cvt_pk_bf16_f32 v56, v56, v56
    v_and_b32 v56, s28, v56
    s_waitcnt vmcnt(8)
    v_lshlrev_b32 v57, 16, v57
    v_mul_f32 v63, s29, v57
    v_exp_f32 v63, v63
    s_nop 0
    v_add_f32 v63, 1.0, v63
    v_rcp_f32 v63, v63
    s_nop 0
    v_mul_f32 v57, v57, v63
    v_cvt_pk_bf16_f32 v57, v57, v57
    v_and_b32 v57, s28, v57
    s_waitcnt vmcnt(7)
    v_lshlrev_b32 v64, 16, v48
    s_waitcnt vmcnt(6)
    v_lshlrev_b32 v72, 16, v52
    v_and_b32 v65, s28, v48
    v_and_b32 v73, s28, v52
    v_lshlrev_b32 v66, 16, v49
    v_lshlrev_b32 v74, 16, v53
    v_and_b32 v67, s28, v49
    v_and_b32 v75, s28, v53
    v_lshlrev_b32 v68, 16, v50
    v_lshlrev_b32 v76, 16, v54
    v_and_b32 v69, s28, v50
    v_and_b32 v77, s28, v54
    v_lshlrev_b32 v70, 16, v51
    v_lshlrev_b32 v78, 16, v55
    v_and_b32 v71, s28, v51
    v_and_b32 v79, s28, v55
    v_mul_f32 v64, v56, v64
    v_mul_f32 v65, v56, v65
    v_mul_f32 v66, v56, v66
    v_mul_f32 v67, v56, v67
    v_mul_f32 v68, v56, v68
    v_mul_f32 v69, v56, v69
    v_mul_f32 v70, v56, v70
    v_mul_f32 v71, v56, v71
    v_fmac_f32 v64, v57, v72
    v_fmac_f32 v65, v57, v73
    v_fmac_f32 v66, v57, v74
    v_fmac_f32 v67, v57, v75
    v_fmac_f32 v68, v57, v76
    v_fmac_f32 v69, v57, v77
    v_fmac_f32 v70, v57, v78
    v_fmac_f32 v71, v57, v79
    v_add_f32_dpp v64, v64, v64 row_ror:8 row_mask:0xf bank_mask:0xf
    v_add_f32_dpp v65, v65, v65 row_ror:8 row_mask:0xf bank_mask:0xf
    v_add_f32_dpp v66, v66, v66 row_ror:8 row_mask:0xf bank_mask:0xf
    v_add_f32_dpp v67, v67, v67 row_ror:8 row_mask:0xf bank_mask:0xf
    v_add_f32_dpp v68, v68, v68 row_ror:8 row_mask:0xf bank_mask:0xf
    v_add_f32_dpp v69, v69, v69 row_ror:8 row_mask:0xf bank_mask:0xf
    v_add_f32_dpp v70, v70, v70 row_ror:8 row_mask:0xf bank_mask:0xf
    v_add_f32_dpp v71, v71, v71 row_ror:8 row_mask:0xf bank_mask:0xf
    v_permlane16_swap_b32 v64, v65
    v_permlane16_swap_b32 v66, v67
    v_permlane16_swap_b32 v68, v69
    v_permlane16_swap_b32 v70, v71
    v_add_f32 v64, v64, v65
    v_add_f32 v66, v66, v67
    v_add_f32 v68, v68, v69
    v_add_f32 v70, v70, v71
    v_permlane32_swap_b32 v64, v66
    s_nop 0
    v_permlane32_swap_b32 v68, v70
    v_add_f32 v64, v64, v66
    v_add_f32 v68, v68, v70
    v_and_b32 v3, 0x70, v1
    v_lshlrev_b32 v3, 1, v3
    v_lshrrev_b32 v4, 8, v1
    v_lshl_add_u32 v3, v4, 2, v3
    s_lshl_b32 s33, s12, 8
    s_add_u32 s33, s33, 135168
    v_add_u32 v3, s33, v3
    ds_write_b32 v3, v64
    ds_write_b32 v3, v68 offset:16
    s_waitcnt lgkmcnt(0)
    s_barrier
    s_cmp_eq_u32 s12, 6
    s_cbranch_scc1 L_p0_pub
L_p0_pubd:
    s_waitcnt vmcnt(2)
    s_cmp_eq_u32 s12, 5
    s_cbranch_scc1 L_j1_k
    ds_read_b64_tr_b16 v[240:241], v82 offset:0
    ds_read_b64_tr_b16 v[242:243], v82 offset:1024
    ds_read_b64_tr_b16 v[244:245], v82 offset:64
    ds_read_b64_tr_b16 v[246:247], v82 offset:1088
    ds_read_b64_tr_b16 v[248:249], v82 offset:128
    ds_read_b64_tr_b16 v[250:251], v82 offset:1152
    ds_read_b64_tr_b16 v[252:253], v82 offset:192
    ds_read_b64_tr_b16 v[254:255], v82 offset:1216
    s_branch L_j1_d
L_j1_k:
    ds_read_b128 v[240:243], v84 offset:0
    ds_read_b128 v[244:247], v84 offset:32
    ds_read_b128 v[248:251], v84 offset:64
    ds_read_b128 v[252:255], v84 offset:96
L_j1_d:
    s_waitcnt lgkmcnt(0)
    s_add_u32 s33, s52, s53
    s_add_u32 s34, s52, s54
    s_add_u32 s35, s34, s53
    buffer_store_dwordx4 v[240:243], v1, s[4:7], s52 offen sc1
    buffer_store_dwordx4 v[244:247], v1, s[4:7], s33 offen sc1
    buffer_store_dwordx4 v[248:251], v1, s[4:7], s34 offen sc1
    buffer_store_dwordx4 v[252:255], v1, s[4:7], s35 offen sc1
    s_lshl_b32 s15, s14, 16
    s_lshl_b32 s16, s12, 13
    s_add_u32 s15, s15, s16
    s_add_u32 s16, s15, 4096
    s_lshl_b32 s33, s12, 10
    s_add_u32 s33, s33, 131072
    s_add_u32 s34, s33, 24576
    s_add_u32 s35, s33, 49152
    s_add_u32 s32, s33, 73728
    s_lshl_b32 s58, s13, 3
    s_lshr_b32 s59, s14, 2
    s_add_u32 s58, s58, s59
    s_lshl_b32 s58, s58, 9
    s_add_u32 s58, s58, 51576832
    s_cmp_eq_u32 s12, 7
    s_cselect_b32 s58, s58, 268435456
    s_mov_b32 s59, 0
    v_and_b32 v87, 0x1f0, v1
    s_lshr_b32 s25, s2, 5
    s_waitcnt vmcnt(0)
    s_barrier
    s_lshl_b32 s24, s25, 8
    s_add_u32 s24, s24, s47
    s_lshl_b32 s24, s24, 4
    s_add_u32 s24, s24, 51576832
    s_cmp_eq_u32 s12, 7
    s_cselect_b32 s24, s24, 268435456
    v_lshlrev_b32 v9, 5, v1
    v_cmp_lt_u32 vcc, 127, v1
    v_mov_b32 v10, 268435456
    s_nop 0
    v_cndmask_b32 v9, v9, v10, vcc
    v_mov_b32 v10, s51
    buffer_store_dword v10, v9, s[4:7], s24 offen sc1
    buffer_load_dwordx4 v[16:19], v1, s[8:11], s15 offen offset:0
    buffer_load_dwordx4 v[20:23], v1, s[8:11], s15 offen offset:1024
    buffer_load_dwordx4 v[24:27], v1, s[8:11], s15 offen offset:2048
    buffer_load_dwordx4 v[28:31], v1, s[8:11], s15 offen offset:3072
    buffer_load_dwordx4 v[32:35], v1, s[8:11], s16 offen offset:0
    buffer_load_dwordx4 v[36:39], v1, s[8:11], s16 offen offset:1024
    buffer_load_dwordx4 v[40:43], v1, s[8:11], s16 offen offset:2048
    buffer_load_dwordx4 v[44:47], v1, s[8:11], s16 offen offset:3072
    s_mov_b32 s28, s48
    s_mov_b32 s29, s49
    s_add_u32 m0, s43, 0
    s_nop 0
    buffer_load_dwordx4 v85, s[28:31], s45 offen nt lds
    s_add_u32 s45, s45, s41
    s_add_u32 m0, s43, 1024
    s_nop 0
    buffer_load_dwordx4 v85, s[28:31], s45 offen nt lds
    s_add_u32 s45, s45, s41
    s_add_u32 m0, s43, 2048
    s_nop 0
    buffer_load_dwordx4 v85, s[28:31], s45 offen nt lds
    s_add_u32 s45, s45, s41
    s_add_u32 m0, s43, 3072
    s_nop 0
    buffer_load_dwordx4 v85, s[28:31], s45 offen nt lds
    s_waitcnt vmcnt(4)
    s_mov_b32 s28, 0xffff0000
    v_lshlrev_b32 v96, 16, v16
    v_and_b32 v97, s28, v16
    v_lshlrev_b32 v98, 16, v17
    v_and_b32 v99, s28, v17
    v_lshlrev_b32 v100, 16, v18
    v_and_b32 v101, s28, v18
    v_lshlrev_b32 v102, 16, v19
    v_and_b32 v103, s28, v19
    v_lshlrev_b32 v104, 16, v20
    v_and_b32 v105, s28, v20
    v_lshlrev_b32 v106, 16, v21
    v_and_b32 v107, s28, v21
    v_lshlrev_b32 v108, 16, v22
    v_and_b32 v109, s28, v22
    v_lshlrev_b32 v110, 16, v23
    v_and_b32 v111, s28, v23
    v_lshlrev_b32 v112, 16, v24
    v_and_b32 v113, s28, v24
    v_lshlrev_b32 v114, 16, v25
    v_and_b32 v115, s28, v25
    v_lshlrev_b32 v116, 16, v26
    v_and_b32 v117, s28, v26
    v_lshlrev_b32 v118, 16, v27
    v_and_b32 v119, s28, v27
    v_lshlrev_b32 v120, 16, v28
    v_and_b32 v121, s28, v28
    v_lshlrev_b32 v122, 16, v29
    v_and_b32 v123, s28, v29
    v_lshlrev_b32 v124, 16, v30
    v_and_b32 v125, s28, v30
    v_lshlrev_b32 v126, 16, v31
    v_and_b32 v127, s28, v31
    v_lshlrev_b32 v128, 16, v32
    v_and_b32 v129, s28, v32
    v_lshlrev_b32 v130, 16, v33
    v_and_b32 v131, s28, v33
    v_lshlrev_b32 v132, 16, v34
    v_and_b32 v133, s28, v34
    v_lshlrev_b32 v134, 16, v35
    v_and_b32 v135, s28, v35
    v_lshlrev_b32 v136, 16, v36
    v_and_b32 v137, s28, v36
    v_lshlrev_b32 v138, 16, v37
    v_and_b32 v139, s28, v37
    v_lshlrev_b32 v140, 16, v38
    v_and_b32 v141, s28, v38
    v_lshlrev_b32 v142, 16, v39
    v_and_b32 v143, s28, v39
    v_lshlrev_b32 v144, 16, v40
    v_and_b32 v145, s28, v40
    v_lshlrev_b32 v146, 16, v41
    v_and_b32 v147, s28, v41
    v_lshlrev_b32 v148, 16, v42
    v_and_b32 v149, s28, v42
    v_lshlrev_b32 v150, 16, v43
    v_and_b32 v151, s28, v43
    v_lshlrev_b32 v152, 16, v44
    v_and_b32 v153, s28, v44
    v_lshlrev_b32 v154, 16, v45
    v_and_b32 v155, s28, v45
    v_lshlrev_b32 v156, 16, v46
    v_and_b32 v157, s28, v46
    v_lshlrev_b32 v158, 16, v47
    v_and_b32 v159, s28, v47
    v_add_f32 v64, v96, v97
    v_add_f32 v72, v98, v99
    v_add_f32 v73, v100, v101
    v_add_f32 v74, v102, v103
    v_add_f32 v64, v64, v72
    v_add_f32 v73, v73, v74
    v_add_f32 v64, v64, v73
    v_add_f32 v65, v104, v105
    v_add_f32 v72, v106, v107
    v_add_f32 v73, v108, v109
    v_add_f32 v74, v110, v111
    v_add_f32 v65, v65, v72
    v_add_f32 v73, v73, v74
    v_add_f32 v65, v65, v73
    v_add_f32 v66, v112, v113
    v_add_f32 v72, v114, v115
    v_add_f32 v73, v116, v117
    v_add_f32 v74, v118, v119
    v_add_f32 v66, v66, v72
    v_add_f32 v73, v73, v74
    v_add_f32 v66, v66, v73
    v_add_f32 v67, v120, v121
    v_add_f32 v72, v122, v123
    v_add_f32 v73, v124, v125
    v_add_f32 v74, v126, v127
    v_add_f32 v67, v67, v72
    v_add_f32 v73, v73, v74
    v_add_f32 v67, v67, v73
    v_add_f32 v68, v128, v129
    v_add_f32 v72, v130, v131
    v_add_f32 v73, v132, v133
    v_add_f32 v74, v134, v135
    v_add_f32 v68, v68, v72
    v_add_f32 v73, v73, v74
    v_add_f32 v68, v68, v73
    v_add_f32 v69, v136, v137
    v_add_f32 v72, v138, v139
    v_add_f32 v73, v140, v141
    v_add_f32 v74, v142, v143
    v_add_f32 v69, v69, v72
    v_add_f32 v73, v73, v74
    v_add_f32 v69, v69, v73
    v_add_f32 v70, v144, v145
    v_add_f32 v72, v146, v147
    v_add_f32 v73, v148, v149
    v_add_f32 v74, v150, v151
    v_add_f32 v70, v70, v72
    v_add_f32 v73, v73, v74
    v_add_f32 v70, v70, v73
    v_add_f32 v71, v152, v153
    v_add_f32 v72, v154, v155
    v_add_f32 v73, v156, v157
    v_add_f32 v74, v158, v159
    v_add_f32 v71, v71, v72
    v_add_f32 v73, v73, v74
    v_add_f32 v71, v71, v73
    v_permlane32_swap_b32 v64, v65
    v_permlane32_swap_b32 v66, v67
    v_permlane32_swap_b32 v68, v69
    v_permlane32_swap_b32 v70, v71
    v_add_f32 v64, v64, v65
    v_add_f32 v66, v66, v67
    v_add_f32 v68, v68, v69
    v_add_f32 v70, v70, v71
    v_permlane16_swap_b32 v64, v66
    s_nop 0
    v_permlane16_swap_b32 v68, v70
    v_add_f32 v64, v64, v66
    v_add_f32 v68, v68, v70
    s_nop 0
    v_add_f32_dpp v64, v64, v64 row_ror:8 row_mask:0xf bank_mask:0xf
    v_add_f32_dpp v68, v68, v68 row_ror:8 row_mask:0xf bank_mask:0xf
    s_nop 0
    v_add_f32_dpp v64, v64, v64 row_ror:4 row_mask:0xf bank_mask:0xf
    v_add_f32_dpp v68, v68, v68 row_ror:4 row_mask:0xf bank_mask:0xf
    s_nop 0
    v_add_f32_dpp v64, v64, v64 row_ror:2 row_mask:0xf bank_mask:0xf
    v_add_f32_dpp v68, v68, v68 row_ror:2 row_mask:0xf bank_mask:0xf
    s_nop 0
    v_add_f32_dpp v64, v64, v64 row_ror:1 row_mask:0xf bank_mask:0xf
    v_add_f32_dpp v68, v68, v68 row_ror:1 row_mask:0xf bank_mask:0xf
    v_mul_f32 v64, 0x3b000000, v64
    v_mul_f32 v68, 0x3b000000, v68
    v_readlane_b32 s60, v64, 0
    v_readlane_b32 s61, v64, 32
    v_readlane_b32 s62, v64, 16
    v_readlane_b32 s63, v64, 48
    v_readlane_b32 s64, v68, 0
    v_readlane_b32 s65, v68, 32
    v_readlane_b32 s66, v68, 16
    v_readlane_b32 s67, v68, 48
    buffer_load_dwordx4 v[48:51], v1, s[4:7], s33 offen sc1
    buffer_load_dwordx4 v[52:55], v1, s[4:7], s34 offen sc1
    buffer_load_dwordx4 v[56:59], v1, s[4:7], s35 offen sc1
    buffer_load_dwordx4 v[60:63], v1, s[4:7], s32 offen sc1
    buffer_load_dword v86, v87, s[4:7], s58 offen sc1
    v_subrev_f32 v96, s60, v96
    v_subrev_f32 v97, s60, v97
    v_subrev_f32 v98, s60, v98
    v_subrev_f32 v99, s60, v99
    v_subrev_f32 v100, s60, v100
    v_subrev_f32 v101, s60, v101
    v_subrev_f32 v102, s60, v102
    v_subrev_f32 v103, s60, v103
    v_mul_f32 v64, v96, v96
    v_fmac_f32 v64, v97, v97
    v_fmac_f32 v64, v98, v98
    v_fmac_f32 v64, v99, v99
    v_fmac_f32 v64, v100, v100
    v_fmac_f32 v64, v101, v101
    v_fmac_f32 v64, v102, v102
    v_fmac_f32 v64, v103, v103
    v_subrev_f32 v104, s61, v104
    v_subrev_f32 v105, s61, v105
    v_subrev_f32 v106, s61, v106
    v_subrev_f32 v107, s61, v107
    v_subrev_f32 v108, s61, v108
    v_subrev_f32 v109, s61, v109
    v_subrev_f32 v110, s61, v110
    v_subrev_f32 v111, s61, v111
    v_mul_f32 v65, v104, v104
    v_fmac_f32 v65, v105, v105
    v_fmac_f32 v65, v106, v106
    v_fmac_f32 v65, v107, v107
    v_fmac_f32 v65, v108, v108
    v_fmac_f32 v65, v109, v109
    v_fmac_f32 v65, v110, v110
    v_fmac_f32 v65, v111, v111
    v_subrev_f32 v112, s62, v112
    v_subrev_f32 v113, s62, v113
    v_subrev_f32 v114, s62, v114
    v_subrev_f32 v115, s62, v115
    v_subrev_f32 v116, s62, v116
    v_subrev_f32 v117, s62, v117
    v_subrev_f32 v118, s62, v118
    v_subrev_f32 v119, s62, v119
    v_mul_f32 v66, v112, v112
    v_fmac_f32 v66, v113, v113
    v_fmac_f32 v66, v114, v114
    v_fmac_f32 v66, v115, v115
    v_fmac_f32 v66, v116, v116
    v_fmac_f32 v66, v117, v117
    v_fmac_f32 v66, v118, v118
    v_fmac_f32 v66, v119, v119
    v_subrev_f32 v120, s63, v120
    v_subrev_f32 v121, s63, v121
    v_subrev_f32 v122, s63, v122
    v_subrev_f32 v123, s63, v123
    v_subrev_f32 v124, s63, v124
    v_subrev_f32 v125, s63, v125
    v_subrev_f32 v126, s63, v126
    v_subrev_f32 v127, s63, v127
    v_mul_f32 v67, v120, v120
    v_fmac_f32 v67, v121, v121
    v_fmac_f32 v67, v122, v122
    v_fmac_f32 v67, v123, v123
    v_fmac_f32 v67, v124, v124
    v_fmac_f32 v67, v125, v125
    v_fmac_f32 v67, v126, v126
    v_fmac_f32 v67, v127, v127
    v_subrev_f32 v128, s64, v128
    v_subrev_f32 v129, s64, v129
    v_subrev_f32 v130, s64, v130
    v_subrev_f32 v131, s64, v131
    v_subrev_f32 v132, s64, v132
    v_subrev_f32 v133, s64, v133
    v_subrev_f32 v134, s64, v134
    v_subrev_f32 v135, s64, v135
    v_mul_f32 v68, v128, v128
    v_fmac_f32 v68, v129, v129
    v_fmac_f32 v68, v130, v130
    v_fmac_f32 v68, v131, v131
    v_fmac_f32 v68, v132, v132
    v_fmac_f32 v68, v133, v133
    v_fmac_f32 v68, v134, v134
    v_fmac_f32 v68, v135, v135
    v_subrev_f32 v136, s65, v136
    v_subrev_f32 v137, s65, v137
    v_subrev_f32 v138, s65, v138
    v_subrev_f32 v139, s65, v139
    v_subrev_f32 v140, s65, v140
    v_subrev_f32 v141, s65, v141
    v_subrev_f32 v142, s65, v142
    v_subrev_f32 v143, s65, v143
    v_mul_f32 v69, v136, v136
    v_fmac_f32 v69, v137, v137
    v_fmac_f32 v69, v138, v138
    v_fmac_f32 v69, v139, v139
    v_fmac_f32 v69, v140, v140
    v_fmac_f32 v69, v141, v141
    v_fmac_f32 v69, v142, v142
    v_fmac_f32 v69, v143, v143
    v_subrev_f32 v144, s66, v144
    v_subrev_f32 v145, s66, v145
    v_subrev_f32 v146, s66, v146
    v_subrev_f32 v147, s66, v147
    v_subrev_f32 v148, s66, v148
    v_subrev_f32 v149, s66, v149
    v_subrev_f32 v150, s66, v150
    v_subrev_f32 v151, s66, v151
    v_mul_f32 v70, v144, v144
    v_fmac_f32 v70, v145, v145
    v_fmac_f32 v70, v146, v146
    v_fmac_f32 v70, v147, v147
    v_fmac_f32 v70, v148, v148
    v_fmac_f32 v70, v149, v149
    v_fmac_f32 v70, v150, v150
    v_fmac_f32 v70, v151, v151
    v_subrev_f32 v152, s67, v152
    v_subrev_f32 v153, s67, v153
    v_subrev_f32 v154, s67, v154
    v_subrev_f32 v155, s67, v155
    v_subrev_f32 v156, s67, v156
    v_subrev_f32 v157, s67, v157
    v_subrev_f32 v158, s67, v158
    v_subrev_f32 v159, s67, v159
    v_mul_f32 v71, v152, v152
    v_fmac_f32 v71, v153, v153
    v_fmac_f32 v71, v154, v154
    v_fmac_f32 v71, v155, v155
    v_fmac_f32 v71, v156, v156
    v_fmac_f32 v71, v157, v157
    v_fmac_f32 v71, v158, v158
    v_fmac_f32 v71, v159, v159
    v_permlane32_swap_b32 v64, v65
    v_permlane32_swap_b32 v66, v67
    v_permlane32_swap_b32 v68, v69
    v_permlane32_swap_b32 v70, v71
    v_add_f32 v64, v64, v65
    v_add_f32 v66, v66, v67
    v_add_f32 v68, v68, v69
    v_add_f32 v70, v70, v71
    v_permlane16_swap_b32 v64, v66
    s_nop 0
    v_permlane16_swap_b32 v68, v70
    v_add_f32 v64, v64, v66
    v_add_f32 v68, v68, v70
    s_nop 0
    v_add_f32_dpp v64, v64, v64 row_ror:8 row_mask:0xf bank_mask:0xf
    v_add_f32_dpp v68, v68, v68 row_ror:8 row_mask:0xf bank_mask:0xf
    s_nop 0
    v_add_f32_dpp v64, v64, v64 row_ror:4 row_mask:0xf bank_mask:0xf
    v_add_f32_dpp v68, v68, v68 row_ror:4 row_mask:0xf bank_mask:0xf
    s_nop 0
    v_add_f32_dpp v64, v64, v64 row_ror:2 row_mask:0xf bank_mask:0xf
    v_add_f32_dpp v68, v68, v68 row_ror:2 row_mask:0xf bank_mask:0xf
    s_nop 0
    v_add_f32_dpp v64, v64, v64 row_ror:1 row_mask:0xf bank_mask:0xf
    v_add_f32_dpp v68, v68, v68 row_ror:1 row_mask:0xf bank_mask:0xf
    v_mov_b32 v72, 0x3727c5ac
    v_fmac_f32 v72, 0x3b000000, v64
    v_rsq_f32 v64, v72
    v_mov_b32 v72, 0x3727c5ac
    v_fmac_f32 v72, 0x3b000000, v68
    v_rsq_f32 v68, v72
    v_readlane_b32 s60, v64, 0
    v_readlane_b32 s61, v64, 32
    v_readlane_b32 s62, v64, 16
    v_readlane_b32 s63, v64, 48
    v_readlane_b32 s64, v68, 0
    v_readlane_b32 s65, v68, 32
    v_readlane_b32 s66, v68, 16
    v_readlane_b32 s67, v68, 48
    s_cmp_eq_u32 s12, 7
    s_cbranch_scc1 L_p0_f1
L_p0_f1d:
    s_waitcnt vmcnt(4)
    v_xor_b32 v80, s51, v49
    v_xor_b32 v81, s51, v51
    v_or_b32 v80, v80, v81
    s_waitcnt vmcnt(3)
    v_xor_b32 v81, s51, v53
    v_or_b32 v80, v80, v81
    v_xor_b32 v81, s51, v55
    v_or_b32 v80, v80, v81
    s_waitcnt vmcnt(2)
    v_xor_b32 v81, s51, v57
    v_or_b32 v80, v80, v81
    v_xor_b32 v81, s51, v59
    v_or_b32 v80, v80, v81
    s_waitcnt vmcnt(1)
    v_xor_b32 v81, s51, v61
    v_or_b32 v80, v80, v81
    v_xor_b32 v81, s51, v63
    v_or_b32 v80, v80, v81
    v_cmp_ne_u32 vcc, 0, v80
    s_nop 0
    s_cbranch_vccnz L_p0_gre
L_p0_got:
    s_cmp_ge_u32 s12, 4
    s_cselect_b32 s33, 1.0, 0
    s_mov_b32 s32, 0x3e0293ee
    v_add_f32 v48, v48, v52
    v_add_f32 v56, v56, v60
    v_add_f32 v48, v48, v56
    v_cvt_pk_bf16_f32 v48, v48, v48
    v_and_b32 v48, s28, v48
    v_add_f32 v48, s33, v48
    v_cvt_pk_bf16_f32 v48, v48, v48
    v_and_b32 v48, s28, v48
    v_add_f32 v50, v50, v54
    v_add_f32 v58, v58, v62
    v_add_f32 v50, v50, v58
    v_cvt_pk_bf16_f32 v50, v50, v50
    v_and_b32 v50, s28, v50
    v_add_f32 v50, s33, v50
    v_cvt_pk_bf16_f32 v50, v50, v50
    v_and_b32 v50, s28, v50
    v_mul_f32 v48, s32, v48
    v_mul_f32 v49, s32, v50
    v_lshrrev_b32 v80, 1, v1
    s_lshl_b32 s33, s12, 9
    s_add_u32 s33, s33, 131072
    v_add_u32 v80, s33, v80
    ds_write_b64 v80, v[48:49]
    s_waitcnt lgkmcnt(0)
    s_barrier
    v_lshlrev_b32 v80, 1, v1
    v_add_u32 v80, 131072, v80
    ds_read_b128 v[48:51], v80
    ds_read_b128 v[52:55], v80 offset:16
    ds_read_b128 v[56:59], v80 offset:2048
    ds_read_b128 v[60:63], v80 offset:2064
    s_lshl_b32 s17, s13, 3
    s_add_u32 s17, s17, s12
    s_lshl_b32 s17, s17, 16
    s_add_u32 s18, s17, 5242880
    s_add_u32 s17, s17, 1048576
    s_lshl_b32 s21, s12, 12
    s_lshl_b32 s22, s12, 10
    s_lshl_b32 s19, s13, 17
    s_add_u32 s20, s19, 13631488
    s_add_u32 s19, s19, 12582912
    s_mul_i32 s23, s12, 3072
    v_lshrrev_b32 v9, 4, v1
    s_and_b32 s25, s12, 1
    s_lshr_b32 s26, s12, 2
    s_lshl_b32 s26, s26, 15
    s_and_b32 s27, s12, 3
    s_lshl_b32 s27, s27, 7
    s_add_u32 s26, s26, s27
    s_add_u32 s26, s26, 32768
    v_lshlrev_b32 v11, 9, v9
    v_and_b32 v10, 7, v9
    v_lshl_add_u32 v11, v10, 4, v11
    v_add_u32 v11, s26, v11
    v_lshrrev_b32 v10, 5, v9
    v_and_b32 v9, 31, v9
    v_xor_b32 v9, v9, v10
    v_lshlrev_b32 v9, 4, v9
    v_lshl_add_u32 v9, v10, 9, v9
    s_lshl_b32 s26, s25, 15
    s_add_u32 s27, s26, 32768
    s_sub_u32 s26, 65536, s26
    v_xor_b32 v10, 0, v9
    v_add_u32 v12, s27, v10
    v_add_u32 v2, s26, v10
    v_xor_b32 v10, 32, v9
    v_add_u32 v13, s27, v10
    v_add_u32 v3, s26, v10
    v_xor_b32 v10, 64, v9
    v_add_u32 v14, s27, v10
    v_add_u32 v6, s26, v10
    v_xor_b32 v10, 96, v9
    v_add_u32 v15, s27, v10
    v_add_u32 v7, s26, v10
    s_add_u32 s34, s17, 0
    buffer_load_dwordx4 v[160:163], v1, s[4:7], s34 offen offset:0 sc1
    buffer_load_dwordx4 v[164:167], v1, s[4:7], s34 offen offset:1024 sc1
    buffer_load_dwordx4 v[168:171], v1, s[4:7], s34 offen offset:2048 sc1
    buffer_load_dwordx4 v[172:175], v1, s[4:7], s34 offen offset:3072 sc1
    v_mul_f32 v96, s60, v96
    v_mul_f32 v97, s60, v97
    v_mul_f32 v98, s60, v98
    v_mul_f32 v99, s60, v99
    v_mul_f32 v100, s60, v100
    v_mul_f32 v101, s60, v101
    v_mul_f32 v102, s60, v102
    v_mul_f32 v103, s60, v103
    s_waitcnt lgkmcnt(1)
    v_fma_f32 v96, v96, v56, v48
    v_fma_f32 v97, v97, v57, v49
    v_fma_f32 v98, v98, v58, v50
    v_fma_f32 v99, v99, v59, v51
    s_waitcnt lgkmcnt(0)
    v_fma_f32 v100, v100, v60, v52
    v_fma_f32 v101, v101, v61, v53
    v_fma_f32 v102, v102, v62, v54
    v_fma_f32 v103, v103, v63, v55
    v_cvt_pk_bf16_f32 v16, v96, v97
    v_cvt_pk_bf16_f32 v17, v98, v99
    v_cvt_pk_bf16_f32 v18, v100, v101
    v_cvt_pk_bf16_f32 v19, v102, v103
    v_xor_b32 v10, 0, v11
    ds_write_b128 v10, v[16:19]
    s_add_u32 s34, s17, 4096
    buffer_load_dwordx4 v[176:179], v1, s[4:7], s34 offen offset:0 sc1
    buffer_load_dwordx4 v[180:183], v1, s[4:7], s34 offen offset:1024 sc1
    v_mul_f32 v104, s61, v104
    v_mul_f32 v105, s61, v105
    v_mul_f32 v106, s61, v106
    v_mul_f32 v107, s61, v107
    v_mul_f32 v108, s61, v108
    v_mul_f32 v109, s61, v109
    v_mul_f32 v110, s61, v110
    v_mul_f32 v111, s61, v111
    v_fma_f32 v104, v104, v56, v48
    v_fma_f32 v105, v105, v57, v49
    v_fma_f32 v106, v106, v58, v50
    v_fma_f32 v107, v107, v59, v51
    v_fma_f32 v108, v108, v60, v52
    v_fma_f32 v109, v109, v61, v53
    v_fma_f32 v110, v110, v62, v54
    v_fma_f32 v111, v111, v63, v55
    v_cvt_pk_bf16_f32 v20, v104, v105
    v_cvt_pk_bf16_f32 v21, v106, v107
    v_cvt_pk_bf16_f32 v22, v108, v109
    v_cvt_pk_bf16_f32 v23, v110, v111
    v_xor_b32 v10, 16, v11
    ds_write_b128 v10, v[20:23]
    buffer_load_dwordx4 v[184:187], v1, s[4:7], s34 offen offset:2048 sc1
    buffer_load_dwordx4 v[188:191], v1, s[4:7], s34 offen offset:3072 sc1
    v_mul_f32 v112, s62, v112
    v_mul_f32 v113, s62, v113
    v_mul_f32 v114, s62, v114
    v_mul_f32 v115, s62, v115
    v_mul_f32 v116, s62, v116
    v_mul_f32 v117, s62, v117
    v_mul_f32 v118, s62, v118
    v_mul_f32 v119, s62, v119
    v_fma_f32 v112, v112, v56, v48
    v_fma_f32 v113, v113, v57, v49
    v_fma_f32 v114, v114, v58, v50
    v_fma_f32 v115, v115, v59, v51
    v_fma_f32 v116, v116, v60, v52
    v_fma_f32 v117, v117, v61, v53
    v_fma_f32 v118, v118, v62, v54
    v_fma_f32 v119, v119, v63, v55
    v_cvt_pk_bf16_f32 v24, v112, v113
    v_cvt_pk_bf16_f32 v25, v114, v115
    v_cvt_pk_bf16_f32 v26, v116, v117
    v_cvt_pk_bf16_f32 v27, v118, v119
    v_xor_b32 v10, 32, v11
    ds_write_b128 v10, v[24:27]
    s_add_u32 s34, s17, 8192
    buffer_load_dwordx4 v[192:195], v1, s[4:7], s34 offen offset:0 sc1
    buffer_load_dwordx4 v[196:199], v1, s[4:7], s34 offen offset:1024 sc1
    v_mul_f32 v120, s63, v120
    v_mul_f32 v121, s63, v121
    v_mul_f32 v122, s63, v122
    v_mul_f32 v123, s63, v123
    v_mul_f32 v124, s63, v124
    v_mul_f32 v125, s63, v125
    v_mul_f32 v126, s63, v126
    v_mul_f32 v127, s63, v127
    v_fma_f32 v120, v120, v56, v48
    v_fma_f32 v121, v121, v57, v49
    v_fma_f32 v122, v122, v58, v50
    v_fma_f32 v123, v123, v59, v51
    v_fma_f32 v124, v124, v60, v52
    v_fma_f32 v125, v125, v61, v53
    v_fma_f32 v126, v126, v62, v54
    v_fma_f32 v127, v127, v63, v55
    v_cvt_pk_bf16_f32 v28, v120, v121
    v_cvt_pk_bf16_f32 v29, v122, v123
    v_cvt_pk_bf16_f32 v30, v124, v125
    v_cvt_pk_bf16_f32 v31, v126, v127
    v_xor_b32 v10, 48, v11
    ds_write_b128 v10, v[28:31]
    buffer_load_dwordx4 v[200:203], v1, s[4:7], s34 offen offset:2048 sc1
    buffer_load_dwordx4 v[204:207], v1, s[4:7], s34 offen offset:3072 sc1
    v_mul_f32 v128, s64, v128
    v_mul_f32 v129, s64, v129
    v_mul_f32 v130, s64, v130
    v_mul_f32 v131, s64, v131
    v_mul_f32 v132, s64, v132
    v_mul_f32 v133, s64, v133
    v_mul_f32 v134, s64, v134
    v_mul_f32 v135, s64, v135
    v_fma_f32 v128, v128, v56, v48
    v_fma_f32 v129, v129, v57, v49
    v_fma_f32 v130, v130, v58, v50
    v_fma_f32 v131, v131, v59, v51
    v_fma_f32 v132, v132, v60, v52
    v_fma_f32 v133, v133, v61, v53
    v_fma_f32 v134, v134, v62, v54
    v_fma_f32 v135, v135, v63, v55
    v_cvt_pk_bf16_f32 v32, v128, v129
    v_cvt_pk_bf16_f32 v33, v130, v131
    v_cvt_pk_bf16_f32 v34, v132, v133
    v_cvt_pk_bf16_f32 v35, v134, v135
    v_xor_b32 v10, 64, v11
    ds_write_b128 v10, v[32:35]
    s_add_u32 s34, s17, 12288
    buffer_load_dwordx4 v[208:211], v1, s[4:7], s34 offen offset:0 sc1
    buffer_load_dwordx4 v[212:215], v1, s[4:7], s34 offen offset:1024 sc1
    v_mul_f32 v136, s65, v136
    v_mul_f32 v137, s65, v137
    v_mul_f32 v138, s65, v138
    v_mul_f32 v139, s65, v139
    v_mul_f32 v140, s65, v140
    v_mul_f32 v141, s65, v141
    v_mul_f32 v142, s65, v142
    v_mul_f32 v143, s65, v143
    v_fma_f32 v136, v136, v56, v48
    v_fma_f32 v137, v137, v57, v49
    v_fma_f32 v138, v138, v58, v50
    v_fma_f32 v139, v139, v59, v51
    v_fma_f32 v140, v140, v60, v52
    v_fma_f32 v141, v141, v61, v53
    v_fma_f32 v142, v142, v62, v54
    v_fma_f32 v143, v143, v63, v55
    v_cvt_pk_bf16_f32 v36, v136, v137
    v_cvt_pk_bf16_f32 v37, v138, v139
    v_cvt_pk_bf16_f32 v38, v140, v141
    v_cvt_pk_bf16_f32 v39, v142, v143
    v_xor_b32 v10, 80, v11
    ds_write_b128 v10, v[36:39]
    buffer_load_dwordx4 v[216:219], v1, s[4:7], s34 offen offset:2048 sc1
    buffer_load_dwordx4 v[220:223], v1, s[4:7], s34 offen offset:3072 sc1
    v_mul_f32 v144, s66, v144
    v_mul_f32 v145, s66, v145
    v_mul_f32 v146, s66, v146
    v_mul_f32 v147, s66, v147
    v_mul_f32 v148, s66, v148
    v_mul_f32 v149, s66, v149
    v_mul_f32 v150, s66, v150
    v_mul_f32 v151, s66, v151
    v_fma_f32 v144, v144, v56, v48
    v_fma_f32 v145, v145, v57, v49
    v_fma_f32 v146, v146, v58, v50
    v_fma_f32 v147, v147, v59, v51
    v_fma_f32 v148, v148, v60, v52
    v_fma_f32 v149, v149, v61, v53
    v_fma_f32 v150, v150, v62, v54
    v_fma_f32 v151, v151, v63, v55
    v_cvt_pk_bf16_f32 v40, v144, v145
    v_cvt_pk_bf16_f32 v41, v146, v147
    v_cvt_pk_bf16_f32 v42, v148, v149
    v_cvt_pk_bf16_f32 v43, v150, v151
    v_xor_b32 v10, 96, v11
    ds_write_b128 v10, v[40:43]
    v_mul_f32 v152, s67, v152
    v_mul_f32 v153, s67, v153
    v_mul_f32 v154, s67, v154
    v_mul_f32 v155, s67, v155
    v_mul_f32 v156, s67, v156
    v_mul_f32 v157, s67, v157
    v_mul_f32 v158, s67, v158
    v_mul_f32 v159, s67, v159
    v_fma_f32 v152, v152, v56, v48
    v_fma_f32 v153, v153, v57, v49
    v_fma_f32 v154, v154, v58, v50
    v_fma_f32 v155, v155, v59, v51
    v_fma_f32 v156, v156, v60, v52
    v_fma_f32 v157, v157, v61, v53
    v_fma_f32 v158, v158, v62, v54
    v_fma_f32 v159, v159, v63, v55
    v_cvt_pk_bf16_f32 v44, v152, v153
    v_cvt_pk_bf16_f32 v45, v154, v155
    v_cvt_pk_bf16_f32 v46, v156, v157
    v_cvt_pk_bf16_f32 v47, v158, v159
    v_xor_b32 v10, 112, v11
    ds_write_b128 v10, v[44:47]
    s_cmp_eq_u32 s12, 7
    s_cbranch_scc1 L_p0_w7
L_p0_w7d:
    s_waitcnt lgkmcnt(0)
    s_barrier
L_q_phase:
    ds_read_b128 v[16:19], v12 offset:0
    ds_read_b128 v[20:23], v2 offset:0
    ds_read_b128 v[24:27], v13 offset:1024
    ds_read_b128 v[28:31], v3 offset:1024
    ds_read_b128 v[32:35], v14 offset:2048
    ds_read_b128 v[36:39], v6 offset:2048
    s_waitcnt vmcnt(15) lgkmcnt(5)
    v_mfma_f32_32x32x16_bf16 v[96:111], v[160:163], v[16:19], 0
    s_waitcnt lgkmcnt(4)
    v_mfma_f32_32x32x16_bf16 v[112:127], v[160:163], v[20:23], 0
    s_add_u32 s34, s17, 16384
    buffer_load_dwordx4 v[224:227], v1, s[4:7], s34 offen offset:0 sc1
    ds_read_b128 v[40:43], v15 offset:3072
    ds_read_b128 v[44:47], v7 offset:3072
    s_waitcnt vmcnt(15)
    v_mfma_f32_32x32x16_bf16 v[128:143], v[164:167], v[16:19], 0
    v_mfma_f32_32x32x16_bf16 v[144:159], v[164:167], v[20:23], 0
    buffer_load_dwordx4 v[228:231], v1, s[4:7], s34 offen offset:1024 sc1
    s_waitcnt vmcnt(15) lgkmcnt(5)
    v_mfma_f32_32x32x16_bf16 v[96:111], v[168:171], v[24:27], v[96:111]
    s_waitcnt lgkmcnt(4)
    v_mfma_f32_32x32x16_bf16 v[112:127], v[168:171], v[28:31], v[112:127]
    buffer_load_dwordx4 v[232:235], v1, s[4:7], s34 offen offset:2048 sc1
    ds_read_b128 v[16:19], v12 offset:4096
    ds_read_b128 v[20:23], v2 offset:4096
    s_waitcnt vmcnt(15)
    v_mfma_f32_32x32x16_bf16 v[128:143], v[172:175], v[24:27], v[128:143]
    v_mfma_f32_32x32x16_bf16 v[144:159], v[172:175], v[28:31], v[144:159]
    buffer_load_dwordx4 v[236:239], v1, s[4:7], s34 offen offset:3072 sc1
    v_add_u32 v82, 98304, v82
    v_add_u32 v83, 98304, v83
    s_cmp_ge_u32 s12, 4
    s_cbranch_scc1 L_j2_b
    ds_read_b64_tr_b16 v[240:241], v82 offset:0
    ds_read_b64_tr_b16 v[242:243], v82 offset:1024
    ds_read_b64_tr_b16 v[244:245], v82 offset:64
    ds_read_b64_tr_b16 v[246:247], v82 offset:1088
    ds_read_b64_tr_b16 v[248:249], v82 offset:128
    ds_read_b64_tr_b16 v[250:251], v82 offset:1152
    ds_read_b64_tr_b16 v[252:253], v82 offset:192
    ds_read_b64_tr_b16 v[254:255], v82 offset:1216
    s_branch L_j2_d
L_j2_b:
    ds_read_b64_tr_b16 v[240:241], v83 offset:0
    ds_read_b64_tr_b16 v[242:243], v83 offset:512
    ds_read_b64_tr_b16 v[244:245], v83 offset:32
    ds_read_b64_tr_b16 v[246:247], v83 offset:544
    ds_read_b64_tr_b16 v[248:249], v83 offset:64
    ds_read_b64_tr_b16 v[250:251], v83 offset:576
    ds_read_b64_tr_b16 v[252:253], v83 offset:96
    ds_read_b64_tr_b16 v[254:255], v83 offset:608
L_j2_d:
    s_waitcnt lgkmcnt(0)
    s_add_u32 s40, s55, s56
    s_add_u32 s41, s55, s57
    s_add_u32 s42, s41, s56
    buffer_store_dwordx4 v[240:243], v1, s[4:7], s55 offen sc1
    buffer_store_dwordx4 v[244:247], v1, s[4:7], s40 offen sc1
    buffer_store_dwordx4 v[248:251], v1, s[4:7], s41 offen sc1
    buffer_store_dwordx4 v[252:255], v1, s[4:7], s42 offen sc1
    s_waitcnt vmcnt(19)
    v_mfma_f32_32x32x16_bf16 v[96:111], v[176:179], v[32:35], v[96:111]
    v_mfma_f32_32x32x16_bf16 v[112:127], v[176:179], v[36:39], v[112:127]
    s_add_u32 s34, s17, 20480
    buffer_load_dwordx4 v[240:243], v1, s[4:7], s34 offen offset:0 sc1
    ds_read_b128 v[24:27], v13 offset:5120
    ds_read_b128 v[28:31], v3 offset:5120
    s_waitcnt vmcnt(19)
    v_mfma_f32_32x32x16_bf16 v[128:143], v[180:183], v[32:35], v[128:143]
    v_mfma_f32_32x32x16_bf16 v[144:159], v[180:183], v[36:39], v[144:159]
    buffer_load_dwordx4 v[244:247], v1, s[4:7], s34 offen offset:1024 sc1
    s_waitcnt vmcnt(19)
    v_mfma_f32_32x32x16_bf16 v[96:111], v[184:187], v[40:43], v[96:111]
    v_mfma_f32_32x32x16_bf16 v[112:127], v[184:187], v[44:47], v[112:127]
    buffer_load_dwordx4 v[248:251], v1, s[4:7], s34 offen offset:2048 sc1
    ds_read_b128 v[32:35], v14 offset:6144
    ds_read_b128 v[36:39], v6 offset:6144
    s_waitcnt vmcnt(19)
    v_mfma_f32_32x32x16_bf16 v[128:143], v[188:191], v[40:43], v[128:143]
    v_mfma_f32_32x32x16_bf16 v[144:159], v[188:191], v[44:47], v[144:159]
    buffer_load_dwordx4 v[252:255], v1, s[4:7], s34 offen offset:3072 sc1
    s_waitcnt vmcnt(19)
    v_mfma_f32_32x32x16_bf16 v[96:111], v[192:195], v[16:19], v[96:111]
    v_mfma_f32_32x32x16_bf16 v[112:127], v[192:195], v[20:23], v[112:127]
    s_add_u32 s34, s17, 24576
    buffer_load_dwordx4 v[48:51], v1, s[4:7], s34 offen offset:0 sc1
    ds_read_b128 v[40:43], v15 offset:7168
    ds_read_b128 v[44:47], v7 offset:7168
    s_waitcnt vmcnt(19)
    v_mfma_f32_32x32x16_bf16 v[128:143], v[196:199], v[16:19], v[128:143]
    v_mfma_f32_32x32x16_bf16 v[144:159], v[196:199], v[20:23], v[144:159]
    buffer_load_dwordx4 v[52:55], v1, s[4:7], s34 offen offset:1024 sc1
    s_waitcnt vmcnt(19) lgkmcnt(5)
    v_mfma_f32_32x32x16_bf16 v[96:111], v[200:203], v[24:27], v[96:111]
    s_waitcnt lgkmcnt(4)
    v_mfma_f32_32x32x16_bf16 v[112:127], v[200:203], v[28:31], v[112:127]
    buffer_load_dwordx4 v[56:59], v1, s[4:7], s34 offen offset:2048 sc1
    ds_read_b128 v[16:19], v12 offset:8192
    ds_read_b128 v[20:23], v2 offset:8192
    s_waitcnt vmcnt(19)
    v_mfma_f32_32x32x16_bf16 v[128:143], v[204:207], v[24:27], v[128:143]
    v_mfma_f32_32x32x16_bf16 v[144:159], v[204:207], v[28:31], v[144:159]
    buffer_load_dwordx4 v[60:63], v1, s[4:7], s34 offen offset:3072 sc1
    s_waitcnt vmcnt(19) lgkmcnt(5)
    v_mfma_f32_32x32x16_bf16 v[96:111], v[208:211], v[32:35], v[96:111]
    s_waitcnt lgkmcnt(4)
    v_mfma_f32_32x32x16_bf16 v[112:127], v[208:211], v[36:39], v[112:127]
    s_add_u32 s34, s17, 28672
    buffer_load_dwordx4 v[64:67], v1, s[4:7], s34 offen offset:0 sc1
    ds_read_b128 v[24:27], v13 offset:9216
    ds_read_b128 v[28:31], v3 offset:9216
    s_waitcnt vmcnt(19)
    v_mfma_f32_32x32x16_bf16 v[128:143], v[212:215], v[32:35], v[128:143]
    v_mfma_f32_32x32x16_bf16 v[144:159], v[212:215], v[36:39], v[144:159]
    buffer_load_dwordx4 v[68:71], v1, s[4:7], s34 offen offset:1024 sc1
    s_waitcnt vmcnt(19) lgkmcnt(5)
    v_mfma_f32_32x32x16_bf16 v[96:111], v[216:219], v[40:43], v[96:111]
    s_waitcnt lgkmcnt(4)
    v_mfma_f32_32x32x16_bf16 v[112:127], v[216:219], v[44:47], v[112:127]
    buffer_load_dwordx4 v[72:75], v1, s[4:7], s34 offen offset:2048 sc1
    ds_read_b128 v[32:35], v14 offset:10240
    ds_read_b128 v[36:39], v6 offset:10240
    s_waitcnt vmcnt(19)
    v_mfma_f32_32x32x16_bf16 v[128:143], v[220:223], v[40:43], v[128:143]
    v_mfma_f32_32x32x16_bf16 v[144:159], v[220:223], v[44:47], v[144:159]
    buffer_load_dwordx4 v[76:79], v1, s[4:7], s34 offen offset:3072 sc1
    s_waitcnt vmcnt(19) lgkmcnt(5)
    v_mfma_f32_32x32x16_bf16 v[96:111], v[224:227], v[16:19], v[96:111]
    s_waitcnt lgkmcnt(4)
    v_mfma_f32_32x32x16_bf16 v[112:127], v[224:227], v[20:23], v[112:127]
    s_add_u32 s34, s17, 32768
    buffer_load_dwordx4 v[80:83], v1, s[4:7], s34 offen offset:0 sc1
    ds_read_b128 v[40:43], v15 offset:11264
    ds_read_b128 v[44:47], v7 offset:11264
    s_waitcnt vmcnt(19)
    v_mfma_f32_32x32x16_bf16 v[128:143], v[228:231], v[16:19], v[128:143]
    v_mfma_f32_32x32x16_bf16 v[144:159], v[228:231], v[20:23], v[144:159]
    buffer_load_dwordx4 v[84:87], v1, s[4:7], s34 offen offset:1024 sc1
    s_waitcnt vmcnt(19) lgkmcnt(5)
    v_mfma_f32_32x32x16_bf16 v[96:111], v[232:235], v[24:27], v[96:111]
    s_waitcnt lgkmcnt(4)
    v_mfma_f32_32x32x16_bf16 v[112:127], v[232:235], v[28:31], v[112:127]
    buffer_load_dwordx4 v[88:91], v1, s[4:7], s34 offen offset:2048 sc1
    ds_read_b128 v[16:19], v12 offset:12288
    ds_read_b128 v[20:23], v2 offset:12288
    s_waitcnt vmcnt(19)
    v_mfma_f32_32x32x16_bf16 v[128:143], v[236:239], v[24:27], v[128:143]
    v_mfma_f32_32x32x16_bf16 v[144:159], v[236:239], v[28:31], v[144:159]
    buffer_load_dwordx4 v[92:95], v1, s[4:7], s34 offen offset:3072 sc1
    s_waitcnt vmcnt(15) lgkmcnt(5)
    v_mfma_f32_32x32x16_bf16 v[96:111], v[240:243], v[32:35], v[96:111]
    s_waitcnt lgkmcnt(4)
    v_mfma_f32_32x32x16_bf16 v[112:127], v[240:243], v[36:39], v[112:127]
    s_add_u32 s34, s17, 36864
    buffer_load_dwordx4 v[160:163], v1, s[4:7], s34 offen offset:0 sc1
    ds_read_b128 v[24:27], v13 offset:13312
    ds_read_b128 v[28:31], v3 offset:13312
    s_waitcnt vmcnt(15)
    v_mfma_f32_32x32x16_bf16 v[128:143], v[244:247], v[32:35], v[128:143]
    v_mfma_f32_32x32x16_bf16 v[144:159], v[244:247], v[36:39], v[144:159]
    buffer_load_dwordx4 v[164:167], v1, s[4:7], s34 offen offset:1024 sc1
    s_waitcnt vmcnt(15) lgkmcnt(5)
    v_mfma_f32_32x32x16_bf16 v[96:111], v[248:251], v[40:43], v[96:111]
    s_waitcnt lgkmcnt(4)
    v_mfma_f32_32x32x16_bf16 v[112:127], v[248:251], v[44:47], v[112:127]
    buffer_load_dwordx4 v[168:171], v1, s[4:7], s34 offen offset:2048 sc1
    ds_read_b128 v[32:35], v14 offset:14336
    ds_read_b128 v[36:39], v6 offset:14336
    s_waitcnt vmcnt(15)
    v_mfma_f32_32x32x16_bf16 v[128:143], v[252:255], v[40:43], v[128:143]
    v_mfma_f32_32x32x16_bf16 v[144:159], v[252:255], v[44:47], v[144:159]
    buffer_load_dwordx4 v[172:175], v1, s[4:7], s34 offen offset:3072 sc1
    s_waitcnt vmcnt(15) lgkmcnt(5)
    v_mfma_f32_32x32x16_bf16 v[96:111], v[48:51], v[16:19], v[96:111]
    s_waitcnt lgkmcnt(4)
    v_mfma_f32_32x32x16_bf16 v[112:127], v[48:51], v[20:23], v[112:127]
    s_add_u32 s34, s17, 40960
    buffer_load_dwordx4 v[176:179], v1, s[4:7], s34 offen offset:0 sc1
    ds_read_b128 v[40:43], v15 offset:15360
    ds_read_b128 v[44:47], v7 offset:15360
    s_waitcnt vmcnt(15)
    v_mfma_f32_32x32x16_bf16 v[128:143], v[52:55], v[16:19], v[128:143]
    v_mfma_f32_32x32x16_bf16 v[144:159], v[52:55], v[20:23], v[144:159]
    buffer_load_dwordx4 v[180:183], v1, s[4:7], s34 offen offset:1024 sc1
    s_waitcnt vmcnt(15) lgkmcnt(5)
    v_mfma_f32_32x32x16_bf16 v[96:111], v[56:59], v[24:27], v[96:111]
    s_waitcnt lgkmcnt(4)
    v_mfma_f32_32x32x16_bf16 v[112:127], v[56:59], v[28:31], v[112:127]
    buffer_load_dwordx4 v[184:187], v1, s[4:7], s34 offen offset:2048 sc1
    ds_read_b128 v[16:19], v12 offset:16384
    ds_read_b128 v[20:23], v2 offset:16384
    s_waitcnt vmcnt(15)
    v_mfma_f32_32x32x16_bf16 v[128:143], v[60:63], v[24:27], v[128:143]
    v_mfma_f32_32x32x16_bf16 v[144:159], v[60:63], v[28:31], v[144:159]
    buffer_load_dwordx4 v[188:191], v1, s[4:7], s34 offen offset:3072 sc1
    s_waitcnt vmcnt(15) lgkmcnt(5)
    v_mfma_f32_32x32x16_bf16 v[96:111], v[64:67], v[32:35], v[96:111]
    s_waitcnt lgkmcnt(4)
    v_mfma_f32_32x32x16_bf16 v[112:127], v[64:67], v[36:39], v[112:127]
    s_add_u32 s34, s17, 45056
    buffer_load_dwordx4 v[192:195], v1, s[4:7], s34 offen offset:0 sc1
    ds_read_b128 v[24:27], v13 offset:17408
    ds_read_b128 v[28:31], v3 offset:17408
    s_waitcnt vmcnt(15)
    v_mfma_f32_32x32x16_bf16 v[128:143], v[68:71], v[32:35], v[128:143]
    v_mfma_f32_32x32x16_bf16 v[144:159], v[68:71], v[36:39], v[144:159]
    buffer_load_dwordx4 v[196:199], v1, s[4:7], s34 offen offset:1024 sc1
    s_waitcnt vmcnt(15) lgkmcnt(5)
    v_mfma_f32_32x32x16_bf16 v[96:111], v[72:75], v[40:43], v[96:111]
    s_waitcnt lgkmcnt(4)
    v_mfma_f32_32x32x16_bf16 v[112:127], v[72:75], v[44:47], v[112:127]
    buffer_load_dwordx4 v[200:203], v1, s[4:7], s34 offen offset:2048 sc1
    ds_read_b128 v[32:35], v14 offset:18432
    ds_read_b128 v[36:39], v6 offset:18432
    s_waitcnt vmcnt(15)
    v_mfma_f32_32x32x16_bf16 v[128:143], v[76:79], v[40:43], v[128:143]
    v_mfma_f32_32x32x16_bf16 v[144:159], v[76:79], v[44:47], v[144:159]
    buffer_load_dwordx4 v[204:207], v1, s[4:7], s34 offen offset:3072 sc1
    s_waitcnt vmcnt(15) lgkmcnt(5)
    v_mfma_f32_32x32x16_bf16 v[96:111], v[80:83], v[16:19], v[96:111]
    s_waitcnt lgkmcnt(4)
    v_mfma_f32_32x32x16_bf16 v[112:127], v[80:83], v[20:23], v[112:127]
    s_add_u32 s34, s17, 49152
    buffer_load_dwordx4 v[208:211], v1, s[4:7], s34 offen offset:0 sc1
    ds_read_b128 v[40:43], v15 offset:19456
    ds_read_b128 v[44:47], v7 offset:19456
    s_waitcnt vmcnt(15)
    v_mfma_f32_32x32x16_bf16 v[128:143], v[84:87], v[16:19], v[128:143]
    v_mfma_f32_32x32x16_bf16 v[144:159], v[84:87], v[20:23], v[144:159]
    buffer_load_dwordx4 v[212:215], v1, s[4:7], s34 offen offset:1024 sc1
    s_waitcnt vmcnt(15) lgkmcnt(5)
    v_mfma_f32_32x32x16_bf16 v[96:111], v[88:91], v[24:27], v[96:111]
    s_waitcnt lgkmcnt(4)
    v_mfma_f32_32x32x16_bf16 v[112:127], v[88:91], v[28:31], v[112:127]
    buffer_load_dwordx4 v[216:219], v1, s[4:7], s34 offen offset:2048 sc1
    ds_read_b128 v[16:19], v12 offset:20480
    ds_read_b128 v[20:23], v2 offset:20480
    s_waitcnt vmcnt(15)
    v_mfma_f32_32x32x16_bf16 v[128:143], v[92:95], v[24:27], v[128:143]
    v_mfma_f32_32x32x16_bf16 v[144:159], v[92:95], v[28:31], v[144:159]
    buffer_load_dwordx4 v[220:223], v1, s[4:7], s34 offen offset:3072 sc1
    s_waitcnt vmcnt(15) lgkmcnt(5)
    v_mfma_f32_32x32x16_bf16 v[96:111], v[160:163], v[32:35], v[96:111]
    s_waitcnt lgkmcnt(4)
    v_mfma_f32_32x32x16_bf16 v[112:127], v[160:163], v[36:39], v[112:127]
    s_add_u32 s34, s17, 53248
    buffer_load_dwordx4 v[224:227], v1, s[4:7], s34 offen offset:0 sc1
    ds_read_b128 v[24:27], v13 offset:21504
    ds_read_b128 v[28:31], v3 offset:21504
    s_waitcnt vmcnt(15)
    v_mfma_f32_32x32x16_bf16 v[128:143], v[164:167], v[32:35], v[128:143]
    v_mfma_f32_32x32x16_bf16 v[144:159], v[164:167], v[36:39], v[144:159]
    buffer_load_dwordx4 v[228:231], v1, s[4:7], s34 offen offset:1024 sc1
    s_waitcnt vmcnt(15) lgkmcnt(5)
    v_mfma_f32_32x32x16_bf16 v[96:111], v[168:171], v[40:43], v[96:111]
    s_waitcnt lgkmcnt(4)
    v_mfma_f32_32x32x16_bf16 v[112:127], v[168:171], v[44:47], v[112:127]
    buffer_load_dwordx4 v[232:235], v1, s[4:7], s34 offen offset:2048 sc1
    ds_read_b128 v[32:35], v14 offset:22528
    ds_read_b128 v[36:39], v6 offset:22528
    s_waitcnt vmcnt(15)
    v_mfma_f32_32x32x16_bf16 v[128:143], v[172:175], v[40:43], v[128:143]
    v_mfma_f32_32x32x16_bf16 v[144:159], v[172:175], v[44:47], v[144:159]
    buffer_load_dwordx4 v[236:239], v1, s[4:7], s34 offen offset:3072 sc1
    s_waitcnt vmcnt(15) lgkmcnt(5)
    v_mfma_f32_32x32x16_bf16 v[96:111], v[176:179], v[16:19], v[96:111]
    s_waitcnt lgkmcnt(4)
    v_mfma_f32_32x32x16_bf16 v[112:127], v[176:179], v[20:23], v[112:127]
    s_add_u32 s34, s17, 57344
    buffer_load_dwordx4 v[240:243], v1, s[4:7], s34 offen offset:0 sc1
    ds_read_b128 v[40:43], v15 offset:23552
    ds_read_b128 v[44:47], v7 offset:23552
    s_waitcnt vmcnt(15)
    v_mfma_f32_32x32x16_bf16 v[128:143], v[180:183], v[16:19], v[128:143]
    v_mfma_f32_32x32x16_bf16 v[144:159], v[180:183], v[20:23], v[144:159]
    buffer_load_dwordx4 v[244:247], v1, s[4:7], s34 offen offset:1024 sc1
    s_waitcnt vmcnt(15) lgkmcnt(5)
    v_mfma_f32_32x32x16_bf16 v[96:111], v[184:187], v[24:27], v[96:111]
    s_waitcnt lgkmcnt(4)
    v_mfma_f32_32x32x16_bf16 v[112:127], v[184:187], v[28:31], v[112:127]
    buffer_load_dwordx4 v[248:251], v1, s[4:7], s34 offen offset:2048 sc1
    ds_read_b128 v[16:19], v12 offset:24576
    ds_read_b128 v[20:23], v2 offset:24576
    s_waitcnt vmcnt(15)
    v_mfma_f32_32x32x16_bf16 v[128:143], v[188:191], v[24:27], v[128:143]
    v_mfma_f32_32x32x16_bf16 v[144:159], v[188:191], v[28:31], v[144:159]
    buffer_load_dwordx4 v[252:255], v1, s[4:7], s34 offen offset:3072 sc1
    s_waitcnt vmcnt(15) lgkmcnt(5)
    v_mfma_f32_32x32x16_bf16 v[96:111], v[192:195], v[32:35], v[96:111]
    s_waitcnt lgkmcnt(4)
    v_mfma_f32_32x32x16_bf16 v[112:127], v[192:195], v[36:39], v[112:127]
    s_add_u32 s34, s17, 61440
    buffer_load_dwordx4 v[48:51], v1, s[4:7], s34 offen offset:0 sc1
    ds_read_b128 v[24:27], v13 offset:25600
    ds_read_b128 v[28:31], v3 offset:25600
    s_waitcnt vmcnt(15)
    v_mfma_f32_32x32x16_bf16 v[128:143], v[196:199], v[32:35], v[128:143]
    v_mfma_f32_32x32x16_bf16 v[144:159], v[196:199], v[36:39], v[144:159]
    buffer_load_dwordx4 v[52:55], v1, s[4:7], s34 offen offset:1024 sc1
    s_waitcnt vmcnt(15) lgkmcnt(5)
    v_mfma_f32_32x32x16_bf16 v[96:111], v[200:203], v[40:43], v[96:111]
    s_waitcnt lgkmcnt(4)
    v_mfma_f32_32x32x16_bf16 v[112:127], v[200:203], v[44:47], v[112:127]
    buffer_load_dwordx4 v[56:59], v1, s[4:7], s34 offen offset:2048 sc1
    ds_read_b128 v[32:35], v14 offset:26624
    ds_read_b128 v[36:39], v6 offset:26624
    s_waitcnt vmcnt(15)
    v_mfma_f32_32x32x16_bf16 v[128:143], v[204:207], v[40:43], v[128:143]
    v_mfma_f32_32x32x16_bf16 v[144:159], v[204:207], v[44:47], v[144:159]
    buffer_load_dwordx4 v[60:63], v1, s[4:7], s34 offen offset:3072 sc1
    s_add_u32 m0, s21, 0
    s_add_u32 s24, s19, s21
    buffer_load_dwordx4 v1, s[4:7], s24 offen offset:0 sc1 lds
    s_waitcnt vmcnt(16) lgkmcnt(5)
    v_mfma_f32_32x32x16_bf16 v[96:111], v[208:211], v[16:19], v[96:111]
    s_waitcnt lgkmcnt(4)
    v_mfma_f32_32x32x16_bf16 v[112:127], v[208:211], v[20:23], v[112:127]
    ds_read_b128 v[40:43], v15 offset:27648
    ds_read_b128 v[44:47], v7 offset:27648
    buffer_load_dwordx4 v1, s[4:7], s24 offen offset:1024 sc1 lds
    s_waitcnt vmcnt(16)
    v_mfma_f32_32x32x16_bf16 v[128:143], v[212:215], v[16:19], v[128:143]
    v_mfma_f32_32x32x16_bf16 v[144:159], v[212:215], v[20:23], v[144:159]
    buffer_load_dwordx4 v1, s[4:7], s24 offen offset:2048 sc1 lds
    s_waitcnt vmcnt(16) lgkmcnt(5)
    v_mfma_f32_32x32x16_bf16 v[96:111], v[216:219], v[24:27], v[96:111]
    s_waitcnt lgkmcnt(4)
    v_mfma_f32_32x32x16_bf16 v[112:127], v[216:219], v[28:31], v[112:127]
    ds_read_b128 v[16:19], v12 offset:28672
    ds_read_b128 v[20:23], v2 offset:28672
    buffer_load_dwordx4 v1, s[4:7], s24 offen offset:3072 sc1 lds
    s_waitcnt vmcnt(16)
    v_mfma_f32_32x32x16_bf16 v[128:143], v[220:223], v[24:27], v[128:143]
    v_mfma_f32_32x32x16_bf16 v[144:159], v[220:223], v[28:31], v[144:159]
    s_add_u32 m0, s22, 131072
    s_add_u32 s24, s20, s22
    buffer_load_dwordx4 v1, s[4:7], s24 offen offset:0 sc1 lds
    s_waitcnt vmcnt(16) lgkmcnt(5)
    v_mfma_f32_32x32x16_bf16 v[96:111], v[224:227], v[32:35], v[96:111]
    s_waitcnt lgkmcnt(4)
    v_mfma_f32_32x32x16_bf16 v[112:127], v[224:227], v[36:39], v[112:127]
    ds_read_b128 v[24:27], v13 offset:29696
    ds_read_b128 v[28:31], v3 offset:29696
    s_waitcnt vmcnt(15)
    v_mfma_f32_32x32x16_bf16 v[128:143], v[228:231], v[32:35], v[128:143]
    v_mfma_f32_32x32x16_bf16 v[144:159], v[228:231], v[36:39], v[144:159]
    s_waitcnt vmcnt(14) lgkmcnt(5)
    v_mfma_f32_32x32x16_bf16 v[96:111], v[232:235], v[40:43], v[96:111]
    s_waitcnt lgkmcnt(4)
    v_mfma_f32_32x32x16_bf16 v[112:127], v[232:235], v[44:47], v[112:127]
    ds_read_b128 v[32:35], v14 offset:30720
    ds_read_b128 v[36:39], v6 offset:30720
    s_waitcnt vmcnt(13)
    v_mfma_f32_32x32x16_bf16 v[128:143], v[236:239], v[40:43], v[128:143]
    v_mfma_f32_32x32x16_bf16 v[144:159], v[236:239], v[44:47], v[144:159]
    s_waitcnt vmcnt(12) lgkmcnt(5)
    v_mfma_f32_32x32x16_bf16 v[96:111], v[240:243], v[16:19], v[96:111]
    s_waitcnt lgkmcnt(4)
    v_mfma_f32_32x32x16_bf16 v[112:127], v[240:243], v[20:23], v[112:127]
    ds_read_b128 v[40:43], v15 offset:31744
    ds_read_b128 v[44:47], v7 offset:31744
    s_waitcnt vmcnt(11)
    v_mfma_f32_32x32x16_bf16 v[128:143], v[244:247], v[16:19], v[128:143]
    v_mfma_f32_32x32x16_bf16 v[144:159], v[244:247], v[20:23], v[144:159]
    s_waitcnt vmcnt(10) lgkmcnt(5)
    v_mfma_f32_32x32x16_bf16 v[96:111], v[248:251], v[24:27], v[96:111]
    s_waitcnt lgkmcnt(4)
    v_mfma_f32_32x32x16_bf16 v[112:127], v[248:251], v[28:31], v[112:127]
    s_waitcnt vmcnt(9)
    v_mfma_f32_32x32x16_bf16 v[128:143], v[252:255], v[24:27], v[128:143]
    v_mfma_f32_32x32x16_bf16 v[144:159], v[252:255], v[28:31], v[144:159]
    s_waitcnt vmcnt(8) lgkmcnt(3)
    v_mfma_f32_32x32x16_bf16 v[96:111], v[48:51], v[32:35], v[96:111]
    s_waitcnt lgkmcnt(2)
    v_mfma_f32_32x32x16_bf16 v[112:127], v[48:51], v[36:39], v[112:127]
    s_waitcnt vmcnt(7)
    v_mfma_f32_32x32x16_bf16 v[128:143], v[52:55], v[32:35], v[128:143]
    v_mfma_f32_32x32x16_bf16 v[144:159], v[52:55], v[36:39], v[144:159]
    s_waitcnt vmcnt(6) lgkmcnt(1)
    v_mfma_f32_32x32x16_bf16 v[96:111], v[56:59], v[40:43], v[96:111]
    s_waitcnt lgkmcnt(0)
    v_mfma_f32_32x32x16_bf16 v[112:127], v[56:59], v[44:47], v[112:127]
    s_waitcnt vmcnt(5)
    v_mfma_f32_32x32x16_bf16 v[128:143], v[60:63], v[40:43], v[128:143]
    v_mfma_f32_32x32x16_bf16 v[144:159], v[60:63], v[44:47], v[144:159]
    s_lshl_b32 s26, s25, 12
    s_sub_u32 s27, 4096, s26
    v_add_u32 v2, s26, v1
    v_add_u32 v3, s27, v1
    v_add_u32 v4, 0x10000, v1
    v_add_u32 v5, 0x20000, v1
    v_add_u32 v9, s21, v4
    s_xor_b32 s26, s21, 4096
    v_add_u32 v10, s26, v4
    v_cvt_pk_bf16_f32 v16, v112, v113
    v_cvt_pk_bf16_f32 v17, v114, v115
    v_cvt_pk_bf16_f32 v18, v116, v117
    v_cvt_pk_bf16_f32 v19, v118, v119
    ds_write_b128 v9, v[16:19] offset:32768
    v_cvt_pk_bf16_f32 v20, v120, v121
    v_cvt_pk_bf16_f32 v21, v122, v123
    v_cvt_pk_bf16_f32 v22, v124, v125
    v_cvt_pk_bf16_f32 v23, v126, v127
    ds_write_b128 v9, v[20:23] offset:33792
    v_cvt_pk_bf16_f32 v24, v144, v145
    v_cvt_pk_bf16_f32 v25, v146, v147
    v_cvt_pk_bf16_f32 v26, v148, v149
    v_cvt_pk_bf16_f32 v27, v150, v151
    ds_write_b128 v9, v[24:27] offset:34816
    v_cvt_pk_bf16_f32 v28, v152, v153
    v_cvt_pk_bf16_f32 v29, v154, v155
    v_cvt_pk_bf16_f32 v30, v156, v157
    v_cvt_pk_bf16_f32 v31, v158, v159
    ds_write_b128 v9, v[28:31] offset:35840
    v_cvt_pk_bf16_f32 v64, v96, v97
    v_cvt_pk_bf16_f32 v65, v98, v99
    v_cvt_pk_bf16_f32 v66, v100, v101
    v_cvt_pk_bf16_f32 v67, v102, v103
    v_cvt_pk_bf16_f32 v68, v104, v105
    v_cvt_pk_bf16_f32 v69, v106, v107
    v_cvt_pk_bf16_f32 v70, v108, v109
    v_cvt_pk_bf16_f32 v71, v110, v111
    v_cvt_pk_bf16_f32 v72, v128, v129
    v_cvt_pk_bf16_f32 v73, v130, v131
    v_cvt_pk_bf16_f32 v74, v132, v133
    v_cvt_pk_bf16_f32 v75, v134, v135
    v_cvt_pk_bf16_f32 v76, v136, v137
    v_cvt_pk_bf16_f32 v77, v138, v139
    v_cvt_pk_bf16_f32 v78, v140, v141
    v_cvt_pk_bf16_f32 v79, v142, v143
    s_waitcnt vmcnt(0)
    s_waitcnt lgkmcnt(0)
    s_barrier
    ds_read_b128 v[80:83], v10 offset:32768
    ds_read_b128 v[84:87], v10 offset:33792
    ds_read_b128 v[88:91], v10 offset:34816
    ds_read_b128 v[92:95], v10 offset:35840
    s_mov_b32 s30, 0x42a00000
    s_mov_b32 s31, 0x42800000
    ds_read_b128 v[16:19], v2 offset:0
    ds_read_b128 v[20:23], v2 offset:1024
    ds_read_b128 v[24:27], v2 offset:2048
    ds_read_b128 v[28:31], v2 offset:3072
    ds_read_b128 v[32:35], v3 offset:0
    ds_read_b128 v[36:39], v3 offset:1024
    s_waitcnt lgkmcnt(5)
    v_mfma_f32_32x32x16_bf16 v[160:175], v[16:19], v[64:67], 0
    ds_read_b128 v[40:43], v3 offset:2048
    v_mov_b32 v224, -1
    v_mov_b32 v225, -1
    v_mov_b32 v226, -1
    v_mov_b32 v227, -1
    s_waitcnt lgkmcnt(5)
    v_mfma_f32_32x32x16_bf16 v[160:175], v[20:23], v[68:71], v[160:175]
    ds_read_b128 v[44:47], v3 offset:3072
    s_and_b32 s35, s2, 1
    s_lshl_b32 s35, s35, 2
    s_bfe_u32 s34, s2, 0x20003
    s_add_u32 s35, s35, s34
    s_mul_i32 s3, s35, 7
    s_and_b32 s34, s12, 3
    s_lshl_b32 s34, s34, 1
    s_add_u32 s3, s3, s34
    s_lshl_b32 s3, s3, 9
    s_bfe_u32 s35, s2, 0x20001
    s_lshl_b32 s35, s35, 3
    s_lshr_b32 s34, s2, 5
    s_add_u32 s35, s35, s34
    s_lshl_b32 s35, s35, 1
    s_lshr_b32 s34, s12, 2
    s_add_u32 s35, s35, s34
    s_mul_i32 s35, s35, 57344
    s_add_u32 s35, s35, s3
    s_add_u32 s35, s35, 46137344
    v_bfe_u32 v11, v1, 8, 1
    v_mul_u32_u24 v11, 28672, v11
    v_lshrrev_b32 v10, 9, v1
    v_lshl_add_u32 v11, v10, 8, v11
    v_and_b32 v10, 0xf0, v1
    v_add_u32 v11, v11, v10
    buffer_store_dwordx4 v[224:227], v11, s[4:7], s35 offen sc1
    s_and_b32 s34, s12, 3
    s_cmp_eq_u32 s34, 3
    s_cselect_b32 s35, 268435456, s35
    buffer_store_dwordx4 v[224:227], v11, s[4:7], s35 offen offset:512 sc1
    s_waitcnt lgkmcnt(5)
    v_mfma_f32_32x32x16_bf16 v[160:175], v[24:27], v[72:75], v[160:175]
    ds_read_b128 v[16:19], v2 offset:8192
    s_waitcnt lgkmcnt(5)
    v_mfma_f32_32x32x16_bf16 v[160:175], v[28:31], v[76:79], v[160:175]
    ds_read_b128 v[20:23], v2 offset:9216
    s_add_u32 m0, s21, 32768
    s_add_u32 s24, s19, s21
    s_add_u32 s24, s24, 32768
    buffer_load_dwordx4 v1, s[4:7], s24 offen offset:0 sc1 lds
    s_waitcnt lgkmcnt(5)
    v_mfma_f32_32x32x16_bf16 v[160:175], v[32:35], v[80:83], v[160:175]
    ds_read_b128 v[24:27], v2 offset:10240
    buffer_load_dwordx4 v1, s[4:7], s24 offen offset:1024 sc1 lds
    s_waitcnt lgkmcnt(5)
    v_mfma_f32_32x32x16_bf16 v[160:175], v[36:39], v[84:87], v[160:175]
    ds_read_b128 v[28:31], v2 offset:11264
    s_waitcnt lgkmcnt(5)
    v_mfma_f32_32x32x16_bf16 v[160:175], v[40:43], v[88:91], v[160:175]
    ds_read_b128 v[32:35], v3 offset:8192
    buffer_load_dwordx4 v1, s[4:7], s24 offen offset:2048 sc1 lds
    s_waitcnt lgkmcnt(5)
    v_mfma_f32_32x32x16_bf16 v[160:175], v[44:47], v[92:95], v[160:175]
    ds_read_b128 v[36:39], v3 offset:9216
    s_waitcnt lgkmcnt(5)
    v_mfma_f32_32x32x16_bf16 v[176:191], v[16:19], v[64:67], 0
    ds_read_b128 v[40:43], v3 offset:10240
    buffer_load_dwordx4 v1, s[4:7], s24 offen offset:3072 sc1 lds
    s_waitcnt lgkmcnt(5)
    v_mfma_f32_32x32x16_bf16 v[176:191], v[20:23], v[68:71], v[176:191]
    ds_read_b128 v[44:47], v3 offset:11264
    s_waitcnt lgkmcnt(5)
    v_mfma_f32_32x32x16_bf16 v[176:191], v[24:27], v[72:75], v[176:191]
    ds_read_b128 v[16:19], v2 offset:16384
    s_nop 0
    v_max3_f32 v8, v160, v161, v162
    v_max3_f32 v8, v8, v163, v164
    v_max3_f32 v8, v8, v165, v166
    v_max3_f32 v8, v8, v167, v168
    v_max3_f32 v8, v8, v169, v170
    s_add_u32 m0, s21, 65536
    s_add_u32 s24, s20, s21
    s_add_u32 s24, s24, 8192
    buffer_load_dwordx4 v1, s[4:7], s24 offen offset:0 sc1 lds
    s_waitcnt lgkmcnt(5)
    v_mfma_f32_32x32x16_bf16 v[176:191], v[28:31], v[76:79], v[176:191]
    ds_read_b128 v[20:23], v2 offset:17408
    v_max3_f32 v8, v8, v171, v172
    v_max3_f32 v8, v8, v173, v174
    v_max_f32 v8, v8, v175
    v_mov_b32 v9, v8
    s_nop 1
    v_permlane32_swap_b32 v8, v9
    s_waitcnt lgkmcnt(5)
    v_mfma_f32_32x32x16_bf16 v[176:191], v[32:35], v[80:83], v[176:191]
    ds_read_b128 v[24:27], v2 offset:18432
    v_max_f32 v8, v8, v9
    v_add_f32 v8, s31, v8
    v_ceil_f32 v8, v8
    v_sub_f32 v48, 0, v8
    v_mov_b32 v49, v48
    buffer_load_dwordx4 v1, s[4:7], s24 offen offset:1024 sc1 lds
    s_waitcnt lgkmcnt(5)
    v_mfma_f32_32x32x16_bf16 v[176:191], v[36:39], v[84:87], v[176:191]
    ds_read_b128 v[28:31], v2 offset:19456
    v_mov_b32 v50, v48
    v_mov_b32 v51, v48
    v_mov_b32 v52, v48
    v_mov_b32 v53, v48
    v_mov_b32 v54, v48
    s_waitcnt lgkmcnt(5)
    v_mfma_f32_32x32x16_bf16 v[176:191], v[40:43], v[88:91], v[176:191]
    ds_read_b128 v[32:35], v3 offset:16384
    v_mov_b32 v55, v48
    v_mov_b32 v56, v48
    v_mov_b32 v57, v48
    v_mov_b32 v58, v48
    v_mov_b32 v59, v48
    buffer_load_dwordx4 v1, s[4:7], s24 offen offset:2048 sc1 lds
    s_waitcnt lgkmcnt(5)
    v_mfma_f32_32x32x16_bf16 v[176:191], v[44:47], v[92:95], v[176:191]
    ds_read_b128 v[36:39], v3 offset:17408
    v_mov_b32 v60, v48
    v_mov_b32 v61, v48
    v_mov_b32 v62, v48
    v_mov_b32 v63, v48
    s_waitcnt lgkmcnt(5)
    s_nop 0
    v_mfma_f32_32x32x16_bf16 v[192:207], v[16:19], v[64:67], v[48:63]
    ds_read_b128 v[40:43], v3 offset:18432
    v_add_f32 v160, v160, v48
    v_add_f32 v161, v161, v48
    v_add_f32 v162, v162, v48
    v_add_f32 v163, v163, v48
    v_add_f32 v164, v164, v48
    v_add_f32 v165, v165, v48
    v_add_f32 v166, v166, v48
    v_add_f32 v167, v167, v48
    v_add_f32 v168, v168, v48
    v_add_f32 v169, v169, v48
    v_add_f32 v170, v170, v48
    buffer_load_dwordx4 v1, s[4:7], s24 offen offset:3072 sc1 lds
    s_waitcnt lgkmcnt(5)
    v_mfma_f32_32x32x16_bf16 v[192:207], v[20:23], v[68:71], v[192:207]
    ds_read_b128 v[44:47], v3 offset:19456
    v_add_f32 v171, v171, v48
    v_add_f32 v172, v172, v48
    v_add_f32 v173, v173, v48
    v_add_f32 v174, v174, v48
    v_add_f32 v175, v175, v48
    v_exp_f32 v160, v160
    v_exp_f32 v161, v161
    v_exp_f32 v162, v162
    v_exp_f32 v163, v163
    v_exp_f32 v164, v164
    s_waitcnt lgkmcnt(5)
    v_mfma_f32_32x32x16_bf16 v[192:207], v[24:27], v[72:75], v[192:207]
    ds_read_b128 v[16:19], v2 offset:24576
    v_exp_f32 v165, v165
    v_exp_f32 v166, v166
    v_exp_f32 v167, v167
    v_exp_f32 v168, v168
    v_mov_b32 v7, v160
    v_exp_f32 v169, v169
    v_mov_b32 v6, v161
    v_exp_f32 v170, v170
    v_add_f32 v7, v7, v162
    v_exp_f32 v171, v171
    v_add_f32 v6, v6, v163
    s_add_u32 m0, s23, 139264
    s_add_u32 s24, s20, s23
    s_add_u32 s24, s24, 106496
    buffer_load_dwordx4 v1, s[4:7], s24 offen offset:0 sc1 lds
    s_waitcnt lgkmcnt(5)
    v_mfma_f32_32x32x16_bf16 v[192:207], v[28:31], v[76:79], v[192:207]
    ds_read_b128 v[20:23], v5 offset:0
    v_exp_f32 v172, v172
    v_add_f32 v7, v7, v164
    v_exp_f32 v173, v173
    v_add_f32 v6, v6, v165
    v_exp_f32 v174, v174
    v_add_f32 v7, v7, v166
    v_exp_f32 v175, v175
    v_add_f32 v6, v6, v167
    v_cvt_pk_bf16_f32 v160, v160, v161
    v_cvt_pk_bf16_f32 v161, v162, v163
    s_waitcnt lgkmcnt(5)
    v_mfma_f32_32x32x16_bf16 v[192:207], v[32:35], v[80:83], v[192:207]
    ds_read_b128 v[24:27], v2 offset:25600
    v_cvt_pk_bf16_f32 v162, v164, v165
    v_cvt_pk_bf16_f32 v163, v166, v167
    v_add_f32 v7, v7, v168
    v_add_f32 v6, v6, v169
    v_add_f32 v7, v7, v170
    v_add_f32 v6, v6, v171
    v_add_f32 v7, v7, v172
    v_add_f32 v6, v6, v173
    v_add_f32 v7, v7, v174
    v_add_f32 v6, v6, v175
    buffer_load_dwordx4 v1, s[4:7], s24 offen offset:1024 sc1 lds
    s_waitcnt lgkmcnt(5)
    v_mfma_f32_32x32x16_bf16 v[192:207], v[36:39], v[84:87], v[192:207]
    ds_read_b128 v[28:31], v5 offset:1024
    v_cvt_pk_bf16_f32 v164, v168, v169
    v_cvt_pk_bf16_f32 v165, v170, v171
    v_cvt_pk_bf16_f32 v166, v172, v173
    v_cvt_pk_bf16_f32 v167, v174, v175
    v_add_f32 v176, v176, v48
    v_add_f32 v177, v177, v48
    v_add_f32 v178, v178, v48
    v_add_f32 v179, v179, v48
    v_add_f32 v180, v180, v48
    v_add_f32 v181, v181, v48
    v_add_f32 v182, v182, v48
    s_waitcnt lgkmcnt(5)
    v_mfma_f32_32x32x16_bf16 v[192:207], v[40:43], v[88:91], v[192:207]
    ds_read_b128 v[32:35], v2 offset:26624
    v_add_f32 v183, v183, v48
    v_add_f32 v184, v184, v48
    v_add_f32 v185, v185, v48
    v_add_f32 v186, v186, v48
    v_add_f32 v187, v187, v48
    v_add_f32 v188, v188, v48
    v_add_f32 v189, v189, v48
    v_add_f32 v190, v190, v48
    v_add_f32 v191, v191, v48
    v_max3_f32 v8, v176, v177, v178
    buffer_load_dwordx4 v1, s[4:7], s24 offen offset:2048 sc1 lds
    s_waitcnt lgkmcnt(5)
    v_mfma_f32_32x32x16_bf16 v[192:207], v[44:47], v[92:95], v[192:207]
    ds_read_b128 v[36:39], v5 offset:2048
    v_max3_f32 v8, v8, v179, v180
    v_max3_f32 v8, v8, v181, v182
    v_max3_f32 v8, v8, v183, v184
    v_max3_f32 v8, v8, v185, v186
    v_max3_f32 v8, v8, v187, v188
    v_max3_f32 v8, v8, v189, v190
    v_max_f32 v8, v8, v191
    v_cmp_lt_f32 vcc, s30, v8
    s_nop 0
    s_cbranch_vccnz L_fix1
L_ret1:
    s_waitcnt lgkmcnt(5)
    v_mfma_f32_32x32x16_bf16 v[208:223], v[16:19], v[64:67], v[48:63]
    ds_read_b128 v[40:43], v2 offset:27648
    v_exp_f32 v176, v176
    v_exp_f32 v177, v177
    v_exp_f32 v178, v178
    v_exp_f32 v179, v179
    s_waitcnt lgkmcnt(5)
    v_mfma_f32_32x32x16_bf16 v[96:111], v[20:23], v[160:163], 0
    ds_read_b128 v[44:47], v5 offset:3072
    v_exp_f32 v180, v180
    v_exp_f32 v181, v181
    v_exp_f32 v182, v182
    s_waitcnt lgkmcnt(5)
    v_mfma_f32_32x32x16_bf16 v[208:223], v[24:27], v[68:71], v[208:223]
    ds_read_b128 v[16:19], v3 offset:24576
    v_exp_f32 v183, v183
    v_exp_f32 v184, v184
    v_add_f32 v7, v7, v176
    s_waitcnt lgkmcnt(5)
    v_mfma_f32_32x32x16_bf16 v[112:127], v[28:31], v[160:163], 0
    ds_read_b128 v[20:23], v5 offset:4096
    v_exp_f32 v185, v185
    v_add_f32 v6, v6, v177
    v_exp_f32 v186, v186
    s_waitcnt lgkmcnt(5)
    v_mfma_f32_32x32x16_bf16 v[208:223], v[32:35], v[72:75], v[208:223]
    ds_read_b128 v[24:27], v3 offset:25600
    v_add_f32 v7, v7, v178
    v_exp_f32 v187, v187
    v_add_f32 v6, v6, v179
    s_waitcnt lgkmcnt(5)
    v_mfma_f32_32x32x16_bf16 v[128:143], v[36:39], v[160:163], 0
    ds_read_b128 v[28:31], v5 offset:5120
    v_exp_f32 v188, v188
    v_add_f32 v7, v7, v180
    v_exp_f32 v189, v189
    v_add_f32 v6, v6, v181
    s_waitcnt lgkmcnt(5)
    v_mfma_f32_32x32x16_bf16 v[208:223], v[40:43], v[76:79], v[208:223]
    ds_read_b128 v[32:35], v3 offset:26624
    v_exp_f32 v190, v190
    v_add_f32 v7, v7, v182
    v_exp_f32 v191, v191
    s_waitcnt lgkmcnt(5)
    v_mfma_f32_32x32x16_bf16 v[144:159], v[44:47], v[160:163], 0
    ds_read_b128 v[36:39], v5 offset:6144
    v_add_f32 v6, v6, v183
    v_cvt_pk_bf16_f32 v176, v176, v177
    v_cvt_pk_bf16_f32 v177, v178, v179
    s_waitcnt lgkmcnt(5)
    v_mfma_f32_32x32x16_bf16 v[208:223], v[16:19], v[80:83], v[208:223]
    ds_read_b128 v[40:43], v3 offset:27648
    v_cvt_pk_bf16_f32 v178, v180, v181
    v_cvt_pk_bf16_f32 v179, v182, v183
    v_add_f32 v7, v7, v184
    s_waitcnt lgkmcnt(5)
    v_mfma_f32_32x32x16_bf16 v[96:111], v[20:23], v[164:167], v[96:111]
    ds_read_b128 v[44:47], v5 offset:7168
    v_add_f32 v6, v6, v185
    v_add_f32 v7, v7, v186
    v_add_f32 v6, v6, v187
    s_waitcnt lgkmcnt(5)
    v_mfma_f32_32x32x16_bf16 v[208:223], v[24:27], v[84:87], v[208:223]
    v_add_f32 v7, v7, v188
    v_add_f32 v6, v6, v189
    v_add_f32 v7, v7, v190
    v_add_f32 v6, v6, v191
    s_waitcnt lgkmcnt(4)
    v_mfma_f32_32x32x16_bf16 v[112:127], v[28:31], v[164:167], v[112:127]
    v_cvt_pk_bf16_f32 v180, v184, v185
    v_cvt_pk_bf16_f32 v181, v186, v187
    v_cvt_pk_bf16_f32 v182, v188, v189
    s_waitcnt lgkmcnt(3)
    v_mfma_f32_32x32x16_bf16 v[208:223], v[32:35], v[88:91], v[208:223]
    s_waitcnt vmcnt(0)
    s_waitcnt lgkmcnt(0)
    s_barrier
    s_lshl_b32 s35, s2, 2
    s_add_u32 s35, s35, 51446784
    s_cmp_eq_u32 s12, 7
    s_cselect_b32 s35, s35, 268435456
    v_lshlrev_b32 v11, 7, v1
    v_lshlrev_b32 v10, 19, v1
    v_and_b32 v10, 0x10000000, v10
    v_or_b32 v11, v11, v10
    v_mov_b32 v10, s51
    buffer_store_dword v10, v11, s[4:7], s35 offen sc1
    ds_read_b128 v[16:19], v2 offset:32768
    ds_read_b128 v[20:23], v4 offset:0
    ds_read_b128 v[24:27], v2 offset:33792
    v_cvt_pk_bf16_f32 v183, v190, v191
    v_max3_f32 v8, v192, v193, v194
    v_max3_f32 v8, v8, v195, v196
    s_add_u32 m0, s21, 0
    s_add_u32 s24, s19, s21
    s_add_u32 s24, s24, 65536
    buffer_load_dwordx4 v1, s[4:7], s24 offen offset:0 sc1 lds
    s_lshl_b32 s35, s2, 15
    s_add_u32 s35, s35, 0
    s_cmp_eq_u32 s12, 0
    s_cselect_b32 s35, s35, 8388608
    v_lshlrev_b32 v11, 3, v1
    buffer_load_dword v0, v11, s[36:39], s35 offen
    v_mfma_f32_32x32x16_bf16 v[128:143], v[36:39], v[164:167], v[128:143]
    ds_read_b128 v[28:31], v4 offset:1024
    v_max3_f32 v8, v8, v197, v198
    v_max3_f32 v8, v8, v199, v200
    v_max3_f32 v8, v8, v201, v202
    v_mfma_f32_32x32x16_bf16 v[208:223], v[40:43], v[92:95], v[208:223]
    ds_read_b128 v[32:35], v2 offset:34816
    v_max3_f32 v8, v8, v203, v204
    v_max3_f32 v8, v8, v205, v206
    v_max_f32 v8, v8, v207
    v_mfma_f32_32x32x16_bf16 v[144:159], v[44:47], v[164:167], v[144:159]
    ds_read_b128 v[36:39], v4 offset:2048
    v_cmp_lt_f32 vcc, s30, v8
    s_nop 0
    s_cbranch_vccnz L_fix2
L_ret2:
    s_waitcnt lgkmcnt(5)
    v_mfma_f32_32x32x16_bf16 v[160:175], v[16:19], v[64:67], v[48:63]
    ds_read_b128 v[40:43], v2 offset:35840
    v_exp_f32 v192, v192
    v_exp_f32 v193, v193
    v_exp_f32 v194, v194
    v_exp_f32 v195, v195
    s_waitcnt lgkmcnt(5)
    v_mfma_f32_32x32x16_bf16 v[96:111], v[20:23], v[176:179], v[96:111]
    ds_read_b128 v[44:47], v4 offset:3072
    v_exp_f32 v196, v196
    v_exp_f32 v197, v197
    v_exp_f32 v198, v198
    buffer_load_dwordx4 v1, s[4:7], s24 offen offset:1024 sc1 lds
    s_waitcnt lgkmcnt(5)
    v_mfma_f32_32x32x16_bf16 v[160:175], v[24:27], v[68:71], v[160:175]
    ds_read_b128 v[16:19], v3 offset:32768
    v_exp_f32 v199, v199
    v_exp_f32 v200, v200
    v_add_f32 v7, v7, v192
    s_waitcnt lgkmcnt(5)
    v_mfma_f32_32x32x16_bf16 v[112:127], v[28:31], v[176:179], v[112:127]
    ds_read_b128 v[20:23], v4 offset:4096
    v_exp_f32 v201, v201
    v_add_f32 v6, v6, v193
    v_exp_f32 v202, v202
    s_waitcnt lgkmcnt(5)
    v_mfma_f32_32x32x16_bf16 v[160:175], v[32:35], v[72:75], v[160:175]
    ds_read_b128 v[24:27], v3 offset:33792
    v_add_f32 v7, v7, v194
    v_exp_f32 v203, v203
    v_add_f32 v6, v6, v195
    s_waitcnt lgkmcnt(5)
    v_mfma_f32_32x32x16_bf16 v[128:143], v[36:39], v[176:179], v[128:143]
    ds_read_b128 v[28:31], v4 offset:5120
    v_exp_f32 v204, v204
    v_add_f32 v7, v7, v196
    v_exp_f32 v205, v205
    v_add_f32 v6, v6, v197
    s_waitcnt lgkmcnt(5)
    v_mfma_f32_32x32x16_bf16 v[160:175], v[40:43], v[76:79], v[160:175]
    ds_read_b128 v[32:35], v3 offset:34816
    v_exp_f32 v206, v206
    v_add_f32 v7, v7, v198
    v_exp_f32 v207, v207
    buffer_load_dwordx4 v1, s[4:7], s24 offen offset:2048 sc1 lds
    s_waitcnt lgkmcnt(5)
    v_mfma_f32_32x32x16_bf16 v[144:159], v[44:47], v[176:179], v[144:159]
    ds_read_b128 v[36:39], v4 offset:6144
    v_add_f32 v6, v6, v199
    v_cvt_pk_bf16_f32 v192, v192, v193
    v_cvt_pk_bf16_f32 v193, v194, v195
    s_waitcnt lgkmcnt(5)
    v_mfma_f32_32x32x16_bf16 v[160:175], v[16:19], v[80:83], v[160:175]
    ds_read_b128 v[40:43], v3 offset:35840
    v_cvt_pk_bf16_f32 v194, v196, v197
    v_cvt_pk_bf16_f32 v195, v198, v199
    v_add_f32 v7, v7, v200
    s_waitcnt lgkmcnt(5)
    v_mfma_f32_32x32x16_bf16 v[96:111], v[20:23], v[180:183], v[96:111]
    ds_read_b128 v[44:47], v4 offset:7168
    v_add_f32 v6, v6, v201
    v_add_f32 v7, v7, v202
    v_add_f32 v6, v6, v203
    s_waitcnt lgkmcnt(5)
    v_mfma_f32_32x32x16_bf16 v[160:175], v[24:27], v[84:87], v[160:175]
    ds_read_b128 v[16:19], v2 offset:40960
    v_add_f32 v7, v7, v204
    v_add_f32 v6, v6, v205
    v_add_f32 v7, v7, v206
    v_add_f32 v6, v6, v207
    s_waitcnt lgkmcnt(5)
    v_mfma_f32_32x32x16_bf16 v[112:127], v[28:31], v[180:183], v[112:127]
    ds_read_b128 v[20:23], v4 offset:8192
    v_cvt_pk_bf16_f32 v196, v200, v201
    v_cvt_pk_bf16_f32 v197, v202, v203
    v_cvt_pk_bf16_f32 v198, v204, v205
    buffer_load_dwordx4 v1, s[4:7], s24 offen offset:3072 sc1 lds
    s_waitcnt lgkmcnt(5)
    v_mfma_f32_32x32x16_bf16 v[160:175], v[32:35], v[88:91], v[160:175]
    ds_read_b128 v[24:27], v2 offset:41984
    v_cvt_pk_bf16_f32 v199, v206, v207
    v_max3_f32 v8, v208, v209, v210
    v_max3_f32 v8, v8, v211, v212
    s_waitcnt lgkmcnt(5)
    v_mfma_f32_32x32x16_bf16 v[128:143], v[36:39], v[180:183], v[128:143]
    ds_read_b128 v[28:31], v4 offset:9216
    v_max3_f32 v8, v8, v213, v214
    v_max3_f32 v8, v8, v215, v216
    v_max3_f32 v8, v8, v217, v218
    s_waitcnt lgkmcnt(5)
    v_mfma_f32_32x32x16_bf16 v[160:175], v[40:43], v[92:95], v[160:175]
    ds_read_b128 v[32:35], v2 offset:43008
    v_max3_f32 v8, v8, v219, v220
    v_max3_f32 v8, v8, v221, v222
    v_max_f32 v8, v8, v223
    s_waitcnt lgkmcnt(5)
    v_mfma_f32_32x32x16_bf16 v[144:159], v[44:47], v[180:183], v[144:159]
    ds_read_b128 v[36:39], v4 offset:10240
    v_cmp_lt_f32 vcc, s30, v8
    s_nop 0
    s_cbranch_vccnz L_fix3
L_ret3:
    s_waitcnt lgkmcnt(5)
    v_mfma_f32_32x32x16_bf16 v[176:191], v[16:19], v[64:67], v[48:63]
    ds_read_b128 v[40:43], v2 offset:44032
    v_exp_f32 v208, v208
    v_exp_f32 v209, v209
    v_exp_f32 v210, v210
    v_exp_f32 v211, v211
    s_add_u32 m0, s21, 98304
    s_add_u32 s24, s20, s21
    s_add_u32 s24, s24, 40960
    buffer_load_dwordx4 v1, s[4:7], s24 offen offset:0 sc1 lds
    s_lshl_b32 s35, s14, 3
    s_add_u32 s35, s35, s13
    s_lshr_b32 s34, s35, 1
    s_lshl_b32 s34, s34, 14
    s_and_b32 s35, s35, 1
    s_lshl_b32 s35, s35, 7
    s_add_u32 s35, s35, s34
    s_lshl_b32 s34, s12, 11
    s_add_u32 s35, s35, s34
    s_add_u32 s35, s35, 35651584
    v_lshrrev_b32 v11, 7, v1
    v_lshlrev_b32 v11, 8, v11
    v_and_b32 v10, 0x70, v1
    v_or_b32 v11, v11, v10
    buffer_store_dwordx4 v[224:227], v11, s[4:7], s35 offen sc1
    s_waitcnt lgkmcnt(5)
    v_mfma_f32_32x32x16_bf16 v[96:111], v[20:23], v[192:195], v[96:111]
    ds_read_b128 v[44:47], v4 offset:11264
    v_exp_f32 v212, v212
    v_exp_f32 v213, v213
    v_exp_f32 v214, v214
    s_waitcnt lgkmcnt(5)
    v_mfma_f32_32x32x16_bf16 v[176:191], v[24:27], v[68:71], v[176:191]
    ds_read_b128 v[16:19], v3 offset:40960
    v_exp_f32 v215, v215
    v_exp_f32 v216, v216
    v_add_f32 v7, v7, v208
    s_waitcnt lgkmcnt(5)
    v_mfma_f32_32x32x16_bf16 v[112:127], v[28:31], v[192:195], v[112:127]
    ds_read_b128 v[20:23], v4 offset:12288
    v_exp_f32 v217, v217
    v_add_f32 v6, v6, v209
    v_exp_f32 v218, v218
    s_waitcnt lgkmcnt(5)
    v_mfma_f32_32x32x16_bf16 v[176:191], v[32:35], v[72:75], v[176:191]
    ds_read_b128 v[24:27], v3 offset:41984
    v_add_f32 v7, v7, v210
    v_exp_f32 v219, v219
    v_add_f32 v6, v6, v211
    s_waitcnt lgkmcnt(5)
    v_mfma_f32_32x32x16_bf16 v[128:143], v[36:39], v[192:195], v[128:143]
    ds_read_b128 v[28:31], v4 offset:13312
    v_exp_f32 v220, v220
    v_add_f32 v7, v7, v212
    v_exp_f32 v221, v221
    v_add_f32 v6, v6, v213
    buffer_load_dwordx4 v1, s[4:7], s24 offen offset:1024 sc1 lds
    s_waitcnt lgkmcnt(5)
    v_mfma_f32_32x32x16_bf16 v[176:191], v[40:43], v[76:79], v[176:191]
    ds_read_b128 v[32:35], v3 offset:43008
    v_exp_f32 v222, v222
    v_add_f32 v7, v7, v214
    v_exp_f32 v223, v223
    s_waitcnt lgkmcnt(5)
    v_mfma_f32_32x32x16_bf16 v[144:159], v[44:47], v[192:195], v[144:159]
    ds_read_b128 v[36:39], v4 offset:14336
    v_add_f32 v6, v6, v215
    v_cvt_pk_bf16_f32 v208, v208, v209
    v_cvt_pk_bf16_f32 v209, v210, v211
    s_waitcnt lgkmcnt(5)
    v_mfma_f32_32x32x16_bf16 v[176:191], v[16:19], v[80:83], v[176:191]
    ds_read_b128 v[40:43], v3 offset:44032
    v_cvt_pk_bf16_f32 v210, v212, v213
    v_cvt_pk_bf16_f32 v211, v214, v215
    v_add_f32 v7, v7, v216
    s_waitcnt lgkmcnt(5)
    v_mfma_f32_32x32x16_bf16 v[96:111], v[20:23], v[196:199], v[96:111]
    ds_read_b128 v[44:47], v4 offset:15360
    v_add_f32 v6, v6, v217
    v_add_f32 v7, v7, v218
    v_add_f32 v6, v6, v219
    s_waitcnt lgkmcnt(5)
    v_mfma_f32_32x32x16_bf16 v[176:191], v[24:27], v[84:87], v[176:191]
    ds_read_b128 v[16:19], v2 offset:49152
    v_add_f32 v7, v7, v220
    v_add_f32 v6, v6, v221
    v_add_f32 v7, v7, v222
    v_add_f32 v6, v6, v223
    buffer_load_dwordx4 v1, s[4:7], s24 offen offset:2048 sc1 lds
    s_waitcnt lgkmcnt(5)
    v_mfma_f32_32x32x16_bf16 v[112:127], v[28:31], v[196:199], v[112:127]
    ds_read_b128 v[20:23], v4 offset:16384
    v_cvt_pk_bf16_f32 v212, v216, v217
    v_cvt_pk_bf16_f32 v213, v218, v219
    v_cvt_pk_bf16_f32 v214, v220, v221
    s_waitcnt lgkmcnt(5)
    v_mfma_f32_32x32x16_bf16 v[176:191], v[32:35], v[88:91], v[176:191]
    ds_read_b128 v[24:27], v2 offset:50176
    v_cvt_pk_bf16_f32 v215, v222, v223
    v_max3_f32 v8, v160, v161, v162
    v_max3_f32 v8, v8, v163, v164
    s_waitcnt lgkmcnt(5)
    v_mfma_f32_32x32x16_bf16 v[128:143], v[36:39], v[196:199], v[128:143]
    ds_read_b128 v[28:31], v4 offset:17408
    v_max3_f32 v8, v8, v165, v166
    v_max3_f32 v8, v8, v167, v168
    v_max3_f32 v8, v8, v169, v170
    s_waitcnt lgkmcnt(5)
    v_mfma_f32_32x32x16_bf16 v[176:191], v[40:43], v[92:95], v[176:191]
    ds_read_b128 v[32:35], v2 offset:51200
    v_max3_f32 v8, v8, v171, v172
    v_max3_f32 v8, v8, v173, v174
    v_max_f32 v8, v8, v175
    s_waitcnt lgkmcnt(5)
    v_mfma_f32_32x32x16_bf16 v[144:159], v[44:47], v[196:199], v[144:159]
    ds_read_b128 v[36:39], v4 offset:18432
    v_cmp_lt_f32 vcc, s30, v8
    s_nop 0
    s_cbranch_vccnz L_fix4
L_ret4:
    buffer_load_dwordx4 v1, s[4:7], s24 offen offset:3072 sc1 lds
    s_waitcnt lgkmcnt(5)
    v_mfma_f32_32x32x16_bf16 v[192:207], v[16:19], v[64:67], v[48:63]
    ds_read_b128 v[40:43], v2 offset:52224
    v_exp_f32 v160, v160
    v_exp_f32 v161, v161
    v_exp_f32 v162, v162
    v_exp_f32 v163, v163
    s_waitcnt lgkmcnt(5)
    v_mfma_f32_32x32x16_bf16 v[96:111], v[20:23], v[208:211], v[96:111]
    ds_read_b128 v[44:47], v4 offset:19456
    v_exp_f32 v164, v164
    v_exp_f32 v165, v165
    v_exp_f32 v166, v166
    s_waitcnt lgkmcnt(5)
    v_mfma_f32_32x32x16_bf16 v[192:207], v[24:27], v[68:71], v[192:207]
    ds_read_b128 v[16:19], v3 offset:49152
    v_exp_f32 v167, v167
    v_exp_f32 v168, v168
    v_add_f32 v7, v7, v160
    s_waitcnt lgkmcnt(5)
    v_mfma_f32_32x32x16_bf16 v[112:127], v[28:31], v[208:211], v[112:127]
    ds_read_b128 v[20:23], v4 offset:20480
    v_exp_f32 v169, v169
    v_add_f32 v6, v6, v161
    v_exp_f32 v170, v170
    s_waitcnt lgkmcnt(5)
    v_mfma_f32_32x32x16_bf16 v[192:207], v[32:35], v[72:75], v[192:207]
    ds_read_b128 v[24:27], v3 offset:50176
    v_add_f32 v7, v7, v162
    v_exp_f32 v171, v171
    v_add_f32 v6, v6, v163
    s_waitcnt lgkmcnt(5)
    v_mfma_f32_32x32x16_bf16 v[128:143], v[36:39], v[208:211], v[128:143]
    ds_read_b128 v[28:31], v4 offset:21504
    v_exp_f32 v172, v172
    v_add_f32 v7, v7, v164
    v_exp_f32 v173, v173
    v_add_f32 v6, v6, v165
    s_waitcnt lgkmcnt(5)
    v_mfma_f32_32x32x16_bf16 v[192:207], v[40:43], v[76:79], v[192:207]
    ds_read_b128 v[32:35], v3 offset:51200
    v_exp_f32 v174, v174
    v_add_f32 v7, v7, v166
    v_exp_f32 v175, v175
    s_waitcnt lgkmcnt(5)
    v_mfma_f32_32x32x16_bf16 v[144:159], v[44:47], v[208:211], v[144:159]
    ds_read_b128 v[36:39], v4 offset:22528
    v_add_f32 v6, v6, v167
    v_cvt_pk_bf16_f32 v160, v160, v161
    v_cvt_pk_bf16_f32 v161, v162, v163
    s_waitcnt lgkmcnt(5)
    v_mfma_f32_32x32x16_bf16 v[192:207], v[16:19], v[80:83], v[192:207]
    ds_read_b128 v[40:43], v3 offset:52224
    v_cvt_pk_bf16_f32 v162, v164, v165
    v_cvt_pk_bf16_f32 v163, v166, v167
    v_add_f32 v7, v7, v168
    s_waitcnt lgkmcnt(5)
    v_mfma_f32_32x32x16_bf16 v[96:111], v[20:23], v[212:215], v[96:111]
    ds_read_b128 v[44:47], v4 offset:23552
    v_add_f32 v6, v6, v169
    v_add_f32 v7, v7, v170
    v_add_f32 v6, v6, v171
    s_waitcnt lgkmcnt(5)
    v_mfma_f32_32x32x16_bf16 v[192:207], v[24:27], v[84:87], v[192:207]
    ds_read_b128 v[16:19], v2 offset:57344
    v_add_f32 v7, v7, v172
    v_add_f32 v6, v6, v173
    v_add_f32 v7, v7, v174
    v_add_f32 v6, v6, v175
    s_waitcnt lgkmcnt(5)
    v_mfma_f32_32x32x16_bf16 v[112:127], v[28:31], v[212:215], v[112:127]
    ds_read_b128 v[20:23], v4 offset:24576
    v_cvt_pk_bf16_f32 v164, v168, v169
    v_cvt_pk_bf16_f32 v165, v170, v171
    v_cvt_pk_bf16_f32 v166, v172, v173
    s_waitcnt lgkmcnt(5)
    v_mfma_f32_32x32x16_bf16 v[192:207], v[32:35], v[88:91], v[192:207]
    ds_read_b128 v[24:27], v2 offset:58368
    v_cvt_pk_bf16_f32 v167, v174, v175
    v_max3_f32 v8, v176, v177, v178
    v_max3_f32 v8, v8, v179, v180
    s_waitcnt lgkmcnt(5)
    v_mfma_f32_32x32x16_bf16 v[128:143], v[36:39], v[212:215], v[128:143]
    ds_read_b128 v[28:31], v4 offset:25600
    v_max3_f32 v8, v8, v181, v182
    v_max3_f32 v8, v8, v183, v184
    v_max3_f32 v8, v8, v185, v186
    s_waitcnt lgkmcnt(5)
    v_mfma_f32_32x32x16_bf16 v[192:207], v[40:43], v[92:95], v[192:207]
    ds_read_b128 v[32:35], v2 offset:59392
    v_max3_f32 v8, v8, v187, v188
    v_max3_f32 v8, v8, v189, v190
    v_max_f32 v8, v8, v191
    s_waitcnt lgkmcnt(5)
    v_mfma_f32_32x32x16_bf16 v[144:159], v[44:47], v[212:215], v[144:159]
    ds_read_b128 v[36:39], v4 offset:26624
    v_cmp_lt_f32 vcc, s30, v8
    s_nop 0
    s_cbranch_vccnz L_fix5
L_ret5:
    s_waitcnt lgkmcnt(5)
    v_mfma_f32_32x32x16_bf16 v[208:223], v[16:19], v[64:67], v[48:63]
    ds_read_b128 v[40:43], v2 offset:60416
    v_exp_f32 v176, v176
    v_exp_f32 v177, v177
    v_exp_f32 v178, v178
    v_exp_f32 v179, v179
    s_lshl_b32 s35, s14, 3
    s_add_u32 s35, s35, s13
    s_lshl_b32 s35, s35, 9
    s_add_u32 s35, s35, 50331648
    s_cmp_eq_u32 s12, 0
    s_cselect_b32 s35, s35, 268435456
    v_lshrrev_b32 v11, 1, v1
    buffer_store_dwordx2 v[224:225], v11, s[4:7], s35 offen sc1
    s_waitcnt lgkmcnt(5)
    v_mfma_f32_32x32x16_bf16 v[96:111], v[20:23], v[160:163], v[96:111]
    ds_read_b128 v[44:47], v4 offset:27648
    v_exp_f32 v180, v180
    v_exp_f32 v181, v181
    v_exp_f32 v182, v182
    s_waitcnt lgkmcnt(5)
    v_mfma_f32_32x32x16_bf16 v[208:223], v[24:27], v[68:71], v[208:223]
    ds_read_b128 v[16:19], v3 offset:57344
    v_exp_f32 v183, v183
    v_exp_f32 v184, v184
    v_add_f32 v7, v7, v176
    s_waitcnt lgkmcnt(5)
    v_mfma_f32_32x32x16_bf16 v[112:127], v[28:31], v[160:163], v[112:127]
    ds_read_b128 v[20:23], v4 offset:28672
    v_exp_f32 v185, v185
    v_add_f32 v6, v6, v177
    v_exp_f32 v186, v186
    s_waitcnt lgkmcnt(5)
    v_mfma_f32_32x32x16_bf16 v[208:223], v[32:35], v[72:75], v[208:223]
    ds_read_b128 v[24:27], v3 offset:58368
    v_add_f32 v7, v7, v178
    v_exp_f32 v187, v187
    v_add_f32 v6, v6, v179
    s_waitcnt lgkmcnt(5)
    v_mfma_f32_32x32x16_bf16 v[128:143], v[36:39], v[160:163], v[128:143]
    ds_read_b128 v[28:31], v4 offset:29696
    v_exp_f32 v188, v188
    v_add_f32 v7, v7, v180
    v_exp_f32 v189, v189
    v_add_f32 v6, v6, v181
    s_waitcnt lgkmcnt(5)
    v_mfma_f32_32x32x16_bf16 v[208:223], v[40:43], v[76:79], v[208:223]
    ds_read_b128 v[32:35], v3 offset:59392
    v_exp_f32 v190, v190
    v_add_f32 v7, v7, v182
    v_exp_f32 v191, v191
    s_waitcnt lgkmcnt(5)
    v_mfma_f32_32x32x16_bf16 v[144:159], v[44:47], v[160:163], v[144:159]
    ds_read_b128 v[36:39], v4 offset:30720
    v_add_f32 v6, v6, v183
    v_cvt_pk_bf16_f32 v176, v176, v177
    v_cvt_pk_bf16_f32 v177, v178, v179
    s_waitcnt lgkmcnt(5)
    v_mfma_f32_32x32x16_bf16 v[208:223], v[16:19], v[80:83], v[208:223]
    ds_read_b128 v[40:43], v3 offset:60416
    v_cvt_pk_bf16_f32 v178, v180, v181
    v_cvt_pk_bf16_f32 v179, v182, v183
    v_add_f32 v7, v7, v184
    s_waitcnt lgkmcnt(5)
    v_mfma_f32_32x32x16_bf16 v[96:111], v[20:23], v[164:167], v[96:111]
    ds_read_b128 v[44:47], v4 offset:31744
    v_add_f32 v6, v6, v185
    v_add_f32 v7, v7, v186
    v_add_f32 v6, v6, v187
    s_waitcnt lgkmcnt(5)
    v_mfma_f32_32x32x16_bf16 v[208:223], v[24:27], v[84:87], v[208:223]
    v_add_f32 v7, v7, v188
    v_add_f32 v6, v6, v189
    v_add_f32 v7, v7, v190
    v_add_f32 v6, v6, v191
    s_waitcnt lgkmcnt(4)
    v_mfma_f32_32x32x16_bf16 v[112:127], v[28:31], v[164:167], v[112:127]
    v_cvt_pk_bf16_f32 v180, v184, v185
    v_cvt_pk_bf16_f32 v181, v186, v187
    v_cvt_pk_bf16_f32 v182, v188, v189
    s_waitcnt lgkmcnt(3)
    v_mfma_f32_32x32x16_bf16 v[208:223], v[32:35], v[88:91], v[208:223]
    s_waitcnt vmcnt(1)
    s_waitcnt lgkmcnt(0)
    s_barrier
    ds_read_b128 v[16:19], v2 offset:0
    ds_read_b128 v[20:23], v4 offset:32768
    ds_read_b128 v[24:27], v2 offset:1024
    v_cvt_pk_bf16_f32 v183, v190, v191
    v_max3_f32 v8, v192, v193, v194
    v_max3_f32 v8, v8, v195, v196
    s_add_u32 m0, s21, 32768
    s_add_u32 s24, s19, s21
    s_add_u32 s24, s24, 98304
    buffer_load_dwordx4 v1, s[4:7], s24 offen offset:0 sc1 lds
    s_lshl_b32 s35, s2, 15
    s_add_u32 s35, s35, 8192
    s_cmp_eq_u32 s12, 2
    s_cselect_b32 s35, s35, 8388608
    v_lshlrev_b32 v11, 3, v1
    buffer_load_dword v0, v11, s[36:39], s35 offen
    v_mfma_f32_32x32x16_bf16 v[128:143], v[36:39], v[164:167], v[128:143]
    ds_read_b128 v[28:31], v4 offset:33792
    v_max3_f32 v8, v8, v197, v198
    v_max3_f32 v8, v8, v199, v200
    v_max3_f32 v8, v8, v201, v202
    v_mfma_f32_32x32x16_bf16 v[208:223], v[40:43], v[92:95], v[208:223]
    ds_read_b128 v[32:35], v2 offset:2048
    v_max3_f32 v8, v8, v203, v204
    v_max3_f32 v8, v8, v205, v206
    v_max_f32 v8, v8, v207
    v_mfma_f32_32x32x16_bf16 v[144:159], v[44:47], v[164:167], v[144:159]
    ds_read_b128 v[36:39], v4 offset:34816
    v_cmp_lt_f32 vcc, s30, v8
    s_nop 0
    s_cbranch_vccnz L_fix6
L_ret6:
    s_waitcnt lgkmcnt(5)
    v_mfma_f32_32x32x16_bf16 v[160:175], v[16:19], v[64:67], v[48:63]
    ds_read_b128 v[40:43], v2 offset:3072
    v_exp_f32 v192, v192
    v_exp_f32 v193, v193
    v_exp_f32 v194, v194
    v_exp_f32 v195, v195
    s_waitcnt lgkmcnt(5)
    v_mfma_f32_32x32x16_bf16 v[96:111], v[20:23], v[176:179], v[96:111]
    ds_read_b128 v[44:47], v4 offset:35840
    v_exp_f32 v196, v196
    v_exp_f32 v197, v197
    v_exp_f32 v198, v198
    buffer_load_dwordx4 v1, s[4:7], s24 offen offset:1024 sc1 lds
    s_waitcnt lgkmcnt(5)
    v_mfma_f32_32x32x16_bf16 v[160:175], v[24:27], v[68:71], v[160:175]
    ds_read_b128 v[16:19], v3 offset:0
    v_exp_f32 v199, v199
    v_exp_f32 v200, v200
    v_add_f32 v7, v7, v192
    s_waitcnt lgkmcnt(5)
    v_mfma_f32_32x32x16_bf16 v[112:127], v[28:31], v[176:179], v[112:127]
    ds_read_b128 v[20:23], v4 offset:36864
    v_exp_f32 v201, v201
    v_add_f32 v6, v6, v193
    v_exp_f32 v202, v202
    s_waitcnt lgkmcnt(5)
    v_mfma_f32_32x32x16_bf16 v[160:175], v[32:35], v[72:75], v[160:175]
    ds_read_b128 v[24:27], v3 offset:1024
    v_add_f32 v7, v7, v194
    v_exp_f32 v203, v203
    v_add_f32 v6, v6, v195
    s_waitcnt lgkmcnt(5)
    v_mfma_f32_32x32x16_bf16 v[128:143], v[36:39], v[176:179], v[128:143]
    ds_read_b128 v[28:31], v4 offset:37888
    v_exp_f32 v204, v204
    v_add_f32 v7, v7, v196
    v_exp_f32 v205, v205
    v_add_f32 v6, v6, v197
    s_waitcnt lgkmcnt(5)
    v_mfma_f32_32x32x16_bf16 v[160:175], v[40:43], v[76:79], v[160:175]
    ds_read_b128 v[32:35], v3 offset:2048
    v_exp_f32 v206, v206
    v_add_f32 v7, v7, v198
    v_exp_f32 v207, v207
    buffer_load_dwordx4 v1, s[4:7], s24 offen offset:2048 sc1 lds
    s_waitcnt lgkmcnt(5)
    v_mfma_f32_32x32x16_bf16 v[144:159], v[44:47], v[176:179], v[144:159]
    ds_read_b128 v[36:39], v4 offset:38912
    v_add_f32 v6, v6, v199
    v_cvt_pk_bf16_f32 v192, v192, v193
    v_cvt_pk_bf16_f32 v193, v194, v195
    s_waitcnt lgkmcnt(5)
    v_mfma_f32_32x32x16_bf16 v[160:175], v[16:19], v[80:83], v[160:175]
    ds_read_b128 v[40:43], v3 offset:3072
    v_cvt_pk_bf16_f32 v194, v196, v197
    v_cvt_pk_bf16_f32 v195, v198, v199
    v_add_f32 v7, v7, v200
    s_waitcnt lgkmcnt(5)
    v_mfma_f32_32x32x16_bf16 v[96:111], v[20:23], v[180:183], v[96:111]
    ds_read_b128 v[44:47], v4 offset:39936
    v_add_f32 v6, v6, v201
    v_add_f32 v7, v7, v202
    v_add_f32 v6, v6, v203
    s_waitcnt lgkmcnt(5)
    v_mfma_f32_32x32x16_bf16 v[160:175], v[24:27], v[84:87], v[160:175]
    ds_read_b128 v[16:19], v2 offset:8192
    v_add_f32 v7, v7, v204
    v_add_f32 v6, v6, v205
    v_add_f32 v7, v7, v206
    v_add_f32 v6, v6, v207
    s_waitcnt lgkmcnt(5)
    v_mfma_f32_32x32x16_bf16 v[112:127], v[28:31], v[180:183], v[112:127]
    ds_read_b128 v[20:23], v4 offset:40960
    v_cvt_pk_bf16_f32 v196, v200, v201
    v_cvt_pk_bf16_f32 v197, v202, v203
    v_cvt_pk_bf16_f32 v198, v204, v205
    buffer_load_dwordx4 v1, s[4:7], s24 offen offset:3072 sc1 lds
    s_waitcnt lgkmcnt(5)
    v_mfma_f32_32x32x16_bf16 v[160:175], v[32:35], v[88:91], v[160:175]
    ds_read_b128 v[24:27], v2 offset:9216
    v_cvt_pk_bf16_f32 v199, v206, v207
    v_max3_f32 v8, v208, v209, v210
    v_max3_f32 v8, v8, v211, v212
    s_waitcnt lgkmcnt(5)
    v_mfma_f32_32x32x16_bf16 v[128:143], v[36:39], v[180:183], v[128:143]
    ds_read_b128 v[28:31], v4 offset:41984
    v_max3_f32 v8, v8, v213, v214
    v_max3_f32 v8, v8, v215, v216
    v_max3_f32 v8, v8, v217, v218
    s_waitcnt lgkmcnt(5)
    v_mfma_f32_32x32x16_bf16 v[160:175], v[40:43], v[92:95], v[160:175]
    ds_read_b128 v[32:35], v2 offset:10240
    v_max3_f32 v8, v8, v219, v220
    v_max3_f32 v8, v8, v221, v222
    v_max_f32 v8, v8, v223
    s_waitcnt lgkmcnt(5)
    v_mfma_f32_32x32x16_bf16 v[144:159], v[44:47], v[180:183], v[144:159]
    ds_read_b128 v[36:39], v4 offset:43008
    v_cmp_lt_f32 vcc, s30, v8
    s_nop 0
    s_cbranch_vccnz L_fix7
L_ret7:
    s_waitcnt lgkmcnt(5)
    v_mfma_f32_32x32x16_bf16 v[176:191], v[16:19], v[64:67], v[48:63]
    ds_read_b128 v[40:43], v2 offset:11264
    v_exp_f32 v208, v208
    v_exp_f32 v209, v209
    v_exp_f32 v210, v210
    v_exp_f32 v211, v211
    s_add_u32 m0, s21, 65536
    s_add_u32 s24, s20, s21
    s_add_u32 s24, s24, 73728
    buffer_load_dwordx4 v1, s[4:7], s24 offen offset:0 sc1 lds
    s_waitcnt lgkmcnt(5)
    v_mfma_f32_32x32x16_bf16 v[96:111], v[20:23], v[192:195], v[96:111]
    ds_read_b128 v[44:47], v4 offset:44032
    v_exp_f32 v212, v212
    v_exp_f32 v213, v213
    v_exp_f32 v214, v214
    s_waitcnt lgkmcnt(5)
    v_mfma_f32_32x32x16_bf16 v[176:191], v[24:27], v[68:71], v[176:191]
    ds_read_b128 v[16:19], v3 offset:8192
    v_exp_f32 v215, v215
    v_exp_f32 v216, v216
    v_add_f32 v7, v7, v208
    s_waitcnt lgkmcnt(5)
    v_mfma_f32_32x32x16_bf16 v[112:127], v[28:31], v[192:195], v[112:127]
    ds_read_b128 v[20:23], v4 offset:45056
    v_exp_f32 v217, v217
    v_add_f32 v6, v6, v209
    v_exp_f32 v218, v218
    s_waitcnt lgkmcnt(5)
    v_mfma_f32_32x32x16_bf16 v[176:191], v[32:35], v[72:75], v[176:191]
    ds_read_b128 v[24:27], v3 offset:9216
    v_add_f32 v7, v7, v210
    v_exp_f32 v219, v219
    v_add_f32 v6, v6, v211
    s_waitcnt lgkmcnt(5)
    v_mfma_f32_32x32x16_bf16 v[128:143], v[36:39], v[192:195], v[128:143]
    ds_read_b128 v[28:31], v4 offset:46080
    v_exp_f32 v220, v220
    v_add_f32 v7, v7, v212
    v_exp_f32 v221, v221
    v_add_f32 v6, v6, v213
    buffer_load_dwordx4 v1, s[4:7], s24 offen offset:1024 sc1 lds
    s_waitcnt lgkmcnt(5)
    v_mfma_f32_32x32x16_bf16 v[176:191], v[40:43], v[76:79], v[176:191]
    ds_read_b128 v[32:35], v3 offset:10240
    v_exp_f32 v222, v222
    v_add_f32 v7, v7, v214
    v_exp_f32 v223, v223
    s_waitcnt lgkmcnt(5)
    v_mfma_f32_32x32x16_bf16 v[144:159], v[44:47], v[192:195], v[144:159]
    ds_read_b128 v[36:39], v4 offset:47104
    v_add_f32 v6, v6, v215
    v_cvt_pk_bf16_f32 v208, v208, v209
    v_cvt_pk_bf16_f32 v209, v210, v211
    s_waitcnt lgkmcnt(5)
    v_mfma_f32_32x32x16_bf16 v[176:191], v[16:19], v[80:83], v[176:191]
    ds_read_b128 v[40:43], v3 offset:11264
    v_cvt_pk_bf16_f32 v210, v212, v213
    v_cvt_pk_bf16_f32 v211, v214, v215
    v_add_f32 v7, v7, v216
    s_waitcnt lgkmcnt(5)
    v_mfma_f32_32x32x16_bf16 v[96:111], v[20:23], v[196:199], v[96:111]
    ds_read_b128 v[44:47], v4 offset:48128
    v_add_f32 v6, v6, v217
    v_add_f32 v7, v7, v218
    v_add_f32 v6, v6, v219
    s_waitcnt lgkmcnt(5)
    v_mfma_f32_32x32x16_bf16 v[176:191], v[24:27], v[84:87], v[176:191]
    ds_read_b128 v[16:19], v2 offset:16384
    v_add_f32 v7, v7, v220
    v_add_f32 v6, v6, v221
    v_add_f32 v7, v7, v222
    v_add_f32 v6, v6, v223
    buffer_load_dwordx4 v1, s[4:7], s24 offen offset:2048 sc1 lds
    s_waitcnt lgkmcnt(5)
    v_mfma_f32_32x32x16_bf16 v[112:127], v[28:31], v[196:199], v[112:127]
    ds_read_b128 v[20:23], v4 offset:49152
    v_cvt_pk_bf16_f32 v212, v216, v217
    v_cvt_pk_bf16_f32 v213, v218, v219
    v_cvt_pk_bf16_f32 v214, v220, v221
    s_waitcnt lgkmcnt(5)
    v_mfma_f32_32x32x16_bf16 v[176:191], v[32:35], v[88:91], v[176:191]
    ds_read_b128 v[24:27], v2 offset:17408
    v_cvt_pk_bf16_f32 v215, v222, v223
    v_max3_f32 v8, v160, v161, v162
    v_max3_f32 v8, v8, v163, v164
    s_waitcnt lgkmcnt(5)
    v_mfma_f32_32x32x16_bf16 v[128:143], v[36:39], v[196:199], v[128:143]
    ds_read_b128 v[28:31], v4 offset:50176
    v_max3_f32 v8, v8, v165, v166
    v_max3_f32 v8, v8, v167, v168
    v_max3_f32 v8, v8, v169, v170
    s_waitcnt lgkmcnt(5)
    v_mfma_f32_32x32x16_bf16 v[176:191], v[40:43], v[92:95], v[176:191]
    ds_read_b128 v[32:35], v2 offset:18432
    v_max3_f32 v8, v8, v171, v172
    v_max3_f32 v8, v8, v173, v174
    v_max_f32 v8, v8, v175
    s_waitcnt lgkmcnt(5)
    v_mfma_f32_32x32x16_bf16 v[144:159], v[44:47], v[196:199], v[144:159]
    ds_read_b128 v[36:39], v4 offset:51200
    v_cmp_lt_f32 vcc, s30, v8
    s_nop 0
    s_cbranch_vccnz L_fix8
L_ret8:
    buffer_load_dwordx4 v1, s[4:7], s24 offen offset:3072 sc1 lds
    s_waitcnt lgkmcnt(5)
    v_mfma_f32_32x32x16_bf16 v[192:207], v[16:19], v[64:67], v[48:63]
    ds_read_b128 v[40:43], v2 offset:19456
    v_exp_f32 v160, v160
    v_exp_f32 v161, v161
    v_exp_f32 v162, v162
    v_exp_f32 v163, v163
    s_lshr_b32 s3, s2, 3
    s_lshl_b32 s3, s3, 11
    s_add_u32 s3, s3, 51446784
    buffer_load_dwordx4 v[252:255], v1, s[4:7], s3 offen sc1
    s_waitcnt lgkmcnt(5)
    v_mfma_f32_32x32x16_bf16 v[96:111], v[20:23], v[208:211], v[96:111]
    ds_read_b128 v[44:47], v4 offset:52224
    v_exp_f32 v164, v164
    v_exp_f32 v165, v165
    v_exp_f32 v166, v166
    s_waitcnt lgkmcnt(5)
    v_mfma_f32_32x32x16_bf16 v[192:207], v[24:27], v[68:71], v[192:207]
    ds_read_b128 v[16:19], v3 offset:16384
    v_exp_f32 v167, v167
    v_exp_f32 v168, v168
    v_add_f32 v7, v7, v160
    s_waitcnt lgkmcnt(5)
    v_mfma_f32_32x32x16_bf16 v[112:127], v[28:31], v[208:211], v[112:127]
    ds_read_b128 v[20:23], v4 offset:53248
    v_exp_f32 v169, v169
    v_add_f32 v6, v6, v161
    v_exp_f32 v170, v170
    s_waitcnt lgkmcnt(5)
    v_mfma_f32_32x32x16_bf16 v[192:207], v[32:35], v[72:75], v[192:207]
    ds_read_b128 v[24:27], v3 offset:17408
    v_add_f32 v7, v7, v162
    v_exp_f32 v171, v171
    v_add_f32 v6, v6, v163
    s_waitcnt lgkmcnt(5)
    v_mfma_f32_32x32x16_bf16 v[128:143], v[36:39], v[208:211], v[128:143]
    ds_read_b128 v[28:31], v4 offset:54272
    v_exp_f32 v172, v172
    v_add_f32 v7, v7, v164
    v_exp_f32 v173, v173
    v_add_f32 v6, v6, v165
    s_waitcnt lgkmcnt(5)
    v_mfma_f32_32x32x16_bf16 v[192:207], v[40:43], v[76:79], v[192:207]
    ds_read_b128 v[32:35], v3 offset:18432
    v_exp_f32 v174, v174
    v_add_f32 v7, v7, v166
    v_exp_f32 v175, v175
    s_waitcnt lgkmcnt(5)
    v_mfma_f32_32x32x16_bf16 v[144:159], v[44:47], v[208:211], v[144:159]
    ds_read_b128 v[36:39], v4 offset:55296
    v_add_f32 v6, v6, v167
    v_cvt_pk_bf16_f32 v160, v160, v161
    v_cvt_pk_bf16_f32 v161, v162, v163
    s_waitcnt lgkmcnt(5)
    v_mfma_f32_32x32x16_bf16 v[192:207], v[16:19], v[80:83], v[192:207]
    ds_read_b128 v[40:43], v3 offset:19456
    v_cvt_pk_bf16_f32 v162, v164, v165
    v_cvt_pk_bf16_f32 v163, v166, v167
    v_add_f32 v7, v7, v168
    s_waitcnt lgkmcnt(5)
    v_mfma_f32_32x32x16_bf16 v[96:111], v[20:23], v[212:215], v[96:111]
    ds_read_b128 v[44:47], v4 offset:56320
    v_add_f32 v6, v6, v169
    v_add_f32 v7, v7, v170
    v_add_f32 v6, v6, v171
    s_waitcnt lgkmcnt(5)
    v_mfma_f32_32x32x16_bf16 v[192:207], v[24:27], v[84:87], v[192:207]
    ds_read_b128 v[16:19], v2 offset:24576
    v_add_f32 v7, v7, v172
    v_add_f32 v6, v6, v173
    v_add_f32 v7, v7, v174
    v_add_f32 v6, v6, v175
    s_waitcnt lgkmcnt(5)
    v_mfma_f32_32x32x16_bf16 v[112:127], v[28:31], v[212:215], v[112:127]
    ds_read_b128 v[20:23], v4 offset:57344
    v_cvt_pk_bf16_f32 v164, v168, v169
    v_cvt_pk_bf16_f32 v165, v170, v171
    v_cvt_pk_bf16_f32 v166, v172, v173
    s_waitcnt lgkmcnt(5)
    v_mfma_f32_32x32x16_bf16 v[192:207], v[32:35], v[88:91], v[192:207]
    ds_read_b128 v[24:27], v2 offset:25600
    v_cvt_pk_bf16_f32 v167, v174, v175
    v_max3_f32 v8, v176, v177, v178
    v_max3_f32 v8, v8, v179, v180
    s_waitcnt lgkmcnt(5)
    v_mfma_f32_32x32x16_bf16 v[128:143], v[36:39], v[212:215], v[128:143]
    ds_read_b128 v[28:31], v4 offset:58368
    v_max3_f32 v8, v8, v181, v182
    v_max3_f32 v8, v8, v183, v184
    v_max3_f32 v8, v8, v185, v186
    s_waitcnt lgkmcnt(5)
    v_mfma_f32_32x32x16_bf16 v[192:207], v[40:43], v[92:95], v[192:207]
    ds_read_b128 v[32:35], v2 offset:26624
    v_max3_f32 v8, v8, v187, v188
    v_max3_f32 v8, v8, v189, v190
    v_max_f32 v8, v8, v191
    s_waitcnt lgkmcnt(5)
    v_mfma_f32_32x32x16_bf16 v[144:159], v[44:47], v[212:215], v[144:159]
    ds_read_b128 v[36:39], v4 offset:59392
    v_cmp_lt_f32 vcc, s30, v8
    s_nop 0
    s_cbranch_vccnz L_fix9
L_ret9:
    s_waitcnt lgkmcnt(5)
    v_mfma_f32_32x32x16_bf16 v[208:223], v[16:19], v[64:67], v[48:63]
    ds_read_b128 v[40:43], v2 offset:27648
    v_exp_f32 v176, v176
    v_exp_f32 v177, v177
    v_exp_f32 v178, v178
    v_exp_f32 v179, v179
    s_waitcnt lgkmcnt(5)
    v_mfma_f32_32x32x16_bf16 v[96:111], v[20:23], v[160:163], v[96:111]
    ds_read_b128 v[44:47], v4 offset:60416
    v_exp_f32 v180, v180
    v_exp_f32 v181, v181
    v_exp_f32 v182, v182
    s_waitcnt lgkmcnt(5)
    v_mfma_f32_32x32x16_bf16 v[208:223], v[24:27], v[68:71], v[208:223]
    ds_read_b128 v[16:19], v3 offset:24576
    v_exp_f32 v183, v183
    v_exp_f32 v184, v184
    v_add_f32 v7, v7, v176
    s_waitcnt lgkmcnt(5)
    v_mfma_f32_32x32x16_bf16 v[112:127], v[28:31], v[160:163], v[112:127]
    ds_read_b128 v[20:23], v4 offset:61440
    v_exp_f32 v185, v185
    v_add_f32 v6, v6, v177
    v_exp_f32 v186, v186
    s_waitcnt lgkmcnt(5)
    v_mfma_f32_32x32x16_bf16 v[208:223], v[32:35], v[72:75], v[208:223]
    ds_read_b128 v[24:27], v3 offset:25600
    v_add_f32 v7, v7, v178
    v_exp_f32 v187, v187
    v_add_f32 v6, v6, v179
    s_waitcnt lgkmcnt(5)
    v_mfma_f32_32x32x16_bf16 v[128:143], v[36:39], v[160:163], v[128:143]
    ds_read_b128 v[28:31], v4 offset:62464
    v_exp_f32 v188, v188
    v_add_f32 v7, v7, v180
    v_exp_f32 v189, v189
    v_add_f32 v6, v6, v181
    s_waitcnt lgkmcnt(5)
    v_mfma_f32_32x32x16_bf16 v[208:223], v[40:43], v[76:79], v[208:223]
    ds_read_b128 v[32:35], v3 offset:26624
    v_exp_f32 v190, v190
    v_add_f32 v7, v7, v182
    v_exp_f32 v191, v191
    s_waitcnt lgkmcnt(5)
    v_mfma_f32_32x32x16_bf16 v[144:159], v[44:47], v[160:163], v[144:159]
    ds_read_b128 v[36:39], v4 offset:63488
    v_add_f32 v6, v6, v183
    v_cvt_pk_bf16_f32 v176, v176, v177
    v_cvt_pk_bf16_f32 v177, v178, v179
    s_waitcnt lgkmcnt(5)
    v_mfma_f32_32x32x16_bf16 v[208:223], v[16:19], v[80:83], v[208:223]
    ds_read_b128 v[40:43], v3 offset:27648
    v_cvt_pk_bf16_f32 v178, v180, v181
    v_cvt_pk_bf16_f32 v179, v182, v183
    v_add_f32 v7, v7, v184
    s_waitcnt vmcnt(0)
    v_xor_b32 v252, s51, v252
    v_xor_b32 v253, s51, v253
    v_xor_b32 v254, s51, v254
    v_xor_b32 v255, s51, v255
    v_or3_b32 v252, v252, v253, v254
    v_or_b32 v252, v252, v255
    v_cmp_ne_u32 vcc, 0, v252
    s_nop 0
    s_cbranch_vccnz L_f2_spin
L_f2_ok:
    s_waitcnt lgkmcnt(5)
    v_mfma_f32_32x32x16_bf16 v[96:111], v[20:23], v[164:167], v[96:111]
    ds_read_b128 v[44:47], v4 offset:64512
    v_add_f32 v6, v6, v185
    v_add_f32 v7, v7, v186
    v_add_f32 v6, v6, v187
    s_waitcnt lgkmcnt(5)
    v_mfma_f32_32x32x16_bf16 v[208:223], v[24:27], v[84:87], v[208:223]
    v_add_f32 v7, v7, v188
    v_add_f32 v6, v6, v189
    v_add_f32 v7, v7, v190
    v_add_f32 v6, v6, v191
    s_waitcnt lgkmcnt(4)
    v_mfma_f32_32x32x16_bf16 v[112:127], v[28:31], v[164:167], v[112:127]
    v_cvt_pk_bf16_f32 v180, v184, v185
    v_cvt_pk_bf16_f32 v181, v186, v187
    v_cvt_pk_bf16_f32 v182, v188, v189
    s_waitcnt lgkmcnt(3)
    v_mfma_f32_32x32x16_bf16 v[208:223], v[32:35], v[88:91], v[208:223]
    s_waitcnt lgkmcnt(0)
    s_barrier
    ds_read_b128 v[16:19], v2 offset:32768
    ds_read_b128 v[20:23], v4 offset:0
    ds_read_b128 v[24:27], v2 offset:33792
    v_cvt_pk_bf16_f32 v183, v190, v191
    v_max3_f32 v8, v192, v193, v194
    v_max3_f32 v8, v8, v195, v196
    s_lshl_b32 s35, s2, 15
    s_add_u32 s35, s35, 16384
    s_cmp_eq_u32 s12, 4
    s_cselect_b32 s35, s35, 8388608
    v_lshlrev_b32 v11, 3, v1
    buffer_load_dword v0, v11, s[36:39], s35 offen
    v_mfma_f32_32x32x16_bf16 v[128:143], v[36:39], v[164:167], v[128:143]
    ds_read_b128 v[28:31], v4 offset:1024
    v_max3_f32 v8, v8, v197, v198
    v_max3_f32 v8, v8, v199, v200
    v_max3_f32 v8, v8, v201, v202
    v_mfma_f32_32x32x16_bf16 v[208:223], v[40:43], v[92:95], v[208:223]
    ds_read_b128 v[32:35], v2 offset:34816
    v_max3_f32 v8, v8, v203, v204
    v_max3_f32 v8, v8, v205, v206
    v_max_f32 v8, v8, v207
    v_mfma_f32_32x32x16_bf16 v[144:159], v[44:47], v[164:167], v[144:159]
    ds_read_b128 v[36:39], v4 offset:2048
    v_cmp_lt_f32 vcc, s30, v8
    s_nop 0
    s_cbranch_vccnz L_fix10
L_ret10:
    s_waitcnt lgkmcnt(5)
    v_mfma_f32_32x32x16_bf16 v[160:175], v[16:19], v[64:67], v[48:63]
    ds_read_b128 v[40:43], v2 offset:35840
    v_exp_f32 v192, v192
    v_exp_f32 v193, v193
    v_exp_f32 v194, v194
    v_exp_f32 v195, v195
    s_add_u32 s34, s18, 0
    buffer_load_dwordx4 v[224:227], v1, s[4:7], s34 offen offset:0 sc1
    s_waitcnt lgkmcnt(5)
    v_mfma_f32_32x32x16_bf16 v[96:111], v[20:23], v[176:179], v[96:111]
    ds_read_b128 v[44:47], v4 offset:3072
    v_exp_f32 v196, v196
    v_exp_f32 v197, v197
    v_exp_f32 v198, v198
    s_waitcnt lgkmcnt(5)
    v_mfma_f32_32x32x16_bf16 v[160:175], v[24:27], v[68:71], v[160:175]
    ds_read_b128 v[16:19], v3 offset:32768
    v_exp_f32 v199, v199
    v_exp_f32 v200, v200
    v_add_f32 v7, v7, v192
    s_waitcnt lgkmcnt(5)
    v_mfma_f32_32x32x16_bf16 v[112:127], v[28:31], v[176:179], v[112:127]
    ds_read_b128 v[20:23], v4 offset:4096
    v_exp_f32 v201, v201
    v_add_f32 v6, v6, v193
    v_exp_f32 v202, v202
    s_waitcnt lgkmcnt(5)
    v_mfma_f32_32x32x16_bf16 v[160:175], v[32:35], v[72:75], v[160:175]
    ds_read_b128 v[24:27], v3 offset:33792
    v_add_f32 v7, v7, v194
    v_exp_f32 v203, v203
    v_add_f32 v6, v6, v195
    s_waitcnt lgkmcnt(5)
    v_mfma_f32_32x32x16_bf16 v[128:143], v[36:39], v[176:179], v[128:143]
    ds_read_b128 v[28:31], v4 offset:5120
    v_exp_f32 v204, v204
    v_add_f32 v7, v7, v196
    v_exp_f32 v205, v205
    v_add_f32 v6, v6, v197
    s_waitcnt lgkmcnt(5)
    v_mfma_f32_32x32x16_bf16 v[160:175], v[40:43], v[76:79], v[160:175]
    ds_read_b128 v[32:35], v3 offset:34816
    v_exp_f32 v206, v206
    v_add_f32 v7, v7, v198
    v_exp_f32 v207, v207
    s_waitcnt lgkmcnt(5)
    v_mfma_f32_32x32x16_bf16 v[144:159], v[44:47], v[176:179], v[144:159]
    ds_read_b128 v[36:39], v4 offset:6144
    v_add_f32 v6, v6, v199
    v_cvt_pk_bf16_f32 v192, v192, v193
    v_cvt_pk_bf16_f32 v193, v194, v195
    s_waitcnt lgkmcnt(5)
    v_mfma_f32_32x32x16_bf16 v[160:175], v[16:19], v[80:83], v[160:175]
    ds_read_b128 v[40:43], v3 offset:35840
    v_cvt_pk_bf16_f32 v194, v196, v197
    v_cvt_pk_bf16_f32 v195, v198, v199
    v_add_f32 v7, v7, v200
    buffer_load_dwordx4 v[228:231], v1, s[4:7], s34 offen offset:1024 sc1
    s_waitcnt lgkmcnt(5)
    v_mfma_f32_32x32x16_bf16 v[96:111], v[20:23], v[180:183], v[96:111]
    ds_read_b128 v[44:47], v4 offset:7168
    v_add_f32 v6, v6, v201
    v_add_f32 v7, v7, v202
    v_add_f32 v6, v6, v203
    s_waitcnt lgkmcnt(5)
    v_mfma_f32_32x32x16_bf16 v[160:175], v[24:27], v[84:87], v[160:175]
    ds_read_b128 v[16:19], v2 offset:40960
    v_add_f32 v7, v7, v204
    v_add_f32 v6, v6, v205
    v_add_f32 v7, v7, v206
    v_add_f32 v6, v6, v207
    s_waitcnt lgkmcnt(5)
    v_mfma_f32_32x32x16_bf16 v[112:127], v[28:31], v[180:183], v[112:127]
    ds_read_b128 v[20:23], v4 offset:8192
    v_cvt_pk_bf16_f32 v196, v200, v201
    v_cvt_pk_bf16_f32 v197, v202, v203
    v_cvt_pk_bf16_f32 v198, v204, v205
    s_waitcnt lgkmcnt(5)
    v_mfma_f32_32x32x16_bf16 v[160:175], v[32:35], v[88:91], v[160:175]
    ds_read_b128 v[24:27], v2 offset:41984
    v_cvt_pk_bf16_f32 v199, v206, v207
    v_max3_f32 v8, v208, v209, v210
    v_max3_f32 v8, v8, v211, v212
    s_waitcnt lgkmcnt(5)
    v_mfma_f32_32x32x16_bf16 v[128:143], v[36:39], v[180:183], v[128:143]
    ds_read_b128 v[28:31], v4 offset:9216
    v_max3_f32 v8, v8, v213, v214
    v_max3_f32 v8, v8, v215, v216
    v_max3_f32 v8, v8, v217, v218
    s_waitcnt lgkmcnt(5)
    v_mfma_f32_32x32x16_bf16 v[160:175], v[40:43], v[92:95], v[160:175]
    ds_read_b128 v[32:35], v2 offset:43008
    v_max3_f32 v8, v8, v219, v220
    v_max3_f32 v8, v8, v221, v222
    v_max_f32 v8, v8, v223
    s_waitcnt lgkmcnt(5)
    v_mfma_f32_32x32x16_bf16 v[144:159], v[44:47], v[180:183], v[144:159]
    ds_read_b128 v[36:39], v4 offset:10240
    v_cmp_lt_f32 vcc, s30, v8
    s_nop 0
    s_cbranch_vccnz L_fix11
L_ret11:
    s_waitcnt lgkmcnt(5)
    v_mfma_f32_32x32x16_bf16 v[176:191], v[16:19], v[64:67], v[48:63]
    ds_read_b128 v[40:43], v2 offset:44032
    v_exp_f32 v208, v208
    v_exp_f32 v209, v209
    v_exp_f32 v210, v210
    v_exp_f32 v211, v211
    buffer_load_dwordx4 v[232:235], v1, s[4:7], s34 offen offset:2048 sc1
    s_waitcnt lgkmcnt(5)
    v_mfma_f32_32x32x16_bf16 v[96:111], v[20:23], v[192:195], v[96:111]
    ds_read_b128 v[44:47], v4 offset:11264
    v_exp_f32 v212, v212
    v_exp_f32 v213, v213
    v_exp_f32 v214, v214
    s_waitcnt lgkmcnt(5)
    v_mfma_f32_32x32x16_bf16 v[176:191], v[24:27], v[68:71], v[176:191]
    ds_read_b128 v[16:19], v3 offset:40960
    v_exp_f32 v215, v215
    v_exp_f32 v216, v216
    v_add_f32 v7, v7, v208
    s_waitcnt lgkmcnt(5)
    v_mfma_f32_32x32x16_bf16 v[112:127], v[28:31], v[192:195], v[112:127]
    ds_read_b128 v[20:23], v4 offset:12288
    v_exp_f32 v217, v217
    v_add_f32 v6, v6, v209
    v_exp_f32 v218, v218
    s_waitcnt lgkmcnt(5)
    v_mfma_f32_32x32x16_bf16 v[176:191], v[32:35], v[72:75], v[176:191]
    ds_read_b128 v[24:27], v3 offset:41984
    v_add_f32 v7, v7, v210
    v_exp_f32 v219, v219
    v_add_f32 v6, v6, v211
    s_waitcnt lgkmcnt(5)
    v_mfma_f32_32x32x16_bf16 v[128:143], v[36:39], v[192:195], v[128:143]
    ds_read_b128 v[28:31], v4 offset:13312
    v_exp_f32 v220, v220
    v_add_f32 v7, v7, v212
    v_exp_f32 v221, v221
    v_add_f32 v6, v6, v213
    s_waitcnt lgkmcnt(5)
    v_mfma_f32_32x32x16_bf16 v[176:191], v[40:43], v[76:79], v[176:191]
    ds_read_b128 v[32:35], v3 offset:43008
    v_exp_f32 v222, v222
    v_add_f32 v7, v7, v214
    v_exp_f32 v223, v223
    s_waitcnt lgkmcnt(5)
    v_mfma_f32_32x32x16_bf16 v[144:159], v[44:47], v[192:195], v[144:159]
    ds_read_b128 v[36:39], v4 offset:14336
    v_add_f32 v6, v6, v215
    v_cvt_pk_bf16_f32 v208, v208, v209
    v_cvt_pk_bf16_f32 v209, v210, v211
    s_waitcnt lgkmcnt(5)
    v_mfma_f32_32x32x16_bf16 v[176:191], v[16:19], v[80:83], v[176:191]
    ds_read_b128 v[40:43], v3 offset:44032
    v_cvt_pk_bf16_f32 v210, v212, v213
    v_cvt_pk_bf16_f32 v211, v214, v215
    v_add_f32 v7, v7, v216
    buffer_load_dwordx4 v[236:239], v1, s[4:7], s34 offen offset:3072 sc1
    s_waitcnt lgkmcnt(5)
    v_mfma_f32_32x32x16_bf16 v[96:111], v[20:23], v[196:199], v[96:111]
    ds_read_b128 v[44:47], v4 offset:15360
    v_add_f32 v6, v6, v217
    v_add_f32 v7, v7, v218
    v_add_f32 v6, v6, v219
    s_waitcnt lgkmcnt(5)
    v_mfma_f32_32x32x16_bf16 v[176:191], v[24:27], v[84:87], v[176:191]
    ds_read_b128 v[16:19], v2 offset:49152
    v_add_f32 v7, v7, v220
    v_add_f32 v6, v6, v221
    v_add_f32 v7, v7, v222
    v_add_f32 v6, v6, v223
    s_waitcnt lgkmcnt(5)
    v_mfma_f32_32x32x16_bf16 v[112:127], v[28:31], v[196:199], v[112:127]
    ds_read_b128 v[20:23], v4 offset:16384
    v_cvt_pk_bf16_f32 v212, v216, v217
    v_cvt_pk_bf16_f32 v213, v218, v219
    v_cvt_pk_bf16_f32 v214, v220, v221
    s_waitcnt lgkmcnt(5)
    v_mfma_f32_32x32x16_bf16 v[176:191], v[32:35], v[88:91], v[176:191]
    ds_read_b128 v[24:27], v2 offset:50176
    v_cvt_pk_bf16_f32 v215, v222, v223
    v_max3_f32 v8, v160, v161, v162
    v_max3_f32 v8, v8, v163, v164
    s_waitcnt lgkmcnt(5)
    v_mfma_f32_32x32x16_bf16 v[128:143], v[36:39], v[196:199], v[128:143]
    ds_read_b128 v[28:31], v4 offset:17408
    v_max3_f32 v8, v8, v165, v166
    v_max3_f32 v8, v8, v167, v168
    v_max3_f32 v8, v8, v169, v170
    s_waitcnt lgkmcnt(5)
    v_mfma_f32_32x32x16_bf16 v[176:191], v[40:43], v[92:95], v[176:191]
    ds_read_b128 v[32:35], v2 offset:51200
    v_max3_f32 v8, v8, v171, v172
    v_max3_f32 v8, v8, v173, v174
    v_max_f32 v8, v8, v175
    s_waitcnt lgkmcnt(5)
    v_mfma_f32_32x32x16_bf16 v[144:159], v[44:47], v[196:199], v[144:159]
    ds_read_b128 v[36:39], v4 offset:18432
    v_cmp_lt_f32 vcc, s30, v8
    s_nop 0
    s_cbranch_vccnz L_fix12
L_ret12:
    s_waitcnt lgkmcnt(5)
    v_mfma_f32_32x32x16_bf16 v[192:207], v[16:19], v[64:67], v[48:63]
    ds_read_b128 v[40:43], v2 offset:52224
    v_exp_f32 v160, v160
    v_exp_f32 v161, v161
    v_exp_f32 v162, v162
    v_exp_f32 v163, v163
    s_add_u32 s34, s18, 4096
    buffer_load_dwordx4 v[240:243], v1, s[4:7], s34 offen offset:0 sc1
    s_waitcnt lgkmcnt(5)
    v_mfma_f32_32x32x16_bf16 v[96:111], v[20:23], v[208:211], v[96:111]
    ds_read_b128 v[44:47], v4 offset:19456
    v_exp_f32 v164, v164
    v_exp_f32 v165, v165
    v_exp_f32 v166, v166
    s_waitcnt lgkmcnt(5)
    v_mfma_f32_32x32x16_bf16 v[192:207], v[24:27], v[68:71], v[192:207]
    ds_read_b128 v[16:19], v3 offset:49152
    v_exp_f32 v167, v167
    v_exp_f32 v168, v168
    v_add_f32 v7, v7, v160
    s_waitcnt lgkmcnt(5)
    v_mfma_f32_32x32x16_bf16 v[112:127], v[28:31], v[208:211], v[112:127]
    ds_read_b128 v[20:23], v4 offset:20480
    v_exp_f32 v169, v169
    v_add_f32 v6, v6, v161
    v_exp_f32 v170, v170
    s_waitcnt lgkmcnt(5)
    v_mfma_f32_32x32x16_bf16 v[192:207], v[32:35], v[72:75], v[192:207]
    ds_read_b128 v[24:27], v3 offset:50176
    v_add_f32 v7, v7, v162
    v_exp_f32 v171, v171
    v_add_f32 v6, v6, v163
    s_waitcnt lgkmcnt(5)
    v_mfma_f32_32x32x16_bf16 v[128:143], v[36:39], v[208:211], v[128:143]
    ds_read_b128 v[28:31], v4 offset:21504
    v_exp_f32 v172, v172
    v_add_f32 v7, v7, v164
    v_exp_f32 v173, v173
    v_add_f32 v6, v6, v165
    s_waitcnt lgkmcnt(5)
    v_mfma_f32_32x32x16_bf16 v[192:207], v[40:43], v[76:79], v[192:207]
    ds_read_b128 v[32:35], v3 offset:51200
    v_exp_f32 v174, v174
    v_add_f32 v7, v7, v166
    v_exp_f32 v175, v175
    s_waitcnt lgkmcnt(5)
    v_mfma_f32_32x32x16_bf16 v[144:159], v[44:47], v[208:211], v[144:159]
    ds_read_b128 v[36:39], v4 offset:22528
    v_add_f32 v6, v6, v167
    v_cvt_pk_bf16_f32 v160, v160, v161
    v_cvt_pk_bf16_f32 v161, v162, v163
    s_waitcnt lgkmcnt(5)
    v_mfma_f32_32x32x16_bf16 v[192:207], v[16:19], v[80:83], v[192:207]
    ds_read_b128 v[40:43], v3 offset:52224
    v_cvt_pk_bf16_f32 v162, v164, v165
    v_cvt_pk_bf16_f32 v163, v166, v167
    v_add_f32 v7, v7, v168
    buffer_load_dwordx4 v[244:247], v1, s[4:7], s34 offen offset:1024 sc1
    s_waitcnt lgkmcnt(5)
    v_mfma_f32_32x32x16_bf16 v[96:111], v[20:23], v[212:215], v[96:111]
    ds_read_b128 v[44:47], v4 offset:23552
    v_add_f32 v6, v6, v169
    v_add_f32 v7, v7, v170
    v_add_f32 v6, v6, v171
    s_waitcnt lgkmcnt(5)
    v_mfma_f32_32x32x16_bf16 v[192:207], v[24:27], v[84:87], v[192:207]
    ds_read_b128 v[16:19], v2 offset:57344
    v_add_f32 v7, v7, v172
    v_add_f32 v6, v6, v173
    v_add_f32 v7, v7, v174
    v_add_f32 v6, v6, v175
    s_waitcnt lgkmcnt(5)
    v_mfma_f32_32x32x16_bf16 v[112:127], v[28:31], v[212:215], v[112:127]
    ds_read_b128 v[20:23], v4 offset:24576
    v_cvt_pk_bf16_f32 v164, v168, v169
    v_cvt_pk_bf16_f32 v165, v170, v171
    v_cvt_pk_bf16_f32 v166, v172, v173
    s_waitcnt lgkmcnt(5)
    v_mfma_f32_32x32x16_bf16 v[192:207], v[32:35], v[88:91], v[192:207]
    ds_read_b128 v[24:27], v2 offset:58368
    v_cvt_pk_bf16_f32 v167, v174, v175
    v_max3_f32 v8, v176, v177, v178
    v_max3_f32 v8, v8, v179, v180
    s_waitcnt lgkmcnt(5)
    v_mfma_f32_32x32x16_bf16 v[128:143], v[36:39], v[212:215], v[128:143]
    ds_read_b128 v[28:31], v4 offset:25600
    v_max3_f32 v8, v8, v181, v182
    v_max3_f32 v8, v8, v183, v184
    v_max3_f32 v8, v8, v185, v186
    s_waitcnt lgkmcnt(5)
    v_mfma_f32_32x32x16_bf16 v[192:207], v[40:43], v[92:95], v[192:207]
    ds_read_b128 v[32:35], v2 offset:59392
    v_max3_f32 v8, v8, v187, v188
    v_max3_f32 v8, v8, v189, v190
    v_max_f32 v8, v8, v191
    s_waitcnt lgkmcnt(5)
    v_mfma_f32_32x32x16_bf16 v[144:159], v[44:47], v[212:215], v[144:159]
    ds_read_b128 v[36:39], v4 offset:26624
    v_cmp_lt_f32 vcc, s30, v8
    s_nop 0
    s_cbranch_vccnz L_fix13
L_ret13:
    s_waitcnt lgkmcnt(5)
    v_mfma_f32_32x32x16_bf16 v[208:223], v[16:19], v[64:67], v[48:63]
    ds_read_b128 v[40:43], v2 offset:60416
    v_exp_f32 v176, v176
    v_exp_f32 v177, v177
    v_exp_f32 v178, v178
    v_exp_f32 v179, v179
    buffer_load_dwordx4 v[248:251], v1, s[4:7], s34 offen offset:2048 sc1
    s_waitcnt lgkmcnt(5)
    v_mfma_f32_32x32x16_bf16 v[96:111], v[20:23], v[160:163], v[96:111]
    ds_read_b128 v[44:47], v4 offset:27648
    v_exp_f32 v180, v180
    v_exp_f32 v181, v181
    v_exp_f32 v182, v182
    s_waitcnt lgkmcnt(5)
    v_mfma_f32_32x32x16_bf16 v[208:223], v[24:27], v[68:71], v[208:223]
    ds_read_b128 v[16:19], v3 offset:57344
    v_exp_f32 v183, v183
    v_exp_f32 v184, v184
    v_add_f32 v7, v7, v176
    s_waitcnt lgkmcnt(5)
    v_mfma_f32_32x32x16_bf16 v[112:127], v[28:31], v[160:163], v[112:127]
    ds_read_b128 v[20:23], v4 offset:28672
    v_exp_f32 v185, v185
    v_add_f32 v6, v6, v177
    v_exp_f32 v186, v186
    s_waitcnt lgkmcnt(5)
    v_mfma_f32_32x32x16_bf16 v[208:223], v[32:35], v[72:75], v[208:223]
    ds_read_b128 v[24:27], v3 offset:58368
    v_add_f32 v7, v7, v178
    v_exp_f32 v187, v187
    v_add_f32 v6, v6, v179
    s_waitcnt lgkmcnt(5)
    v_mfma_f32_32x32x16_bf16 v[128:143], v[36:39], v[160:163], v[128:143]
    ds_read_b128 v[28:31], v4 offset:29696
    v_exp_f32 v188, v188
    v_add_f32 v7, v7, v180
    v_exp_f32 v189, v189
    v_add_f32 v6, v6, v181
    s_waitcnt lgkmcnt(5)
    v_mfma_f32_32x32x16_bf16 v[208:223], v[40:43], v[76:79], v[208:223]
    ds_read_b128 v[32:35], v3 offset:59392
    v_exp_f32 v190, v190
    v_add_f32 v7, v7, v182
    v_exp_f32 v191, v191
    s_waitcnt lgkmcnt(5)
    v_mfma_f32_32x32x16_bf16 v[144:159], v[44:47], v[160:163], v[144:159]
    ds_read_b128 v[36:39], v4 offset:30720
    v_add_f32 v6, v6, v183
    v_cvt_pk_bf16_f32 v176, v176, v177
    v_cvt_pk_bf16_f32 v177, v178, v179
    s_waitcnt lgkmcnt(5)
    v_mfma_f32_32x32x16_bf16 v[208:223], v[16:19], v[80:83], v[208:223]
    ds_read_b128 v[40:43], v3 offset:60416
    v_cvt_pk_bf16_f32 v178, v180, v181
    v_cvt_pk_bf16_f32 v179, v182, v183
    v_add_f32 v7, v7, v184
    buffer_load_dwordx4 v[252:255], v1, s[4:7], s34 offen offset:3072 sc1
    s_waitcnt lgkmcnt(5)
    v_mfma_f32_32x32x16_bf16 v[96:111], v[20:23], v[164:167], v[96:111]
    ds_read_b128 v[44:47], v4 offset:31744
    v_add_f32 v6, v6, v185
    v_add_f32 v7, v7, v186
    v_add_f32 v6, v6, v187
    s_waitcnt lgkmcnt(5)
    v_mfma_f32_32x32x16_bf16 v[208:223], v[24:27], v[84:87], v[208:223]
    ds_read_b128 v[16:19], v5 offset:8192
    v_add_f32 v7, v7, v188
    v_add_f32 v6, v6, v189
    v_add_f32 v7, v7, v190
    v_add_f32 v6, v6, v191
    s_waitcnt lgkmcnt(5)
    v_mfma_f32_32x32x16_bf16 v[112:127], v[28:31], v[164:167], v[112:127]
    ds_read_b128 v[20:23], v5 offset:9216
    v_cvt_pk_bf16_f32 v180, v184, v185
    v_cvt_pk_bf16_f32 v181, v186, v187
    v_cvt_pk_bf16_f32 v182, v188, v189
    s_waitcnt lgkmcnt(5)
    v_mfma_f32_32x32x16_bf16 v[208:223], v[32:35], v[88:91], v[208:223]
    ds_read_b128 v[24:27], v5 offset:10240
    v_cvt_pk_bf16_f32 v183, v190, v191
    v_max3_f32 v8, v192, v193, v194
    v_max3_f32 v8, v8, v195, v196
    s_waitcnt lgkmcnt(5)
    v_mfma_f32_32x32x16_bf16 v[128:143], v[36:39], v[164:167], v[128:143]
    ds_read_b128 v[28:31], v5 offset:11264
    v_max3_f32 v8, v8, v197, v198
    v_max3_f32 v8, v8, v199, v200
    v_max3_f32 v8, v8, v201, v202
    s_waitcnt lgkmcnt(5)
    v_mfma_f32_32x32x16_bf16 v[208:223], v[40:43], v[92:95], v[208:223]
    ds_read_b128 v[32:35], v5 offset:12288
    v_max3_f32 v8, v8, v203, v204
    v_max3_f32 v8, v8, v205, v206
    v_max_f32 v8, v8, v207
    s_waitcnt lgkmcnt(5)
    v_mfma_f32_32x32x16_bf16 v[144:159], v[44:47], v[164:167], v[144:159]
    ds_read_b128 v[36:39], v5 offset:13312
    v_cmp_lt_f32 vcc, s30, v8
    s_nop 0
    s_cbranch_vccnz L_fix14
L_ret14:
    s_waitcnt lgkmcnt(5)
    v_mfma_f32_32x32x16_bf16 v[96:111], v[16:19], v[176:179], v[96:111]
    ds_read_b128 v[40:43], v5 offset:14336
    v_exp_f32 v192, v192
    v_exp_f32 v193, v193
    v_exp_f32 v194, v194
    v_exp_f32 v195, v195
    v_exp_f32 v196, v196
    v_exp_f32 v197, v197
    v_exp_f32 v198, v198
    s_add_u32 s34, s18, 8192
    buffer_load_dwordx4 v[64:67], v1, s[4:7], s34 offen offset:0 sc1
    s_waitcnt lgkmcnt(5)
    v_mfma_f32_32x32x16_bf16 v[112:127], v[20:23], v[176:179], v[112:127]
    ds_read_b128 v[44:47], v5 offset:15360
    v_exp_f32 v199, v199
    v_exp_f32 v200, v200
    v_add_f32 v7, v7, v192
    v_exp_f32 v201, v201
    v_add_f32 v6, v6, v193
    v_exp_f32 v202, v202
    buffer_load_dwordx4 v[68:71], v1, s[4:7], s34 offen offset:1024 sc1
    s_waitcnt lgkmcnt(5)
    v_mfma_f32_32x32x16_bf16 v[128:143], v[24:27], v[176:179], v[128:143]
    ds_read_b128 v[16:19], v5 offset:16384
    v_add_f32 v7, v7, v194
    v_exp_f32 v203, v203
    v_add_f32 v6, v6, v195
    v_exp_f32 v204, v204
    v_add_f32 v7, v7, v196
    v_exp_f32 v205, v205
    v_add_f32 v6, v6, v197
    s_waitcnt lgkmcnt(5)
    v_mfma_f32_32x32x16_bf16 v[144:159], v[28:31], v[176:179], v[144:159]
    ds_read_b128 v[20:23], v5 offset:17408
    v_exp_f32 v206, v206
    v_add_f32 v7, v7, v198
    v_exp_f32 v207, v207
    v_add_f32 v6, v6, v199
    v_cvt_pk_bf16_f32 v192, v192, v193
    v_cvt_pk_bf16_f32 v193, v194, v195
    buffer_load_dwordx4 v[72:75], v1, s[4:7], s34 offen offset:2048 sc1
    s_waitcnt lgkmcnt(5)
    v_mfma_f32_32x32x16_bf16 v[96:111], v[32:35], v[180:183], v[96:111]
    ds_read_b128 v[24:27], v5 offset:18432
    v_cvt_pk_bf16_f32 v194, v196, v197
    v_cvt_pk_bf16_f32 v195, v198, v199
    v_add_f32 v7, v7, v200
    v_add_f32 v6, v6, v201
    v_add_f32 v7, v7, v202
    v_add_f32 v6, v6, v203
    buffer_load_dwordx4 v[76:79], v1, s[4:7], s34 offen offset:3072 sc1
    s_waitcnt lgkmcnt(5)
    v_mfma_f32_32x32x16_bf16 v[112:127], v[36:39], v[180:183], v[112:127]
    ds_read_b128 v[28:31], v5 offset:19456
    v_add_f32 v7, v7, v204
    v_add_f32 v6, v6, v205
    v_add_f32 v7, v7, v206
    v_add_f32 v6, v6, v207
    v_cvt_pk_bf16_f32 v196, v200, v201
    v_cvt_pk_bf16_f32 v197, v202, v203
    v_cvt_pk_bf16_f32 v198, v204, v205
    s_waitcnt lgkmcnt(5)
    v_mfma_f32_32x32x16_bf16 v[128:143], v[40:43], v[180:183], v[128:143]
    ds_read_b128 v[32:35], v5 offset:20480
    v_cvt_pk_bf16_f32 v199, v206, v207
    v_max3_f32 v8, v208, v209, v210
    v_max3_f32 v8, v8, v211, v212
    v_max3_f32 v8, v8, v213, v214
    v_max3_f32 v8, v8, v215, v216
    v_max3_f32 v8, v8, v217, v218
    s_add_u32 s34, s18, 12288
    buffer_load_dwordx4 v[80:83], v1, s[4:7], s34 offen offset:0 sc1
    s_waitcnt lgkmcnt(5)
    v_mfma_f32_32x32x16_bf16 v[144:159], v[44:47], v[180:183], v[144:159]
    ds_read_b128 v[36:39], v5 offset:21504
    v_max3_f32 v8, v8, v219, v220
    v_max3_f32 v8, v8, v221, v222
    v_max_f32 v8, v8, v223
    v_cmp_lt_f32 vcc, s30, v8
    s_nop 0
    s_cbranch_vccnz L_fix15
L_ret15:
    buffer_load_dwordx4 v[84:87], v1, s[4:7], s34 offen offset:1024 sc1
    s_waitcnt lgkmcnt(5)
    v_mfma_f32_32x32x16_bf16 v[96:111], v[16:19], v[192:195], v[96:111]
    ds_read_b128 v[40:43], v5 offset:22528
    v_exp_f32 v208, v208
    v_exp_f32 v209, v209
    v_exp_f32 v210, v210
    v_exp_f32 v211, v211
    v_exp_f32 v212, v212
    s_waitcnt lgkmcnt(5)
    v_mfma_f32_32x32x16_bf16 v[112:127], v[20:23], v[192:195], v[112:127]
    ds_read_b128 v[44:47], v5 offset:23552
    v_exp_f32 v213, v213
    v_exp_f32 v214, v214
    v_exp_f32 v215, v215
    v_exp_f32 v216, v216
    v_add_f32 v7, v7, v208
    buffer_load_dwordx4 v[88:91], v1, s[4:7], s34 offen offset:2048 sc1
    s_waitcnt lgkmcnt(5)
    v_mfma_f32_32x32x16_bf16 v[128:143], v[24:27], v[192:195], v[128:143]
    ds_read_b128 v[16:19], v5 offset:24576
    v_exp_f32 v217, v217
    v_add_f32 v6, v6, v209
    v_exp_f32 v218, v218
    v_add_f32 v7, v7, v210
    v_exp_f32 v219, v219
    buffer_load_dwordx4 v[92:95], v1, s[4:7], s34 offen offset:3072 sc1
    s_waitcnt lgkmcnt(5)
    v_mfma_f32_32x32x16_bf16 v[144:159], v[28:31], v[192:195], v[144:159]
    ds_read_b128 v[20:23], v5 offset:25600
    v_add_f32 v6, v6, v211
    v_exp_f32 v220, v220
    v_add_f32 v7, v7, v212
    v_exp_f32 v221, v221
    v_add_f32 v6, v6, v213
    s_waitcnt lgkmcnt(5)
    v_mfma_f32_32x32x16_bf16 v[96:111], v[32:35], v[196:199], v[96:111]
    ds_read_b128 v[24:27], v5 offset:26624
    v_exp_f32 v222, v222
    v_add_f32 v7, v7, v214
    v_exp_f32 v223, v223
    v_add_f32 v6, v6, v215
    v_cvt_pk_bf16_f32 v208, v208, v209
    s_add_u32 s34, s18, 16384
    buffer_load_dwordx4 v[48:51], v1, s[4:7], s34 offen offset:0 sc1
    s_waitcnt lgkmcnt(5)
    v_mfma_f32_32x32x16_bf16 v[112:127], v[36:39], v[196:199], v[112:127]
    ds_read_b128 v[28:31], v5 offset:27648
    v_cvt_pk_bf16_f32 v209, v210, v211
    v_cvt_pk_bf16_f32 v210, v212, v213
    v_cvt_pk_bf16_f32 v211, v214, v215
    v_add_f32 v7, v7, v216
    v_add_f32 v6, v6, v217
    buffer_load_dwordx4 v[52:55], v1, s[4:7], s34 offen offset:1024 sc1
    s_waitcnt lgkmcnt(5)
    v_mfma_f32_32x32x16_bf16 v[128:143], v[40:43], v[196:199], v[128:143]
    ds_read_b128 v[32:35], v5 offset:28672
    v_add_f32 v7, v7, v218
    v_add_f32 v6, v6, v219
    v_add_f32 v7, v7, v220
    v_add_f32 v6, v6, v221
    v_add_f32 v7, v7, v222
    s_waitcnt lgkmcnt(5)
    v_mfma_f32_32x32x16_bf16 v[144:159], v[44:47], v[196:199], v[144:159]
    ds_read_b128 v[36:39], v5 offset:29696
    v_add_f32 v6, v6, v223
    v_cvt_pk_bf16_f32 v212, v216, v217
    v_cvt_pk_bf16_f32 v213, v218, v219
    v_cvt_pk_bf16_f32 v214, v220, v221
    v_cvt_pk_bf16_f32 v215, v222, v223
    buffer_load_dwordx4 v[56:59], v1, s[4:7], s34 offen offset:2048 sc1
    s_waitcnt lgkmcnt(5)
    v_mfma_f32_32x32x16_bf16 v[96:111], v[16:19], v[208:211], v[96:111]
    ds_read_b128 v[40:43], v5 offset:30720
    buffer_load_dwordx4 v[60:63], v1, s[4:7], s34 offen offset:3072 sc1
    s_waitcnt lgkmcnt(5)
    v_mfma_f32_32x32x16_bf16 v[112:127], v[20:23], v[208:211], v[112:127]
    ds_read_b128 v[44:47], v5 offset:31744
    s_waitcnt lgkmcnt(5)
    v_mfma_f32_32x32x16_bf16 v[128:143], v[24:27], v[208:211], v[128:143]
    s_add_u32 s34, s18, 20480
    buffer_load_dwordx4 v[160:163], v1, s[4:7], s34 offen offset:0 sc1
    s_waitcnt lgkmcnt(4)
    v_mfma_f32_32x32x16_bf16 v[144:159], v[28:31], v[208:211], v[144:159]
    buffer_load_dwordx4 v[164:167], v1, s[4:7], s34 offen offset:1024 sc1
    s_waitcnt lgkmcnt(3)
    v_mfma_f32_32x32x16_bf16 v[96:111], v[32:35], v[212:215], v[96:111]
    s_waitcnt lgkmcnt(2)
    v_mfma_f32_32x32x16_bf16 v[112:127], v[36:39], v[212:215], v[112:127]
    buffer_load_dwordx4 v[168:171], v1, s[4:7], s34 offen offset:2048 sc1
    s_waitcnt lgkmcnt(1)
    v_mfma_f32_32x32x16_bf16 v[128:143], v[40:43], v[212:215], v[128:143]
    buffer_load_dwordx4 v[172:175], v1, s[4:7], s34 offen offset:3072 sc1
    s_waitcnt lgkmcnt(0)
    v_mfma_f32_32x32x16_bf16 v[144:159], v[44:47], v[212:215], v[144:159]
    v_add_f32 v6, v6, v7
    v_mov_b32 v9, v6
    s_nop 1
    v_permlane32_swap_b32 v6, v9
    v_add_f32 v6, v6, v9
    v_rcp_f32 v6, v6
    s_lshr_b32 s26, s12, 1
    s_lshl_b32 s26, s26, 13
    s_mul_i32 s24, s25, 98304
    s_add_u32 s26, s26, s24
    v_add_u32 v11, s26, v1
    v_mul_f32 v96, v96, v6
    v_mul_f32 v97, v97, v6
    v_mul_f32 v98, v98, v6
    v_mul_f32 v99, v99, v6
    v_mul_f32 v100, v100, v6
    v_mul_f32 v101, v101, v6
    v_mul_f32 v102, v102, v6
    v_mul_f32 v103, v103, v6
    v_mul_f32 v104, v104, v6
    v_mul_f32 v105, v105, v6
    v_mul_f32 v106, v106, v6
    v_mul_f32 v107, v107, v6
    v_mul_f32 v108, v108, v6
    v_mul_f32 v109, v109, v6
    v_mul_f32 v110, v110, v6
    v_mul_f32 v111, v111, v6
    v_cvt_pk_bf16_f32 v16, v96, v97
    v_cvt_pk_bf16_f32 v17, v98, v99
    v_cvt_pk_bf16_f32 v18, v100, v101
    v_cvt_pk_bf16_f32 v19, v102, v103
    ds_write_b128 v11, v[16:19] offset:0
    v_cvt_pk_bf16_f32 v20, v104, v105
    v_cvt_pk_bf16_f32 v21, v106, v107
    v_cvt_pk_bf16_f32 v22, v108, v109
    v_cvt_pk_bf16_f32 v23, v110, v111
    ds_write_b128 v11, v[20:23] offset:1024
    s_add_u32 s34, s18, 24576
    buffer_load_dwordx4 v[176:179], v1, s[4:7], s34 offen offset:0 sc1
    buffer_load_dwordx4 v[180:183], v1, s[4:7], s34 offen offset:1024 sc1
    buffer_load_dwordx4 v[184:187], v1, s[4:7], s34 offen offset:2048 sc1
    v_mul_f32 v112, v112, v6
    v_mul_f32 v113, v113, v6
    v_mul_f32 v114, v114, v6
    v_mul_f32 v115, v115, v6
    v_mul_f32 v116, v116, v6
    v_mul_f32 v117, v117, v6
    v_mul_f32 v118, v118, v6
    v_mul_f32 v119, v119, v6
    v_mul_f32 v120, v120, v6
    v_mul_f32 v121, v121, v6
    v_mul_f32 v122, v122, v6
    v_mul_f32 v123, v123, v6
    v_mul_f32 v124, v124, v6
    v_mul_f32 v125, v125, v6
    v_mul_f32 v126, v126, v6
    v_mul_f32 v127, v127, v6
    v_cvt_pk_bf16_f32 v24, v112, v113
    v_cvt_pk_bf16_f32 v25, v114, v115
    v_cvt_pk_bf16_f32 v26, v116, v117
    v_cvt_pk_bf16_f32 v27, v118, v119
    ds_write_b128 v11, v[24:27] offset:2048
    v_cvt_pk_bf16_f32 v28, v120, v121
    v_cvt_pk_bf16_f32 v29, v122, v123
    v_cvt_pk_bf16_f32 v30, v124, v125
    v_cvt_pk_bf16_f32 v31, v126, v127
    ds_write_b128 v11, v[28:31] offset:3072
    buffer_load_dwordx4 v[188:191], v1, s[4:7], s34 offen offset:3072 sc1
    s_add_u32 s34, s18, 28672
    buffer_load_dwordx4 v[192:195], v1, s[4:7], s34 offen offset:0 sc1
    buffer_load_dwordx4 v[196:199], v1, s[4:7], s34 offen offset:1024 sc1
    v_mul_f32 v128, v128, v6
    v_mul_f32 v129, v129, v6
    v_mul_f32 v130, v130, v6
    v_mul_f32 v131, v131, v6
    v_mul_f32 v132, v132, v6
    v_mul_f32 v133, v133, v6
    v_mul_f32 v134, v134, v6
    v_mul_f32 v135, v135, v6
    v_mul_f32 v136, v136, v6
    v_mul_f32 v137, v137, v6
    v_mul_f32 v138, v138, v6
    v_mul_f32 v139, v139, v6
    v_mul_f32 v140, v140, v6
    v_mul_f32 v141, v141, v6
    v_mul_f32 v142, v142, v6
    v_mul_f32 v143, v143, v6
    v_cvt_pk_bf16_f32 v32, v128, v129
    v_cvt_pk_bf16_f32 v33, v130, v131
    v_cvt_pk_bf16_f32 v34, v132, v133
    v_cvt_pk_bf16_f32 v35, v134, v135
    ds_write_b128 v11, v[32:35] offset:4096
    v_cvt_pk_bf16_f32 v36, v136, v137
    v_cvt_pk_bf16_f32 v37, v138, v139
    v_cvt_pk_bf16_f32 v38, v140, v141
    v_cvt_pk_bf16_f32 v39, v142, v143
    ds_write_b128 v11, v[36:39] offset:5120
    buffer_load_dwordx4 v[200:203], v1, s[4:7], s34 offen offset:2048 sc1
    buffer_load_dwordx4 v[204:207], v1, s[4:7], s34 offen offset:3072 sc1
    s_add_u32 s34, s18, 32768
    buffer_load_dwordx4 v[208:211], v1, s[4:7], s34 offen offset:0 sc1
    v_mul_f32 v144, v144, v6
    v_mul_f32 v145, v145, v6
    v_mul_f32 v146, v146, v6
    v_mul_f32 v147, v147, v6
    v_mul_f32 v148, v148, v6
    v_mul_f32 v149, v149, v6
    v_mul_f32 v150, v150, v6
    v_mul_f32 v151, v151, v6
    v_mul_f32 v152, v152, v6
    v_mul_f32 v153, v153, v6
    v_mul_f32 v154, v154, v6
    v_mul_f32 v155, v155, v6
    v_mul_f32 v156, v156, v6
    v_mul_f32 v157, v157, v6
    v_mul_f32 v158, v158, v6
    v_mul_f32 v159, v159, v6
    v_cvt_pk_bf16_f32 v40, v144, v145
    v_cvt_pk_bf16_f32 v41, v146, v147
    v_cvt_pk_bf16_f32 v42, v148, v149
    v_cvt_pk_bf16_f32 v43, v150, v151
    ds_write_b128 v11, v[40:43] offset:6144
    v_cvt_pk_bf16_f32 v44, v152, v153
    v_cvt_pk_bf16_f32 v45, v154, v155
    v_cvt_pk_bf16_f32 v46, v156, v157
    v_cvt_pk_bf16_f32 v47, v158, v159
    ds_write_b128 v11, v[44:47] offset:7168
    buffer_load_dwordx4 v[212:215], v1, s[4:7], s34 offen offset:1024 sc1
    buffer_load_dwordx4 v[216:219], v1, s[4:7], s34 offen offset:2048 sc1
    buffer_load_dwordx4 v[220:223], v1, s[4:7], s34 offen offset:3072 sc1
    s_waitcnt lgkmcnt(0)
    s_barrier
    s_lshl_b32 s26, s13, 21
    s_lshl_b32 s27, s14, 16
    s_add_u32 s26, s26, s27
    s_add_u32 s26, s26, s21
    s_add_u32 s26, s26, 16777216
    s_add_u32 s27, s26, 32768
    ds_read_b128 v[16:19], v1 offset:0
    ds_read_b128 v[20:23], v4 offset:32768
    ds_read_b128 v[24:27], v1 offset:1024
    ds_read_b128 v[28:31], v4 offset:33792
    ds_read_b128 v[32:35], v1 offset:2048
    ds_read_b128 v[36:39], v4 offset:34816
    s_waitcnt vmcnt(35) lgkmcnt(5)
    v_mfma_f32_32x32x16_bf16 v[96:111], v[224:227], v[16:19], 0
    s_waitcnt lgkmcnt(4)
    v_mfma_f32_32x32x16_bf16 v[112:127], v[224:227], v[20:23], 0
    s_add_u32 s34, s18, 36864
    buffer_load_dwordx4 v[224:227], v1, s[4:7], s34 offen offset:0 sc1
    ds_read_b128 v[40:43], v1 offset:3072
    ds_read_b128 v[44:47], v4 offset:35840
    s_waitcnt vmcnt(35) lgkmcnt(5)
    v_mfma_f32_32x32x16_bf16 v[96:111], v[228:231], v[24:27], v[96:111]
    s_waitcnt lgkmcnt(4)
    v_mfma_f32_32x32x16_bf16 v[112:127], v[228:231], v[28:31], v[112:127]
    buffer_load_dwordx4 v[228:231], v1, s[4:7], s34 offen offset:1024 sc1
    ds_read_b128 v[16:19], v1 offset:4096
    ds_read_b128 v[20:23], v4 offset:36864
    s_waitcnt vmcnt(35) lgkmcnt(5)
    v_mfma_f32_32x32x16_bf16 v[96:111], v[232:235], v[32:35], v[96:111]
    s_waitcnt lgkmcnt(4)
    v_mfma_f32_32x32x16_bf16 v[112:127], v[232:235], v[36:39], v[112:127]
    buffer_load_dwordx4 v[232:235], v1, s[4:7], s34 offen offset:2048 sc1
    ds_read_b128 v[24:27], v1 offset:5120
    ds_read_b128 v[28:31], v4 offset:37888
    s_waitcnt vmcnt(35) lgkmcnt(5)
    v_mfma_f32_32x32x16_bf16 v[96:111], v[236:239], v[40:43], v[96:111]
    s_waitcnt lgkmcnt(4)
    v_mfma_f32_32x32x16_bf16 v[112:127], v[236:239], v[44:47], v[112:127]
    buffer_load_dwordx4 v[236:239], v1, s[4:7], s34 offen offset:3072 sc1
    ds_read_b128 v[32:35], v1 offset:6144
    ds_read_b128 v[36:39], v4 offset:38912
    s_waitcnt vmcnt(35) lgkmcnt(5)
    v_mfma_f32_32x32x16_bf16 v[96:111], v[240:243], v[16:19], v[96:111]
    s_waitcnt lgkmcnt(4)
    v_mfma_f32_32x32x16_bf16 v[112:127], v[240:243], v[20:23], v[112:127]
    s_add_u32 s34, s18, 40960
    buffer_load_dwordx4 v[240:243], v1, s[4:7], s34 offen offset:0 sc1
    ds_read_b128 v[40:43], v1 offset:7168
    ds_read_b128 v[44:47], v4 offset:39936
    s_waitcnt vmcnt(35) lgkmcnt(5)
    v_mfma_f32_32x32x16_bf16 v[96:111], v[244:247], v[24:27], v[96:111]
    s_waitcnt lgkmcnt(4)
    v_mfma_f32_32x32x16_bf16 v[112:127], v[244:247], v[28:31], v[112:127]
    buffer_load_dwordx4 v[244:247], v1, s[4:7], s34 offen offset:1024 sc1
    ds_read_b128 v[16:19], v1 offset:8192
    ds_read_b128 v[20:23], v4 offset:40960
    s_waitcnt vmcnt(35) lgkmcnt(5)
    v_mfma_f32_32x32x16_bf16 v[96:111], v[248:251], v[32:35], v[96:111]
    s_waitcnt lgkmcnt(4)
    v_mfma_f32_32x32x16_bf16 v[112:127], v[248:251], v[36:39], v[112:127]
    buffer_load_dwordx4 v[248:251], v1, s[4:7], s34 offen offset:2048 sc1
    ds_read_b128 v[24:27], v1 offset:9216
    ds_read_b128 v[28:31], v4 offset:41984
    s_waitcnt vmcnt(35) lgkmcnt(5)
    v_mfma_f32_32x32x16_bf16 v[96:111], v[252:255], v[40:43], v[96:111]
    s_waitcnt lgkmcnt(4)
    v_mfma_f32_32x32x16_bf16 v[112:127], v[252:255], v[44:47], v[112:127]
    buffer_load_dwordx4 v[252:255], v1, s[4:7], s34 offen offset:3072 sc1
    ds_read_b128 v[32:35], v1 offset:10240
    ds_read_b128 v[36:39], v4 offset:43008
    s_waitcnt vmcnt(35) lgkmcnt(5)
    v_mfma_f32_32x32x16_bf16 v[96:111], v[64:67], v[16:19], v[96:111]
    s_waitcnt lgkmcnt(4)
    v_mfma_f32_32x32x16_bf16 v[112:127], v[64:67], v[20:23], v[112:127]
    s_add_u32 s34, s18, 45056
    buffer_load_dwordx4 v[64:67], v1, s[4:7], s34 offen offset:0 sc1
    ds_read_b128 v[40:43], v1 offset:11264
    ds_read_b128 v[44:47], v4 offset:44032
    s_waitcnt vmcnt(35) lgkmcnt(5)
    v_mfma_f32_32x32x16_bf16 v[96:111], v[68:71], v[24:27], v[96:111]
    s_waitcnt lgkmcnt(4)
    v_mfma_f32_32x32x16_bf16 v[112:127], v[68:71], v[28:31], v[112:127]
    buffer_load_dwordx4 v[68:71], v1, s[4:7], s34 offen offset:1024 sc1
    ds_read_b128 v[16:19], v1 offset:12288
    ds_read_b128 v[20:23], v4 offset:45056
    s_waitcnt vmcnt(35) lgkmcnt(5)
    v_mfma_f32_32x32x16_bf16 v[96:111], v[72:75], v[32:35], v[96:111]
    s_waitcnt lgkmcnt(4)
    v_mfma_f32_32x32x16_bf16 v[112:127], v[72:75], v[36:39], v[112:127]
    buffer_load_dwordx4 v[72:75], v1, s[4:7], s34 offen offset:2048 sc1
    ds_read_b128 v[24:27], v1 offset:13312
    ds_read_b128 v[28:31], v4 offset:46080
    s_waitcnt vmcnt(35) lgkmcnt(5)
    v_mfma_f32_32x32x16_bf16 v[96:111], v[76:79], v[40:43], v[96:111]
    s_waitcnt lgkmcnt(4)
    v_mfma_f32_32x32x16_bf16 v[112:127], v[76:79], v[44:47], v[112:127]
    buffer_load_dwordx4 v[76:79], v1, s[4:7], s34 offen offset:3072 sc1
    ds_read_b128 v[32:35], v1 offset:14336
    ds_read_b128 v[36:39], v4 offset:47104
    s_waitcnt vmcnt(35) lgkmcnt(5)
    v_mfma_f32_32x32x16_bf16 v[96:111], v[80:83], v[16:19], v[96:111]
    s_waitcnt lgkmcnt(4)
    v_mfma_f32_32x32x16_bf16 v[112:127], v[80:83], v[20:23], v[112:127]
    s_add_u32 s34, s18, 49152
    buffer_load_dwordx4 v[80:83], v1, s[4:7], s34 offen offset:0 sc1
    ds_read_b128 v[40:43], v1 offset:15360
    ds_read_b128 v[44:47], v4 offset:48128
    s_waitcnt vmcnt(35) lgkmcnt(5)
    v_mfma_f32_32x32x16_bf16 v[96:111], v[84:87], v[24:27], v[96:111]
    s_waitcnt lgkmcnt(4)
    v_mfma_f32_32x32x16_bf16 v[112:127], v[84:87], v[28:31], v[112:127]
    buffer_load_dwordx4 v[84:87], v1, s[4:7], s34 offen offset:1024 sc1
    ds_read_b128 v[16:19], v1 offset:16384
    ds_read_b128 v[20:23], v4 offset:49152
    s_waitcnt vmcnt(35) lgkmcnt(5)
    v_mfma_f32_32x32x16_bf16 v[96:111], v[88:91], v[32:35], v[96:111]
    s_waitcnt lgkmcnt(4)
    v_mfma_f32_32x32x16_bf16 v[112:127], v[88:91], v[36:39], v[112:127]
    buffer_load_dwordx4 v[88:91], v1, s[4:7], s34 offen offset:2048 sc1
    ds_read_b128 v[24:27], v1 offset:17408
    ds_read_b128 v[28:31], v4 offset:50176
    s_waitcnt vmcnt(35) lgkmcnt(5)
    v_mfma_f32_32x32x16_bf16 v[96:111], v[92:95], v[40:43], v[96:111]
    s_waitcnt lgkmcnt(4)
    v_mfma_f32_32x32x16_bf16 v[112:127], v[92:95], v[44:47], v[112:127]
    buffer_load_dwordx4 v[92:95], v1, s[4:7], s34 offen offset:3072 sc1
    ds_read_b128 v[32:35], v1 offset:18432
    ds_read_b128 v[36:39], v4 offset:51200
    s_waitcnt vmcnt(35) lgkmcnt(5)
    v_mfma_f32_32x32x16_bf16 v[96:111], v[48:51], v[16:19], v[96:111]
    s_waitcnt lgkmcnt(4)
    v_mfma_f32_32x32x16_bf16 v[112:127], v[48:51], v[20:23], v[112:127]
    s_add_u32 s34, s18, 53248
    buffer_load_dwordx4 v[48:51], v1, s[4:7], s34 offen offset:0 sc1
    ds_read_b128 v[40:43], v1 offset:19456
    ds_read_b128 v[44:47], v4 offset:52224
    s_waitcnt vmcnt(35) lgkmcnt(5)
    v_mfma_f32_32x32x16_bf16 v[96:111], v[52:55], v[24:27], v[96:111]
    s_waitcnt lgkmcnt(4)
    v_mfma_f32_32x32x16_bf16 v[112:127], v[52:55], v[28:31], v[112:127]
    buffer_load_dwordx4 v[52:55], v1, s[4:7], s34 offen offset:1024 sc1
    ds_read_b128 v[16:19], v1 offset:20480
    ds_read_b128 v[20:23], v4 offset:53248
    s_waitcnt vmcnt(35) lgkmcnt(5)
    v_mfma_f32_32x32x16_bf16 v[96:111], v[56:59], v[32:35], v[96:111]
    s_waitcnt lgkmcnt(4)
    v_mfma_f32_32x32x16_bf16 v[112:127], v[56:59], v[36:39], v[112:127]
    buffer_load_dwordx4 v[56:59], v1, s[4:7], s34 offen offset:2048 sc1
    ds_read_b128 v[24:27], v1 offset:21504
    ds_read_b128 v[28:31], v4 offset:54272
    s_waitcnt vmcnt(35) lgkmcnt(5)
    v_mfma_f32_32x32x16_bf16 v[96:111], v[60:63], v[40:43], v[96:111]
    s_waitcnt lgkmcnt(4)
    v_mfma_f32_32x32x16_bf16 v[112:127], v[60:63], v[44:47], v[112:127]
    buffer_load_dwordx4 v[60:63], v1, s[4:7], s34 offen offset:3072 sc1
    ds_read_b128 v[32:35], v1 offset:22528
    ds_read_b128 v[36:39], v4 offset:55296
    s_waitcnt vmcnt(35) lgkmcnt(5)
    v_mfma_f32_32x32x16_bf16 v[96:111], v[160:163], v[16:19], v[96:111]
    s_waitcnt lgkmcnt(4)
    v_mfma_f32_32x32x16_bf16 v[112:127], v[160:163], v[20:23], v[112:127]
    s_add_u32 s34, s18, 57344
    buffer_load_dwordx4 v[160:163], v1, s[4:7], s34 offen offset:0 sc1
    ds_read_b128 v[40:43], v1 offset:23552
    ds_read_b128 v[44:47], v4 offset:56320
    s_waitcnt vmcnt(35) lgkmcnt(5)
    v_mfma_f32_32x32x16_bf16 v[96:111], v[164:167], v[24:27], v[96:111]
    s_waitcnt lgkmcnt(4)
    v_mfma_f32_32x32x16_bf16 v[112:127], v[164:167], v[28:31], v[112:127]
    buffer_load_dwordx4 v[164:167], v1, s[4:7], s34 offen offset:1024 sc1
    ds_read_b128 v[16:19], v1 offset:24576
    ds_read_b128 v[20:23], v4 offset:57344
    s_waitcnt vmcnt(35) lgkmcnt(5)
    v_mfma_f32_32x32x16_bf16 v[96:111], v[168:171], v[32:35], v[96:111]
    s_waitcnt lgkmcnt(4)
    v_mfma_f32_32x32x16_bf16 v[112:127], v[168:171], v[36:39], v[112:127]
    buffer_load_dwordx4 v[168:171], v1, s[4:7], s34 offen offset:2048 sc1
    ds_read_b128 v[24:27], v1 offset:25600
    ds_read_b128 v[28:31], v4 offset:58368
    s_waitcnt vmcnt(35) lgkmcnt(5)
    v_mfma_f32_32x32x16_bf16 v[96:111], v[172:175], v[40:43], v[96:111]
    s_waitcnt lgkmcnt(4)
    v_mfma_f32_32x32x16_bf16 v[112:127], v[172:175], v[44:47], v[112:127]
    buffer_load_dwordx4 v[172:175], v1, s[4:7], s34 offen offset:3072 sc1
    ds_read_b128 v[32:35], v1 offset:26624
    ds_read_b128 v[36:39], v4 offset:59392
    s_waitcnt vmcnt(35) lgkmcnt(5)
    v_mfma_f32_32x32x16_bf16 v[96:111], v[176:179], v[16:19], v[96:111]
    s_waitcnt lgkmcnt(4)
    v_mfma_f32_32x32x16_bf16 v[112:127], v[176:179], v[20:23], v[112:127]
    s_add_u32 s34, s18, 61440
    buffer_load_dwordx4 v[176:179], v1, s[4:7], s34 offen offset:0 sc1
    ds_read_b128 v[40:43], v1 offset:27648
    ds_read_b128 v[44:47], v4 offset:60416
    s_waitcnt vmcnt(35) lgkmcnt(5)
    v_mfma_f32_32x32x16_bf16 v[96:111], v[180:183], v[24:27], v[96:111]
    s_waitcnt lgkmcnt(4)
    v_mfma_f32_32x32x16_bf16 v[112:127], v[180:183], v[28:31], v[112:127]
    buffer_load_dwordx4 v[180:183], v1, s[4:7], s34 offen offset:1024 sc1
    ds_read_b128 v[16:19], v1 offset:28672
    ds_read_b128 v[20:23], v4 offset:61440
    s_waitcnt vmcnt(35) lgkmcnt(5)
    v_mfma_f32_32x32x16_bf16 v[96:111], v[184:187], v[32:35], v[96:111]
    s_waitcnt lgkmcnt(4)
    v_mfma_f32_32x32x16_bf16 v[112:127], v[184:187], v[36:39], v[112:127]
    buffer_load_dwordx4 v[184:187], v1, s[4:7], s34 offen offset:2048 sc1
    ds_read_b128 v[24:27], v1 offset:29696
    ds_read_b128 v[28:31], v4 offset:62464
    s_waitcnt vmcnt(35) lgkmcnt(5)
    v_mfma_f32_32x32x16_bf16 v[96:111], v[188:191], v[40:43], v[96:111]
    s_waitcnt lgkmcnt(4)
    v_mfma_f32_32x32x16_bf16 v[112:127], v[188:191], v[44:47], v[112:127]
    buffer_load_dwordx4 v[188:191], v1, s[4:7], s34 offen offset:3072 sc1
    ds_read_b128 v[32:35], v1 offset:30720
    ds_read_b128 v[36:39], v4 offset:63488
    s_waitcnt vmcnt(35) lgkmcnt(5)
    v_mfma_f32_32x32x16_bf16 v[96:111], v[192:195], v[16:19], v[96:111]
    s_waitcnt lgkmcnt(4)
    v_mfma_f32_32x32x16_bf16 v[112:127], v[192:195], v[20:23], v[112:127]
    ds_read_b128 v[40:43], v1 offset:31744
    ds_read_b128 v[44:47], v4 offset:64512
    s_waitcnt vmcnt(34) lgkmcnt(5)
    v_mfma_f32_32x32x16_bf16 v[96:111], v[196:199], v[24:27], v[96:111]
    s_waitcnt lgkmcnt(4)
    v_mfma_f32_32x32x16_bf16 v[112:127], v[196:199], v[28:31], v[112:127]
    ds_read_b128 v[16:19], v1 offset:0
    ds_read_b128 v[20:23], v4 offset:32768
    s_waitcnt vmcnt(33) lgkmcnt(5)
    v_mfma_f32_32x32x16_bf16 v[96:111], v[200:203], v[32:35], v[96:111]
    s_waitcnt lgkmcnt(4)
    v_mfma_f32_32x32x16_bf16 v[112:127], v[200:203], v[36:39], v[112:127]
    ds_read_b128 v[24:27], v1 offset:1024
    ds_read_b128 v[28:31], v4 offset:33792
    s_lshl_b32 s35, s2, 15
    s_add_u32 s35, s35, 24576
    s_cmp_eq_u32 s12, 6
    s_cselect_b32 s35, s35, 8388608
    v_lshlrev_b32 v11, 3, v1
    buffer_load_dword v0, v11, s[36:39], s35 offen
    s_waitcnt vmcnt(33) lgkmcnt(5)
    v_mfma_f32_32x32x16_bf16 v[96:111], v[204:207], v[40:43], v[96:111]
    s_waitcnt lgkmcnt(4)
    v_mfma_f32_32x32x16_bf16 v[112:127], v[204:207], v[44:47], v[112:127]
    ds_read_b128 v[32:35], v1 offset:2048
    ds_read_b128 v[36:39], v4 offset:34816
    s_lshl_b32 s35, s14, 3
    s_add_u32 s35, s35, s13
    s_lshl_b32 s35, s35, 13
    s_lshl_b32 s24, s12, 10
    s_add_u32 s35, s35, s24
    v_lshlrev_b32 v10, 3, v1
    v_and_b32 v10, 0x380, v10
    buffer_load_dword v0, v10, s[8:11], s35 offen
    s_waitcnt vmcnt(33) lgkmcnt(5)
    v_mfma_f32_32x32x16_bf16 v[128:143], v[208:211], v[16:19], 0
    s_waitcnt lgkmcnt(4)
    v_mfma_f32_32x32x16_bf16 v[144:159], v[208:211], v[20:23], 0
    ds_read_b128 v[40:43], v1 offset:3072
    ds_read_b128 v[44:47], v4 offset:35840
    s_waitcnt vmcnt(32) lgkmcnt(5)
    v_mfma_f32_32x32x16_bf16 v[128:143], v[212:215], v[24:27], v[128:143]
    s_waitcnt lgkmcnt(4)
    v_mfma_f32_32x32x16_bf16 v[144:159], v[212:215], v[28:31], v[144:159]
    ds_read_b128 v[16:19], v1 offset:4096
    ds_read_b128 v[20:23], v4 offset:36864
    s_waitcnt vmcnt(31) lgkmcnt(5)
    v_mfma_f32_32x32x16_bf16 v[128:143], v[216:219], v[32:35], v[128:143]
    s_waitcnt lgkmcnt(4)
    v_mfma_f32_32x32x16_bf16 v[144:159], v[216:219], v[36:39], v[144:159]
    ds_read_b128 v[24:27], v1 offset:5120
    ds_read_b128 v[28:31], v4 offset:37888
    s_waitcnt vmcnt(30) lgkmcnt(5)
    v_mfma_f32_32x32x16_bf16 v[128:143], v[220:223], v[40:43], v[128:143]
    s_waitcnt lgkmcnt(4)
    v_mfma_f32_32x32x16_bf16 v[144:159], v[220:223], v[44:47], v[144:159]
    ds_read_b128 v[32:35], v1 offset:6144
    ds_read_b128 v[36:39], v4 offset:38912
    v_cvt_pk_bf16_f32 v96, v96, v97
    v_cvt_pk_bf16_f32 v97, v98, v99
    s_waitcnt vmcnt(29) lgkmcnt(5)
    v_mfma_f32_32x32x16_bf16 v[128:143], v[224:227], v[16:19], v[128:143]
    s_waitcnt lgkmcnt(4)
    v_mfma_f32_32x32x16_bf16 v[144:159], v[224:227], v[20:23], v[144:159]
    ds_read_b128 v[40:43], v1 offset:7168
    ds_read_b128 v[44:47], v4 offset:39936
    v_cvt_pk_bf16_f32 v98, v100, v101
    v_cvt_pk_bf16_f32 v99, v102, v103
    s_waitcnt vmcnt(28) lgkmcnt(5)
    v_mfma_f32_32x32x16_bf16 v[128:143], v[228:231], v[24:27], v[128:143]
    s_waitcnt lgkmcnt(4)
    v_mfma_f32_32x32x16_bf16 v[144:159], v[228:231], v[28:31], v[144:159]
    ds_read_b128 v[16:19], v1 offset:8192
    ds_read_b128 v[20:23], v4 offset:40960
    buffer_store_dwordx4 v[96:99], v1, s[4:7], s26 offen offset:0 sc1
    v_cvt_pk_bf16_f32 v100, v104, v105
    s_waitcnt vmcnt(28) lgkmcnt(5)
    v_mfma_f32_32x32x16_bf16 v[128:143], v[232:235], v[32:35], v[128:143]
    s_waitcnt lgkmcnt(4)
    v_mfma_f32_32x32x16_bf16 v[144:159], v[232:235], v[36:39], v[144:159]
    ds_read_b128 v[24:27], v1 offset:9216
    ds_read_b128 v[28:31], v4 offset:41984
    v_cvt_pk_bf16_f32 v101, v106, v107
    v_cvt_pk_bf16_f32 v102, v108, v109
    s_waitcnt vmcnt(27) lgkmcnt(5)
    v_mfma_f32_32x32x16_bf16 v[128:143], v[236:239], v[40:43], v[128:143]
    s_waitcnt lgkmcnt(4)
    v_mfma_f32_32x32x16_bf16 v[144:159], v[236:239], v[44:47], v[144:159]
    ds_read_b128 v[32:35], v1 offset:10240
    ds_read_b128 v[36:39], v4 offset:43008
    v_cvt_pk_bf16_f32 v103, v110, v111
    buffer_store_dwordx4 v[100:103], v1, s[4:7], s26 offen offset:1024 sc1
    s_waitcnt vmcnt(27) lgkmcnt(5)
    v_mfma_f32_32x32x16_bf16 v[128:143], v[240:243], v[16:19], v[128:143]
    s_waitcnt lgkmcnt(4)
    v_mfma_f32_32x32x16_bf16 v[144:159], v[240:243], v[20:23], v[144:159]
    ds_read_b128 v[40:43], v1 offset:11264
    ds_read_b128 v[44:47], v4 offset:44032
    v_cvt_pk_bf16_f32 v112, v112, v113
    v_cvt_pk_bf16_f32 v113, v114, v115
    s_waitcnt vmcnt(26) lgkmcnt(5)
    v_mfma_f32_32x32x16_bf16 v[128:143], v[244:247], v[24:27], v[128:143]
    s_waitcnt lgkmcnt(4)
    v_mfma_f32_32x32x16_bf16 v[144:159], v[244:247], v[28:31], v[144:159]
    ds_read_b128 v[16:19], v1 offset:12288
    ds_read_b128 v[20:23], v4 offset:45056
    v_cvt_pk_bf16_f32 v114, v116, v117
    v_cvt_pk_bf16_f32 v115, v118, v119
    s_waitcnt vmcnt(25) lgkmcnt(5)
    v_mfma_f32_32x32x16_bf16 v[128:143], v[248:251], v[32:35], v[128:143]
    s_waitcnt lgkmcnt(4)
    v_mfma_f32_32x32x16_bf16 v[144:159], v[248:251], v[36:39], v[144:159]
    ds_read_b128 v[24:27], v1 offset:13312
    ds_read_b128 v[28:31], v4 offset:46080
    buffer_store_dwordx4 v[112:115], v1, s[4:7], s27 offen offset:0 sc1
    v_cvt_pk_bf16_f32 v116, v120, v121
    s_waitcnt vmcnt(25) lgkmcnt(5)
    v_mfma_f32_32x32x16_bf16 v[128:143], v[252:255], v[40:43], v[128:143]
    s_waitcnt lgkmcnt(4)
    v_mfma_f32_32x32x16_bf16 v[144:159], v[252:255], v[44:47], v[144:159]
    ds_read_b128 v[32:35], v1 offset:14336
    ds_read_b128 v[36:39], v4 offset:47104
    v_cvt_pk_bf16_f32 v117, v122, v123
    v_cvt_pk_bf16_f32 v118, v124, v125
    s_waitcnt vmcnt(24) lgkmcnt(5)
    v_mfma_f32_32x32x16_bf16 v[128:143], v[64:67], v[16:19], v[128:143]
    s_waitcnt lgkmcnt(4)
    v_mfma_f32_32x32x16_bf16 v[144:159], v[64:67], v[20:23], v[144:159]
    ds_read_b128 v[40:43], v1 offset:15360
    ds_read_b128 v[44:47], v4 offset:48128
    v_cvt_pk_bf16_f32 v119, v126, v127
    buffer_store_dwordx4 v[116:119], v1, s[4:7], s27 offen offset:1024 sc1
    s_waitcnt vmcnt(24) lgkmcnt(5)
    v_mfma_f32_32x32x16_bf16 v[128:143], v[68:71], v[24:27], v[128:143]
    s_waitcnt lgkmcnt(4)
    v_mfma_f32_32x32x16_bf16 v[144:159], v[68:71], v[28:31], v[144:159]
    ds_read_b128 v[16:19], v1 offset:16384
    ds_read_b128 v[20:23], v4 offset:49152
    s_waitcnt vmcnt(23) lgkmcnt(5)
    v_mfma_f32_32x32x16_bf16 v[128:143], v[72:75], v[32:35], v[128:143]
    s_waitcnt lgkmcnt(4)
    v_mfma_f32_32x32x16_bf16 v[144:159], v[72:75], v[36:39], v[144:159]
    ds_read_b128 v[24:27], v1 offset:17408
    ds_read_b128 v[28:31], v4 offset:50176
    s_waitcnt vmcnt(22) lgkmcnt(5)
    v_mfma_f32_32x32x16_bf16 v[128:143], v[76:79], v[40:43], v[128:143]
    s_waitcnt lgkmcnt(4)
    v_mfma_f32_32x32x16_bf16 v[144:159], v[76:79], v[44:47], v[144:159]
    ds_read_b128 v[32:35], v1 offset:18432
    ds_read_b128 v[36:39], v4 offset:51200
    s_waitcnt vmcnt(21) lgkmcnt(5)
    v_mfma_f32_32x32x16_bf16 v[128:143], v[80:83], v[16:19], v[128:143]
    s_waitcnt lgkmcnt(4)
    v_mfma_f32_32x32x16_bf16 v[144:159], v[80:83], v[20:23], v[144:159]
    ds_read_b128 v[40:43], v1 offset:19456
    ds_read_b128 v[44:47], v4 offset:52224
    s_waitcnt vmcnt(20) lgkmcnt(5)
    v_mfma_f32_32x32x16_bf16 v[128:143], v[84:87], v[24:27], v[128:143]
    s_waitcnt lgkmcnt(4)
    v_mfma_f32_32x32x16_bf16 v[144:159], v[84:87], v[28:31], v[144:159]
    ds_read_b128 v[16:19], v1 offset:20480
    ds_read_b128 v[20:23], v4 offset:53248
    s_waitcnt vmcnt(19) lgkmcnt(5)
    v_mfma_f32_32x32x16_bf16 v[128:143], v[88:91], v[32:35], v[128:143]
    s_waitcnt lgkmcnt(4)
    v_mfma_f32_32x32x16_bf16 v[144:159], v[88:91], v[36:39], v[144:159]
    ds_read_b128 v[24:27], v1 offset:21504
    ds_read_b128 v[28:31], v4 offset:54272
    s_waitcnt vmcnt(18) lgkmcnt(5)
    v_mfma_f32_32x32x16_bf16 v[128:143], v[92:95], v[40:43], v[128:143]
    s_waitcnt lgkmcnt(4)
    v_mfma_f32_32x32x16_bf16 v[144:159], v[92:95], v[44:47], v[144:159]
    ds_read_b128 v[32:35], v1 offset:22528
    ds_read_b128 v[36:39], v4 offset:55296
    s_waitcnt vmcnt(17) lgkmcnt(5)
    v_mfma_f32_32x32x16_bf16 v[128:143], v[48:51], v[16:19], v[128:143]
    s_waitcnt lgkmcnt(4)
    v_mfma_f32_32x32x16_bf16 v[144:159], v[48:51], v[20:23], v[144:159]
    ds_read_b128 v[40:43], v1 offset:23552
    ds_read_b128 v[44:47], v4 offset:56320
    s_waitcnt vmcnt(16) lgkmcnt(5)
    v_mfma_f32_32x32x16_bf16 v[128:143], v[52:55], v[24:27], v[128:143]
    s_waitcnt lgkmcnt(4)
    v_mfma_f32_32x32x16_bf16 v[144:159], v[52:55], v[28:31], v[144:159]
    ds_read_b128 v[16:19], v1 offset:24576
    ds_read_b128 v[20:23], v4 offset:57344
    s_waitcnt vmcnt(15) lgkmcnt(5)
    v_mfma_f32_32x32x16_bf16 v[128:143], v[56:59], v[32:35], v[128:143]
    s_waitcnt lgkmcnt(4)
    v_mfma_f32_32x32x16_bf16 v[144:159], v[56:59], v[36:39], v[144:159]
    ds_read_b128 v[24:27], v1 offset:25600
    ds_read_b128 v[28:31], v4 offset:58368
    s_waitcnt vmcnt(14) lgkmcnt(5)
    v_mfma_f32_32x32x16_bf16 v[128:143], v[60:63], v[40:43], v[128:143]
    s_waitcnt lgkmcnt(4)
    v_mfma_f32_32x32x16_bf16 v[144:159], v[60:63], v[44:47], v[144:159]
    ds_read_b128 v[32:35], v1 offset:26624
    ds_read_b128 v[36:39], v4 offset:59392
    s_waitcnt vmcnt(13) lgkmcnt(5)
    v_mfma_f32_32x32x16_bf16 v[128:143], v[160:163], v[16:19], v[128:143]
    s_waitcnt lgkmcnt(4)
    v_mfma_f32_32x32x16_bf16 v[144:159], v[160:163], v[20:23], v[144:159]
    ds_read_b128 v[40:43], v1 offset:27648
    ds_read_b128 v[44:47], v4 offset:60416
    s_waitcnt vmcnt(12) lgkmcnt(5)
    v_mfma_f32_32x32x16_bf16 v[128:143], v[164:167], v[24:27], v[128:143]
    s_waitcnt lgkmcnt(4)
    v_mfma_f32_32x32x16_bf16 v[144:159], v[164:167], v[28:31], v[144:159]
    ds_read_b128 v[16:19], v1 offset:28672
    ds_read_b128 v[20:23], v4 offset:61440
    s_waitcnt vmcnt(11) lgkmcnt(5)
    v_mfma_f32_32x32x16_bf16 v[128:143], v[168:171], v[32:35], v[128:143]
    s_waitcnt lgkmcnt(4)
    v_mfma_f32_32x32x16_bf16 v[144:159], v[168:171], v[36:39], v[144:159]
    ds_read_b128 v[24:27], v1 offset:29696
    ds_read_b128 v[28:31], v4 offset:62464
    s_waitcnt vmcnt(10) lgkmcnt(5)
    v_mfma_f32_32x32x16_bf16 v[128:143], v[172:175], v[40:43], v[128:143]
    s_waitcnt lgkmcnt(4)
    v_mfma_f32_32x32x16_bf16 v[144:159], v[172:175], v[44:47], v[144:159]
    ds_read_b128 v[32:35], v1 offset:30720
    ds_read_b128 v[36:39], v4 offset:63488
    s_waitcnt vmcnt(9) lgkmcnt(5)
    v_mfma_f32_32x32x16_bf16 v[128:143], v[176:179], v[16:19], v[128:143]
    s_waitcnt lgkmcnt(4)
    v_mfma_f32_32x32x16_bf16 v[144:159], v[176:179], v[20:23], v[144:159]
    ds_read_b128 v[40:43], v1 offset:31744
    ds_read_b128 v[44:47], v4 offset:64512
    s_waitcnt vmcnt(8) lgkmcnt(5)
    v_mfma_f32_32x32x16_bf16 v[128:143], v[180:183], v[24:27], v[128:143]
    s_waitcnt lgkmcnt(4)
    v_mfma_f32_32x32x16_bf16 v[144:159], v[180:183], v[28:31], v[144:159]
    s_waitcnt vmcnt(7) lgkmcnt(3)
    v_mfma_f32_32x32x16_bf16 v[128:143], v[184:187], v[32:35], v[128:143]
    s_waitcnt lgkmcnt(2)
    v_mfma_f32_32x32x16_bf16 v[144:159], v[184:187], v[36:39], v[144:159]
    s_waitcnt vmcnt(6) lgkmcnt(1)
    v_mfma_f32_32x32x16_bf16 v[128:143], v[188:191], v[40:43], v[128:143]
    s_waitcnt lgkmcnt(0)
    v_mfma_f32_32x32x16_bf16 v[144:159], v[188:191], v[44:47], v[144:159]
    s_nop 9
    v_cvt_pk_bf16_f32 v128, v128, v129
    v_cvt_pk_bf16_f32 v129, v130, v131
    v_cvt_pk_bf16_f32 v130, v132, v133
    v_cvt_pk_bf16_f32 v131, v134, v135
    buffer_store_dwordx4 v[128:131], v1, s[4:7], s26 offen offset:2048 sc1
    v_cvt_pk_bf16_f32 v132, v136, v137
    v_cvt_pk_bf16_f32 v133, v138, v139
    v_cvt_pk_bf16_f32 v134, v140, v141
    v_cvt_pk_bf16_f32 v135, v142, v143
    buffer_store_dwordx4 v[132:135], v1, s[4:7], s26 offen offset:3072 sc1
    v_cvt_pk_bf16_f32 v144, v144, v145
    v_cvt_pk_bf16_f32 v145, v146, v147
    v_cvt_pk_bf16_f32 v146, v148, v149
    v_cvt_pk_bf16_f32 v147, v150, v151
    buffer_store_dwordx4 v[144:147], v1, s[4:7], s27 offen offset:2048 sc1
    v_cvt_pk_bf16_f32 v148, v152, v153
    v_cvt_pk_bf16_f32 v149, v154, v155
    v_cvt_pk_bf16_f32 v150, v156, v157
    v_cvt_pk_bf16_f32 v151, v158, v159
    buffer_store_dwordx4 v[148:151], v1, s[4:7], s27 offen offset:3072 sc1
    s_and_b32 s41, s2, 1
    s_lshl_b32 s41, s41, 2
    s_bfe_u32 s40, s2, 0x20003
    s_add_u32 s41, s41, s40
    s_bfe_u32 s40, s2, 0x20001
    s_lshl_b32 s40, s40, 3
    s_lshr_b32 s42, s2, 5
    s_add_u32 s40, s40, s42
    s_lshl_b32 s42, s40, 18
    s_lshl_b32 s43, s12, 10
    v_lshrrev_b32 v15, 7, v1
    s_lshl_b32 s44, s12, 3
    v_add_u32 v15, s44, v15
    v_bfe_u32 v14, v15, 1, 3
    v_lshlrev_b32 v14, 4, v14
    v_and_b32 v13, 0x70, v1
    v_xor_b32 v14, v14, v13
    v_lshl_add_u32 v15, v15, 12, v14
    s_lshl_b32 s3, s14, 3
    s_add_u32 s3, s3, s13
    s_mul_i32 s18, s13, 7
    s_add_u32 s18, s18, s12
    s_lshl_b32 s19, s18, 14
    s_add_u32 s19, s19, 9437184
    s_cmp_eq_u32 s12, 7
    s_cselect_b32 s19, 268435456, s19
    s_add_u32 s17, s19, 917504
    s_waitcnt vmcnt(0)
    s_barrier
    s_cmp_eq_u32 s12, 7
    s_cbranch_scc1 L_h1_sync
    s_barrier
    buffer_load_dwordx4 v[128:131], v1, s[4:7], s17 offen offset:0 sc1
    buffer_load_dwordx4 v[132:135], v1, s[4:7], s19 offen offset:0 sc1
    buffer_load_dwordx4 v[136:139], v1, s[4:7], s17 offen offset:1024 sc1
    buffer_load_dwordx4 v[140:143], v1, s[4:7], s19 offen offset:1024 sc1
    buffer_load_dwordx4 v[144:147], v1, s[4:7], s17 offen offset:2048 sc1
    buffer_load_dwordx4 v[148:151], v1, s[4:7], s19 offen offset:2048 sc1
    buffer_load_dwordx4 v[152:155], v1, s[4:7], s17 offen offset:3072 sc1
    buffer_load_dwordx4 v[156:159], v1, s[4:7], s19 offen offset:3072 sc1
L_h1_mid:
    s_cmp_eq_u32 s12, 7
    s_cbranch_scc1 L_h1_poll0
L_h1_back:
    s_setprio 0
    s_barrier
    v_lshrrev_b32 v6, 4, v1
    v_and_b32 v7, 7, v6
    v_lshrrev_b32 v2, 3, v6
    s_lshl_b32 s15, s12, 3
    v_add_u32 v2, s15, v2
    v_lshlrev_b32 v3, 9, v2
    v_lshl_add_u32 v3, v7, 4, v3
    s_lshr_b32 s20, s3, 2
    s_lshl_b32 s20, s20, 15
    s_and_b32 s21, s3, 3
    s_lshl_b32 s21, s21, 7
    s_add_u32 s20, s20, s21
    v_lshlrev_b32 v4, 10, v7
    v_lshl_add_u32 v4, v2, 4, v4
    s_lshl_b32 s21, s3, 13
    v_lshlrev_b32 v5, 4, v2
    s_add_u32 s15, s20, 16777216
    buffer_load_dwordx4 v[16:19], v3, s[4:7], s15 offen sc1
    s_add_u32 s15, s20, 18874368
    buffer_load_dwordx4 v[20:23], v3, s[4:7], s15 offen sc1
    s_add_u32 s15, s20, 20971520
    buffer_load_dwordx4 v[24:27], v3, s[4:7], s15 offen sc1
    s_add_u32 s15, s20, 23068672
    buffer_load_dwordx4 v[28:31], v3, s[4:7], s15 offen sc1
    s_add_u32 s15, s20, 25165824
    buffer_load_dwordx4 v[32:35], v3, s[4:7], s15 offen sc1
    s_add_u32 s15, s20, 27262976
    buffer_load_dwordx4 v[36:39], v3, s[4:7], s15 offen sc1
    s_add_u32 s15, s20, 29360128
    buffer_load_dwordx4 v[40:43], v3, s[4:7], s15 offen sc1
    s_add_u32 s15, s20, 31457280
    buffer_load_dwordx4 v[44:47], v3, s[4:7], s15 offen sc1
    buffer_load_dwordx4 v[48:51], v4, s[8:11], s21 offen
    s_mov_b32 s15, 18432
    buffer_load_dwordx4 v[52:55], v5, s[4:7], s15 offen offset:0 sc1
    buffer_load_dwordx4 v[56:59], v5, s[4:7], s15 offen offset:1024 sc1
    buffer_load_dwordx4 v[60:63], v5, s[4:7], s15 offen offset:2048 sc1
    s_waitcnt vmcnt(11)
    v_lshlrev_b32 v80, 16, v16
    v_and_b32 v81, s28, v16
    v_lshlrev_b32 v82, 16, v17
    v_and_b32 v83, s28, v17
    v_lshlrev_b32 v84, 16, v18
    v_and_b32 v85, s28, v18
    v_lshlrev_b32 v86, 16, v19
    v_and_b32 v87, s28, v19
    s_waitcnt vmcnt(10)
    v_lshlrev_b32 v88, 16, v20
    v_and_b32 v89, s28, v20
    v_lshlrev_b32 v90, 16, v21
    v_and_b32 v91, s28, v21
    v_lshlrev_b32 v92, 16, v22
    v_and_b32 v93, s28, v22
    v_lshlrev_b32 v94, 16, v23
    v_and_b32 v95, s28, v23
    v_add_f32 v80, v80, v88
    v_add_f32 v81, v81, v89
    v_add_f32 v82, v82, v90
    v_add_f32 v83, v83, v91
    v_add_f32 v84, v84, v92
    v_add_f32 v85, v85, v93
    v_add_f32 v86, v86, v94
    v_add_f32 v87, v87, v95
    s_add_u32 s17, s17, 4096
    buffer_load_dwordx4 v[160:163], v1, s[4:7], s17 offen offset:0 sc1
    s_add_u32 s19, s19, 4096
    buffer_load_dwordx4 v[164:167], v1, s[4:7], s19 offen offset:0 sc1
    s_waitcnt vmcnt(11)
    v_lshlrev_b32 v88, 16, v24
    v_and_b32 v89, s28, v24
    v_lshlrev_b32 v90, 16, v25
    v_and_b32 v91, s28, v25
    v_lshlrev_b32 v92, 16, v26
    v_and_b32 v93, s28, v26
    v_lshlrev_b32 v94, 16, v27
    v_and_b32 v95, s28, v27
    v_add_f32 v80, v80, v88
    v_add_f32 v81, v81, v89
    v_add_f32 v82, v82, v90
    v_add_f32 v83, v83, v91
    v_add_f32 v84, v84, v92
    v_add_f32 v85, v85, v93
    v_add_f32 v86, v86, v94
    v_add_f32 v87, v87, v95
    buffer_load_dwordx4 v[168:171], v1, s[4:7], s17 offen offset:1024 sc1
    buffer_load_dwordx4 v[172:175], v1, s[4:7], s19 offen offset:1024 sc1
    s_waitcnt vmcnt(12)
    v_lshlrev_b32 v88, 16, v28
    v_and_b32 v89, s28, v28
    v_lshlrev_b32 v90, 16, v29
    v_and_b32 v91, s28, v29
    v_lshlrev_b32 v92, 16, v30
    v_and_b32 v93, s28, v30
    v_lshlrev_b32 v94, 16, v31
    v_and_b32 v95, s28, v31
    v_add_f32 v80, v80, v88
    v_add_f32 v81, v81, v89
    v_add_f32 v82, v82, v90
    v_add_f32 v83, v83, v91
    v_add_f32 v84, v84, v92
    v_add_f32 v85, v85, v93
    v_add_f32 v86, v86, v94
    v_add_f32 v87, v87, v95
    buffer_load_dwordx4 v[176:179], v1, s[4:7], s17 offen offset:2048 sc1
    buffer_load_dwordx4 v[180:183], v1, s[4:7], s19 offen offset:2048 sc1
    s_waitcnt vmcnt(13)
    v_lshlrev_b32 v88, 16, v32
    v_and_b32 v89, s28, v32
    v_lshlrev_b32 v90, 16, v33
    v_and_b32 v91, s28, v33
    v_lshlrev_b32 v92, 16, v34
    v_and_b32 v93, s28, v34
    v_lshlrev_b32 v94, 16, v35
    v_and_b32 v95, s28, v35
    v_add_f32 v80, v80, v88
    v_add_f32 v81, v81, v89
    v_add_f32 v82, v82, v90
    v_add_f32 v83, v83, v91
    v_add_f32 v84, v84, v92
    v_add_f32 v85, v85, v93
    v_add_f32 v86, v86, v94
    v_add_f32 v87, v87, v95
    buffer_load_dwordx4 v[184:187], v1, s[4:7], s17 offen offset:3072 sc1
    buffer_load_dwordx4 v[188:191], v1, s[4:7], s19 offen offset:3072 sc1
    s_waitcnt vmcnt(14)
    v_lshlrev_b32 v88, 16, v36
    v_and_b32 v89, s28, v36
    v_lshlrev_b32 v90, 16, v37
    v_and_b32 v91, s28, v37
    v_lshlrev_b32 v92, 16, v38
    v_and_b32 v93, s28, v38
    v_lshlrev_b32 v94, 16, v39
    v_and_b32 v95, s28, v39
    v_add_f32 v80, v80, v88
    v_add_f32 v81, v81, v89
    v_add_f32 v82, v82, v90
    v_add_f32 v83, v83, v91
    v_add_f32 v84, v84, v92
    v_add_f32 v85, v85, v93
    v_add_f32 v86, v86, v94
    v_add_f32 v87, v87, v95
    s_waitcnt vmcnt(13)
    v_lshlrev_b32 v88, 16, v40
    v_and_b32 v89, s28, v40
    v_lshlrev_b32 v90, 16, v41
    v_and_b32 v91, s28, v41
    v_lshlrev_b32 v92, 16, v42
    v_and_b32 v93, s28, v42
    v_lshlrev_b32 v94, 16, v43
    v_and_b32 v95, s28, v43
    v_add_f32 v80, v80, v88
    v_add_f32 v81, v81, v89
    v_add_f32 v82, v82, v90
    v_add_f32 v83, v83, v91
    v_add_f32 v84, v84, v92
    v_add_f32 v85, v85, v93
    v_add_f32 v86, v86, v94
    v_add_f32 v87, v87, v95
    s_waitcnt vmcnt(12)
    v_lshlrev_b32 v88, 16, v44
    v_and_b32 v89, s28, v44
    v_lshlrev_b32 v90, 16, v45
    v_and_b32 v91, s28, v45
    v_lshlrev_b32 v92, 16, v46
    v_and_b32 v93, s28, v46
    v_lshlrev_b32 v94, 16, v47
    v_and_b32 v95, s28, v47
    v_add_f32 v80, v80, v88
    v_add_f32 v81, v81, v89
    v_add_f32 v82, v82, v90
    v_add_f32 v83, v83, v91
    v_add_f32 v84, v84, v92
    v_add_f32 v85, v85, v93
    v_add_f32 v86, v86, v94
    v_add_f32 v87, v87, v95
    s_waitcnt vmcnt(11)
    v_lshlrev_b32 v88, 16, v48
    v_and_b32 v89, s28, v48
    v_lshlrev_b32 v90, 16, v49
    v_and_b32 v91, s28, v49
    v_lshlrev_b32 v92, 16, v50
    v_and_b32 v93, s28, v50
    v_lshlrev_b32 v94, 16, v51
    v_and_b32 v95, s28, v51
    s_waitcnt vmcnt(10)
    v_lshlrev_b32 v96, 16, v52
    v_and_b32 v97, s28, v52
    v_lshlrev_b32 v98, 16, v53
    v_and_b32 v99, s28, v53
    v_lshlrev_b32 v100, 16, v54
    v_and_b32 v101, s28, v54
    v_lshlrev_b32 v102, 16, v55
    v_and_b32 v103, s28, v55
    s_waitcnt vmcnt(9)
    v_lshlrev_b32 v104, 16, v56
    v_and_b32 v105, s28, v56
    v_lshlrev_b32 v106, 16, v57
    v_and_b32 v107, s28, v57
    v_lshlrev_b32 v108, 16, v58
    v_and_b32 v109, s28, v58
    v_lshlrev_b32 v110, 16, v59
    v_and_b32 v111, s28, v59
    s_waitcnt vmcnt(8)
    v_lshlrev_b32 v112, 16, v60
    v_and_b32 v113, s28, v60
    v_lshlrev_b32 v114, 16, v61
    v_and_b32 v115, s28, v61
    v_lshlrev_b32 v116, 16, v62
    v_and_b32 v117, s28, v62
    v_lshlrev_b32 v118, 16, v63
    v_and_b32 v119, s28, v63
    v_fmac_f32 v88, v96, v80
    v_fmac_f32 v89, v97, v81
    v_fmac_f32 v90, v98, v82
    v_fmac_f32 v91, v99, v83
    v_fmac_f32 v92, v100, v84
    v_fmac_f32 v93, v101, v85
    v_fmac_f32 v94, v102, v86
    v_fmac_f32 v95, v103, v87
    v_cvt_pk_bf16_f32 v48, v88, v89
    v_cvt_pk_bf16_f32 v49, v90, v91
    v_cvt_pk_bf16_f32 v50, v92, v93
    v_cvt_pk_bf16_f32 v51, v94, v95
    s_add_u32 s15, s21, 33554432
    buffer_store_dwordx4 v[48:51], v4, s[4:7], s15 offen sc1
    v_lshlrev_b32 v80, 16, v48
    v_and_b32 v81, s28, v48
    v_lshlrev_b32 v82, 16, v49
    v_and_b32 v83, s28, v49
    v_lshlrev_b32 v84, 16, v50
    v_and_b32 v85, s28, v50
    v_lshlrev_b32 v86, 16, v51
    v_and_b32 v87, s28, v51
    v_add_f32 v8, v80, v81
    v_add_f32 v9, v82, v83
    v_add_f32 v10, v84, v85
    v_add_f32 v11, v86, v87
    v_add_f32 v8, v8, v9
    v_add_f32 v10, v10, v11
    v_add_f32 v8, v8, v10
    s_nop 1
    v_add_f32_dpp v8, v8, v8 row_ror:8 row_mask:0xf bank_mask:0xf
    v_mov_b32 v9, v8
    s_nop 1
    v_permlane16_swap_b32 v8, v9
    v_add_f32 v8, v8, v9
    v_mov_b32 v9, v8
    s_nop 1
    v_permlane32_swap_b32 v8, v9
    v_add_f32 v8, v8, v9
    v_lshlrev_b32 v12, 5, v7
    s_lshl_b32 s15, s12, 2
    v_add_u32 v13, s15, v12
    ds_write_b32 v13, v8
    s_waitcnt lgkmcnt(0)
    s_barrier
    ds_read_b128 v[16:19], v12
    ds_read_b128 v[20:23], v12 offset:16
    s_waitcnt lgkmcnt(1)
    v_add_f32 v16, v16, v17
    v_add_f32 v18, v18, v19
    s_waitcnt lgkmcnt(0)
    v_add_f32 v20, v20, v21
    v_add_f32 v22, v22, v23
    v_add_f32 v16, v16, v18
    v_add_f32 v20, v20, v22
    v_add_f32 v8, v16, v20
    v_mul_f32 v8, 0x3b000000, v8
    v_sub_f32 v80, v80, v8
    v_sub_f32 v81, v81, v8
    v_sub_f32 v82, v82, v8
    v_sub_f32 v83, v83, v8
    v_sub_f32 v84, v84, v8
    v_sub_f32 v85, v85, v8
    v_sub_f32 v86, v86, v8
    v_sub_f32 v87, v87, v8
    v_mul_f32 v8, v80, v80
    v_mul_f32 v9, v81, v81
    v_fmac_f32 v8, v82, v82
    v_fmac_f32 v9, v83, v83
    v_fmac_f32 v8, v84, v84
    v_fmac_f32 v9, v85, v85
    v_fmac_f32 v8, v86, v86
    v_fmac_f32 v9, v87, v87
    v_add_f32 v8, v8, v9
    s_nop 1
    v_add_f32_dpp v8, v8, v8 row_ror:8 row_mask:0xf bank_mask:0xf
    v_mov_b32 v9, v8
    s_nop 1
    v_permlane16_swap_b32 v8, v9
    v_add_f32 v8, v8, v9
    v_mov_b32 v9, v8
    s_nop 1
    v_permlane32_swap_b32 v8, v9
    v_add_f32 v8, v8, v9
    ds_write_b32 v13, v8 offset:256
    s_waitcnt lgkmcnt(0)
    s_barrier
    ds_read_b128 v[16:19], v12 offset:256
    ds_read_b128 v[20:23], v12 offset:272
    s_waitcnt lgkmcnt(1)
    v_add_f32 v16, v16, v17
    v_add_f32 v18, v18, v19
    s_waitcnt lgkmcnt(0)
    v_add_f32 v20, v20, v21
    v_add_f32 v22, v22, v23
    v_add_f32 v16, v16, v18
    v_add_f32 v20, v20, v22
    v_add_f32 v8, v16, v20
    v_mov_b32 v9, 0x3727c5ac
    v_fmac_f32 v9, 0x3b000000, v8
    v_rsq_f32 v9, v9
    s_nop 0
    v_mul_f32 v80, v80, v9
    v_mul_f32 v81, v81, v9
    v_mul_f32 v82, v82, v9
    v_mul_f32 v83, v83, v9
    v_mul_f32 v84, v84, v9
    v_mul_f32 v85, v85, v9
    v_mul_f32 v86, v86, v9
    v_mul_f32 v87, v87, v9
    v_fma_f32 v80, v80, v112, v104
    v_fma_f32 v81, v81, v113, v105
    v_fma_f32 v82, v82, v114, v106
    v_fma_f32 v83, v83, v115, v107
    v_fma_f32 v84, v84, v116, v108
    v_fma_f32 v85, v85, v117, v109
    v_fma_f32 v86, v86, v118, v110
    v_fma_f32 v87, v87, v119, v111
    v_cvt_pk_bf16_f32 v16, v80, v81
    v_cvt_pk_bf16_f32 v17, v82, v83
    v_cvt_pk_bf16_f32 v18, v84, v85
    v_cvt_pk_bf16_f32 v19, v86, v87
    s_lshr_b32 s15, s3, 1
    s_lshl_b32 s15, s15, 14
    s_and_b32 s20, s3, 1
    s_lshl_b32 s20, s20, 7
    s_add_u32 s15, s15, s20
    s_add_u32 s15, s15, 35651584
    v_lshlrev_b32 v3, 8, v2
    v_lshl_add_u32 v3, v7, 4, v3
    s_waitcnt vmcnt(0)
    buffer_store_dwordx4 v[16:19], v3, s[4:7], s15 offen sc1
    s_lshl_b32 s15, s12, 13
    s_lshl_b32 s16, s14, 16
    s_add_u32 s16, s16, s15
    s_add_u32 s16, s16, 35651584
    s_add_u32 s20, s16, 4096
    v_add_u32 v3, s15, v1
    s_mov_b32 s25, 0
L_h2_poll:
    buffer_load_dwordx4 v[64:67], v1, s[4:7], s16 offen offset:0 sc1
    buffer_load_dwordx4 v[68:71], v1, s[4:7], s16 offen offset:1024 sc1
    buffer_load_dwordx4 v[72:75], v1, s[4:7], s16 offen offset:2048 sc1
    buffer_load_dwordx4 v[76:79], v1, s[4:7], s16 offen offset:3072 sc1
    buffer_load_dwordx4 v[80:83], v1, s[4:7], s20 offen offset:0 sc1
    buffer_load_dwordx4 v[84:87], v1, s[4:7], s20 offen offset:1024 sc1
    buffer_load_dwordx4 v[88:91], v1, s[4:7], s20 offen offset:2048 sc1
    buffer_load_dwordx4 v[92:95], v1, s[4:7], s20 offen offset:3072 sc1
    s_waitcnt vmcnt(7)
    v_max_u32 v8, v64, v67
    s_waitcnt vmcnt(6)
    v_max3_u32 v8, v8, v68, v71
    s_waitcnt vmcnt(5)
    v_max3_u32 v8, v8, v72, v75
    s_waitcnt vmcnt(4)
    v_max3_u32 v8, v8, v76, v79
    s_waitcnt vmcnt(3)
    v_max3_u32 v8, v8, v80, v83
    s_waitcnt vmcnt(2)
    v_max3_u32 v8, v8, v84, v87
    s_waitcnt vmcnt(1)
    v_max3_u32 v8, v8, v88, v91
    s_waitcnt vmcnt(0)
    v_max3_u32 v8, v8, v92, v95
    v_cmp_eq_u32 vcc, -1, v8
    s_nop 0
    s_cbranch_vccnz L_h2_spin
L_h2_got:
    s_mov_b32 s20, 0xc0135761
    s_mov_b32 s21, 0xbdd2d3e8
    v_mov_b32 v4, s20
    v_lshrrev_b32 v2, 4, v1
    v_lshlrev_b32 v5, 6, v2
    s_lshl_b32 s22, s12, 3
    s_add_u32 s22, s22, 83456
    v_add_u32 v5, s22, v5
    ds_write_b128 v3, v[64:67] offset:0
    ds_write_b128 v3, v[68:71] offset:1024
    ds_write_b128 v3, v[72:75] offset:2048
    ds_write_b128 v3, v[76:79] offset:3072
    ds_write_b128 v3, v[80:83] offset:4096
    ds_write_b128 v3, v[84:87] offset:5120
    ds_write_b128 v3, v[88:91] offset:6144
    ds_write_b128 v3, v[92:95] offset:7168
    s_waitcnt lgkmcnt(0)
    s_barrier
    s_cmp_eq_u32 s12, 7
    s_cbranch_scc1 L_k4_helper
    ds_read_b128 v[64:67], v1 offset:0
    ds_read_b128 v[68:71], v1 offset:16384
    ds_read_b128 v[72:75], v1 offset:32768
    ds_read_b128 v[76:79], v1 offset:49152
    ds_read_b128 v[80:83], v1 offset:1024
    ds_read_b128 v[84:87], v1 offset:17408
    ds_read_b128 v[88:91], v1 offset:33792
    ds_read_b128 v[92:95], v1 offset:50176
    ds_read_b128 v[96:99], v1 offset:2048
    ds_read_b128 v[100:103], v1 offset:18432
    ds_read_b128 v[104:107], v1 offset:34816
    ds_read_b128 v[108:111], v1 offset:51200
    s_waitcnt lgkmcnt(8)
    v_mfma_f32_16x16x32_bf16 v[16:19], v[128:131], v[64:67], 0
    v_mfma_f32_16x16x32_bf16 v[20:23], v[128:131], v[68:71], 0
    s_add_u32 s17, s17, 4096
    buffer_load_dwordx4 v[192:195], v1, s[4:7], s17 offen offset:0 sc1
    v_mfma_f32_16x16x32_bf16 v[24:27], v[128:131], v[72:75], 0
    v_mfma_f32_16x16x32_bf16 v[28:31], v[128:131], v[76:79], 0
    v_mfma_f32_16x16x32_bf16 v[32:35], v[132:135], v[64:67], 0
    v_mfma_f32_16x16x32_bf16 v[36:39], v[132:135], v[68:71], 0
    buffer_load_dwordx4 v[196:199], v1, s[4:7], s17 offen offset:1024 sc1
    v_mfma_f32_16x16x32_bf16 v[40:43], v[132:135], v[72:75], 0
    v_mfma_f32_16x16x32_bf16 v[44:47], v[132:135], v[76:79], 0
    ds_read_b128 v[112:115], v1 offset:3072
    ds_read_b128 v[116:119], v1 offset:19456
    ds_read_b128 v[120:123], v1 offset:35840
    ds_read_b128 v[124:127], v1 offset:52224
    s_waitcnt lgkmcnt(8)
    v_mfma_f32_16x16x32_bf16 v[16:19], v[136:139], v[80:83], v[16:19]
    v_mfma_f32_16x16x32_bf16 v[20:23], v[136:139], v[84:87], v[20:23]
    buffer_load_dwordx4 v[200:203], v1, s[4:7], s17 offen offset:2048 sc1
    v_mfma_f32_16x16x32_bf16 v[24:27], v[136:139], v[88:91], v[24:27]
    v_mfma_f32_16x16x32_bf16 v[28:31], v[136:139], v[92:95], v[28:31]
    v_mfma_f32_16x16x32_bf16 v[32:35], v[140:143], v[80:83], v[32:35]
    v_mfma_f32_16x16x32_bf16 v[36:39], v[140:143], v[84:87], v[36:39]
    buffer_load_dwordx4 v[204:207], v1, s[4:7], s17 offen offset:3072 sc1
    v_mfma_f32_16x16x32_bf16 v[40:43], v[140:143], v[88:91], v[40:43]
    v_mfma_f32_16x16x32_bf16 v[44:47], v[140:143], v[92:95], v[44:47]
    ds_read_b128 v[64:67], v1 offset:4096
    ds_read_b128 v[68:71], v1 offset:20480
    ds_read_b128 v[72:75], v1 offset:36864
    ds_read_b128 v[76:79], v1 offset:53248
    s_waitcnt lgkmcnt(8)
    v_mfma_f32_16x16x32_bf16 v[16:19], v[144:147], v[96:99], v[16:19]
    v_mfma_f32_16x16x32_bf16 v[20:23], v[144:147], v[100:103], v[20:23]
    s_add_u32 s17, s17, 4096
    buffer_load_dwordx4 v[208:211], v1, s[4:7], s17 offen offset:0 sc1
    v_mfma_f32_16x16x32_bf16 v[24:27], v[144:147], v[104:107], v[24:27]
    v_mfma_f32_16x16x32_bf16 v[28:31], v[144:147], v[108:111], v[28:31]
    v_mfma_f32_16x16x32_bf16 v[32:35], v[148:151], v[96:99], v[32:35]
    v_mfma_f32_16x16x32_bf16 v[36:39], v[148:151], v[100:103], v[36:39]
    buffer_load_dwordx4 v[212:215], v1, s[4:7], s17 offen offset:1024 sc1
    v_mfma_f32_16x16x32_bf16 v[40:43], v[148:151], v[104:107], v[40:43]
    v_mfma_f32_16x16x32_bf16 v[44:47], v[148:151], v[108:111], v[44:47]
    ds_read_b128 v[80:83], v1 offset:5120
    ds_read_b128 v[84:87], v1 offset:21504
    ds_read_b128 v[88:91], v1 offset:37888
    ds_read_b128 v[92:95], v1 offset:54272
    s_waitcnt lgkmcnt(8)
    v_mfma_f32_16x16x32_bf16 v[16:19], v[152:155], v[112:115], v[16:19]
    v_mfma_f32_16x16x32_bf16 v[20:23], v[152:155], v[116:119], v[20:23]
    buffer_load_dwordx4 v[216:219], v1, s[4:7], s17 offen offset:2048 sc1
    v_mfma_f32_16x16x32_bf16 v[24:27], v[152:155], v[120:123], v[24:27]
    v_mfma_f32_16x16x32_bf16 v[28:31], v[152:155], v[124:127], v[28:31]
    v_mfma_f32_16x16x32_bf16 v[32:35], v[156:159], v[112:115], v[32:35]
    v_mfma_f32_16x16x32_bf16 v[36:39], v[156:159], v[116:119], v[36:39]
    buffer_load_dwordx4 v[220:223], v1, s[4:7], s17 offen offset:3072 sc1
    v_mfma_f32_16x16x32_bf16 v[40:43], v[156:159], v[120:123], v[40:43]
    v_mfma_f32_16x16x32_bf16 v[44:47], v[156:159], v[124:127], v[44:47]
    ds_read_b128 v[96:99], v1 offset:6144
    ds_read_b128 v[100:103], v1 offset:22528
    ds_read_b128 v[104:107], v1 offset:38912
    ds_read_b128 v[108:111], v1 offset:55296
    s_waitcnt lgkmcnt(8)
    v_mfma_f32_16x16x32_bf16 v[16:19], v[160:163], v[64:67], v[16:19]
    v_mfma_f32_16x16x32_bf16 v[20:23], v[160:163], v[68:71], v[20:23]
    s_add_u32 s19, s19, 4096
    buffer_load_dwordx4 v[224:227], v1, s[4:7], s19 offen offset:0 sc1
    v_mfma_f32_16x16x32_bf16 v[24:27], v[160:163], v[72:75], v[24:27]
    v_mfma_f32_16x16x32_bf16 v[28:31], v[160:163], v[76:79], v[28:31]
    v_mfma_f32_16x16x32_bf16 v[32:35], v[164:167], v[64:67], v[32:35]
    v_mfma_f32_16x16x32_bf16 v[36:39], v[164:167], v[68:71], v[36:39]
    buffer_load_dwordx4 v[228:231], v1, s[4:7], s19 offen offset:1024 sc1
    v_mfma_f32_16x16x32_bf16 v[40:43], v[164:167], v[72:75], v[40:43]
    v_mfma_f32_16x16x32_bf16 v[44:47], v[164:167], v[76:79], v[44:47]
    ds_read_b128 v[112:115], v1 offset:7168
    ds_read_b128 v[116:119], v1 offset:23552
    ds_read_b128 v[120:123], v1 offset:39936
    ds_read_b128 v[124:127], v1 offset:56320
    s_waitcnt lgkmcnt(8)
    v_mfma_f32_16x16x32_bf16 v[16:19], v[168:171], v[80:83], v[16:19]
    v_mfma_f32_16x16x32_bf16 v[20:23], v[168:171], v[84:87], v[20:23]
    buffer_load_dwordx4 v[232:235], v1, s[4:7], s19 offen offset:2048 sc1
    v_mfma_f32_16x16x32_bf16 v[24:27], v[168:171], v[88:91], v[24:27]
    v_mfma_f32_16x16x32_bf16 v[28:31], v[168:171], v[92:95], v[28:31]
    v_mfma_f32_16x16x32_bf16 v[32:35], v[172:175], v[80:83], v[32:35]
    v_mfma_f32_16x16x32_bf16 v[36:39], v[172:175], v[84:87], v[36:39]
    buffer_load_dwordx4 v[236:239], v1, s[4:7], s19 offen offset:3072 sc1
    v_mfma_f32_16x16x32_bf16 v[40:43], v[172:175], v[88:91], v[40:43]
    v_mfma_f32_16x16x32_bf16 v[44:47], v[172:175], v[92:95], v[44:47]
    ds_read_b128 v[128:131], v1 offset:8192
    ds_read_b128 v[132:135], v1 offset:24576
    ds_read_b128 v[136:139], v1 offset:40960
    ds_read_b128 v[140:143], v1 offset:57344
    s_waitcnt lgkmcnt(8)
    v_mfma_f32_16x16x32_bf16 v[16:19], v[176:179], v[96:99], v[16:19]
    v_mfma_f32_16x16x32_bf16 v[20:23], v[176:179], v[100:103], v[20:23]
    s_add_u32 s19, s19, 4096
    buffer_load_dwordx4 v[240:243], v1, s[4:7], s19 offen offset:0 sc1
    v_mfma_f32_16x16x32_bf16 v[24:27], v[176:179], v[104:107], v[24:27]
    v_mfma_f32_16x16x32_bf16 v[28:31], v[176:179], v[108:111], v[28:31]
    v_mfma_f32_16x16x32_bf16 v[32:35], v[180:183], v[96:99], v[32:35]
    v_mfma_f32_16x16x32_bf16 v[36:39], v[180:183], v[100:103], v[36:39]
    buffer_load_dwordx4 v[244:247], v1, s[4:7], s19 offen offset:1024 sc1
    v_mfma_f32_16x16x32_bf16 v[40:43], v[180:183], v[104:107], v[40:43]
    v_mfma_f32_16x16x32_bf16 v[44:47], v[180:183], v[108:111], v[44:47]
    ds_read_b128 v[144:147], v1 offset:9216
    ds_read_b128 v[148:151], v1 offset:25600
    ds_read_b128 v[152:155], v1 offset:41984
    ds_read_b128 v[156:159], v1 offset:58368
    s_waitcnt lgkmcnt(8)
    v_mfma_f32_16x16x32_bf16 v[16:19], v[184:187], v[112:115], v[16:19]
    v_mfma_f32_16x16x32_bf16 v[20:23], v[184:187], v[116:119], v[20:23]
    buffer_load_dwordx4 v[248:251], v1, s[4:7], s19 offen offset:2048 sc1
    v_mfma_f32_16x16x32_bf16 v[24:27], v[184:187], v[120:123], v[24:27]
    v_mfma_f32_16x16x32_bf16 v[28:31], v[184:187], v[124:127], v[28:31]
    v_mfma_f32_16x16x32_bf16 v[32:35], v[188:191], v[112:115], v[32:35]
    v_mfma_f32_16x16x32_bf16 v[36:39], v[188:191], v[116:119], v[36:39]
    buffer_load_dwordx4 v[252:255], v1, s[4:7], s19 offen offset:3072 sc1
    v_mfma_f32_16x16x32_bf16 v[40:43], v[188:191], v[120:123], v[40:43]
    v_mfma_f32_16x16x32_bf16 v[44:47], v[188:191], v[124:127], v[44:47]
    ds_read_b128 v[160:163], v1 offset:10240
    ds_read_b128 v[164:167], v1 offset:26624
    ds_read_b128 v[168:171], v1 offset:43008
    ds_read_b128 v[172:175], v1 offset:59392
    s_waitcnt lgkmcnt(8)
    s_waitcnt vmcnt(15)
    v_mfma_f32_16x16x32_bf16 v[16:19], v[192:195], v[128:131], v[16:19]
    ds_read_b128 v[176:179], v1 offset:11264
    ds_read_b128 v[180:183], v1 offset:27648
    ds_read_b128 v[184:187], v1 offset:44032
    ds_read_b128 v[188:191], v1 offset:60416
    v_mfma_f32_16x16x32_bf16 v[20:23], v[192:195], v[132:135], v[20:23]
    v_mfma_f32_16x16x32_bf16 v[24:27], v[192:195], v[136:139], v[24:27]
    v_mfma_f32_16x16x32_bf16 v[28:31], v[192:195], v[140:143], v[28:31]
    s_waitcnt lgkmcnt(8)
    s_waitcnt vmcnt(14)
    v_mfma_f32_16x16x32_bf16 v[16:19], v[196:199], v[144:147], v[16:19]
    ds_read_b128 v[64:67], v1 offset:12288
    ds_read_b128 v[68:71], v1 offset:28672
    ds_read_b128 v[72:75], v1 offset:45056
    ds_read_b128 v[76:79], v1 offset:61440
    v_mfma_f32_16x16x32_bf16 v[20:23], v[196:199], v[148:151], v[20:23]
    s_add_u32 m0, s43, 98304
    s_add_u32 s44, s42, 0
    buffer_load_dwordx4 v15, s[36:39], s44 offen lds
    v_mfma_f32_16x16x32_bf16 v[24:27], v[196:199], v[152:155], v[24:27]
    v_mfma_f32_16x16x32_bf16 v[28:31], v[196:199], v[156:159], v[28:31]
    s_waitcnt lgkmcnt(8)
    s_waitcnt vmcnt(14)
    v_mfma_f32_16x16x32_bf16 v[16:19], v[200:203], v[160:163], v[16:19]
    ds_read_b128 v[80:83], v1 offset:13312
    ds_read_b128 v[84:87], v1 offset:29696
    ds_read_b128 v[88:91], v1 offset:46080
    ds_read_b128 v[92:95], v1 offset:62464
    v_mfma_f32_16x16x32_bf16 v[20:23], v[200:203], v[164:167], v[20:23]
    s_add_u32 m0, s43, 106496
    s_add_u32 s44, s42, 2048
    buffer_load_dwordx4 v15, s[36:39], s44 offen lds
    v_mfma_f32_16x16x32_bf16 v[24:27], v[200:203], v[168:171], v[24:27]
    v_mfma_f32_16x16x32_bf16 v[28:31], v[200:203], v[172:175], v[28:31]
    s_waitcnt lgkmcnt(8)
    s_waitcnt vmcnt(14)
    v_mfma_f32_16x16x32_bf16 v[16:19], v[204:207], v[176:179], v[16:19]
    ds_read_b128 v[96:99], v1 offset:14336
    ds_read_b128 v[100:103], v1 offset:30720
    ds_read_b128 v[104:107], v1 offset:47104
    ds_read_b128 v[108:111], v1 offset:63488
    v_mfma_f32_16x16x32_bf16 v[20:23], v[204:207], v[180:183], v[20:23]
    s_add_u32 m0, s43, 114688
    s_add_u32 s44, s42, 128
    buffer_load_dwordx4 v15, s[36:39], s44 offen lds
    v_mfma_f32_16x16x32_bf16 v[24:27], v[204:207], v[184:187], v[24:27]
    v_mfma_f32_16x16x32_bf16 v[28:31], v[204:207], v[188:191], v[28:31]
    s_waitcnt lgkmcnt(8)
    s_waitcnt vmcnt(14)
    v_mfma_f32_16x16x32_bf16 v[16:19], v[208:211], v[64:67], v[16:19]
    ds_read_b128 v[112:115], v1 offset:15360
    ds_read_b128 v[116:119], v1 offset:31744
    ds_read_b128 v[120:123], v1 offset:48128
    ds_read_b128 v[124:127], v1 offset:64512
    v_mfma_f32_16x16x32_bf16 v[20:23], v[208:211], v[68:71], v[20:23]
    s_add_u32 m0, s43, 122880
    s_add_u32 s44, s42, 2176
    buffer_load_dwordx4 v15, s[36:39], s44 offen lds
    v_mfma_f32_16x16x32_bf16 v[24:27], v[208:211], v[72:75], v[24:27]
    v_mfma_f32_16x16x32_bf16 v[28:31], v[208:211], v[76:79], v[28:31]
    s_waitcnt lgkmcnt(8)
    s_waitcnt vmcnt(14)
    v_mfma_f32_16x16x32_bf16 v[16:19], v[212:215], v[80:83], v[16:19]
    v_mfma_f32_16x16x32_bf16 v[20:23], v[212:215], v[84:87], v[20:23]
    s_add_u32 m0, s43, 131072
    s_add_u32 s44, s42, 256
    buffer_load_dwordx4 v15, s[36:39], s44 offen lds
    v_mfma_f32_16x16x32_bf16 v[24:27], v[212:215], v[88:91], v[24:27]
    v_mfma_f32_16x16x32_bf16 v[28:31], v[212:215], v[92:95], v[28:31]
    s_waitcnt lgkmcnt(4)
    s_waitcnt vmcnt(14)
    v_mfma_f32_16x16x32_bf16 v[16:19], v[216:219], v[96:99], v[16:19]
    v_mfma_f32_16x16x32_bf16 v[20:23], v[216:219], v[100:103], v[20:23]
    s_add_u32 m0, s43, 139264
    s_add_u32 s44, s42, 2304
    buffer_load_dwordx4 v15, s[36:39], s44 offen lds
    v_mfma_f32_16x16x32_bf16 v[24:27], v[216:219], v[104:107], v[24:27]
    v_mfma_f32_16x16x32_bf16 v[28:31], v[216:219], v[108:111], v[28:31]
    s_waitcnt lgkmcnt(0)
    s_waitcnt vmcnt(14)
    v_mfma_f32_16x16x32_bf16 v[16:19], v[220:223], v[112:115], v[16:19]
    v_mfma_f32_16x16x32_bf16 v[20:23], v[220:223], v[116:119], v[20:23]
    s_add_u32 m0, s43, 147456
    s_add_u32 s44, s42, 384
    buffer_load_dwordx4 v15, s[36:39], s44 offen lds
    v_mfma_f32_16x16x32_bf16 v[24:27], v[220:223], v[120:123], v[24:27]
    v_mfma_f32_16x16x32_bf16 v[28:31], v[220:223], v[124:127], v[28:31]
    s_waitcnt vmcnt(14)
    v_mfma_f32_16x16x32_bf16 v[32:35], v[224:227], v[128:131], v[32:35]
    v_mfma_f32_16x16x32_bf16 v[36:39], v[224:227], v[132:135], v[36:39]
    s_add_u32 m0, s43, 155648
    s_add_u32 s44, s42, 2432
    buffer_load_dwordx4 v15, s[36:39], s44 offen lds
    v_mfma_f32_16x16x32_bf16 v[40:43], v[224:227], v[136:139], v[40:43]
    v_mul_f32 v48, v16, v16
    v_mul_f32 v49, v17, v17
    v_mul_f32 v50, v18, v18
    v_mul_f32 v51, v19, v19
    v_mul_f32 v52, v20, v20
    v_mul_f32 v53, v21, v21
    v_mul_f32 v54, v22, v22
    v_mul_f32 v55, v23, v23
    v_fma_f32 v48, v48, s21, v4
    v_fma_f32 v49, v49, s21, v4
    v_mfma_f32_16x16x32_bf16 v[44:47], v[224:227], v[140:143], v[44:47]
    v_fma_f32 v50, v50, s21, v4
    v_fma_f32 v51, v51, s21, v4
    v_fma_f32 v52, v52, s21, v4
    v_fma_f32 v53, v53, s21, v4
    v_fma_f32 v54, v54, s21, v4
    v_fma_f32 v55, v55, s21, v4
    v_mul_f32 v48, v48, v16
    v_mul_f32 v49, v49, v17
    v_mul_f32 v50, v50, v18
    v_mul_f32 v51, v51, v19
    v_mul_f32 v52, v52, v20
    s_waitcnt vmcnt(14)
    v_mfma_f32_16x16x32_bf16 v[32:35], v[228:231], v[144:147], v[32:35]
    v_mul_f32 v53, v53, v21
    v_mul_f32 v54, v54, v22
    v_mul_f32 v55, v55, v23
    v_exp_f32 v48, v48
    v_exp_f32 v49, v49
    v_exp_f32 v50, v50
    v_exp_f32 v51, v51
    v_exp_f32 v52, v52
    v_exp_f32 v53, v53
    v_exp_f32 v54, v54
    v_exp_f32 v55, v55
    v_mfma_f32_16x16x32_bf16 v[36:39], v[228:231], v[148:151], v[36:39]
    v_add_f32 v48, 1.0, v48
    v_add_f32 v49, 1.0, v49
    v_add_f32 v50, 1.0, v50
    v_add_f32 v51, 1.0, v51
    v_add_f32 v52, 1.0, v52
    v_add_f32 v53, 1.0, v53
    v_add_f32 v54, 1.0, v54
    v_add_f32 v55, 1.0, v55
    v_rcp_f32 v48, v48
    v_rcp_f32 v49, v49
    v_rcp_f32 v50, v50
    v_mfma_f32_16x16x32_bf16 v[40:43], v[228:231], v[152:155], v[40:43]
    v_rcp_f32 v51, v51
    v_rcp_f32 v52, v52
    v_rcp_f32 v53, v53
    v_rcp_f32 v54, v54
    v_rcp_f32 v55, v55
    v_mul_f32 v16, v16, v48
    v_mul_f32 v17, v17, v49
    v_mul_f32 v18, v18, v50
    v_mul_f32 v19, v19, v51
    v_mul_f32 v20, v20, v52
    v_mul_f32 v21, v21, v53
    v_mfma_f32_16x16x32_bf16 v[44:47], v[228:231], v[156:159], v[44:47]
    v_mul_f32 v22, v22, v54
    v_mul_f32 v23, v23, v55
    v_mul_f32 v56, v24, v24
    v_mul_f32 v57, v25, v25
    v_mul_f32 v58, v26, v26
    v_mul_f32 v59, v27, v27
    v_mul_f32 v60, v28, v28
    v_mul_f32 v61, v29, v29
    v_mul_f32 v62, v30, v30
    v_mul_f32 v63, v31, v31
    v_fma_f32 v56, v56, s21, v4
    s_waitcnt vmcnt(13)
    v_mfma_f32_16x16x32_bf16 v[32:35], v[232:235], v[160:163], v[32:35]
    v_fma_f32 v57, v57, s21, v4
    v_fma_f32 v58, v58, s21, v4
    v_fma_f32 v59, v59, s21, v4
    v_fma_f32 v60, v60, s21, v4
    v_fma_f32 v61, v61, s21, v4
    v_fma_f32 v62, v62, s21, v4
    v_fma_f32 v63, v63, s21, v4
    v_mul_f32 v56, v56, v24
    v_mul_f32 v57, v57, v25
    v_mul_f32 v58, v58, v26
    v_mul_f32 v59, v59, v27
    v_mfma_f32_16x16x32_bf16 v[36:39], v[232:235], v[164:167], v[36:39]
    v_mul_f32 v60, v60, v28
    v_mul_f32 v61, v61, v29
    v_mul_f32 v62, v62, v30
    v_mul_f32 v63, v63, v31
    v_exp_f32 v56, v56
    v_exp_f32 v57, v57
    v_exp_f32 v58, v58
    v_exp_f32 v59, v59
    v_exp_f32 v60, v60
    v_exp_f32 v61, v61
    v_exp_f32 v62, v62
    v_mfma_f32_16x16x32_bf16 v[40:43], v[232:235], v[168:171], v[40:43]
    v_exp_f32 v63, v63
    v_add_f32 v56, 1.0, v56
    v_add_f32 v57, 1.0, v57
    v_add_f32 v58, 1.0, v58
    v_add_f32 v59, 1.0, v59
    v_add_f32 v60, 1.0, v60
    v_add_f32 v61, 1.0, v61
    v_add_f32 v62, 1.0, v62
    v_add_f32 v63, 1.0, v63
    v_rcp_f32 v56, v56
    v_rcp_f32 v57, v57
    v_mfma_f32_16x16x32_bf16 v[44:47], v[232:235], v[172:175], v[44:47]
    v_rcp_f32 v58, v58
    v_rcp_f32 v59, v59
    v_rcp_f32 v60, v60
    v_rcp_f32 v61, v61
    v_rcp_f32 v62, v62
    v_rcp_f32 v63, v63
    v_mul_f32 v24, v24, v56
    v_mul_f32 v25, v25, v57
    v_mul_f32 v26, v26, v58
    v_mul_f32 v27, v27, v59
    v_mul_f32 v28, v28, v60
    s_waitcnt vmcnt(12)
    v_mfma_f32_16x16x32_bf16 v[32:35], v[236:239], v[176:179], v[32:35]
    v_mul_f32 v29, v29, v61
    v_mul_f32 v30, v30, v62
    v_mul_f32 v31, v31, v63
    v_add_f32 v48, v16, v17
    v_mul_f32 v52, v16, v16
    v_add_f32 v56, v18, v19
    v_fmac_f32 v52, v17, v17
    v_add_f32 v48, v48, v56
    v_fmac_f32 v52, v18, v18
    v_fmac_f32 v52, v19, v19
    v_add_f32 v49, v20, v21
    v_mfma_f32_16x16x32_bf16 v[36:39], v[236:239], v[180:183], v[36:39]
    v_mul_f32 v53, v20, v20
    v_add_f32 v56, v22, v23
    v_fmac_f32 v53, v21, v21
    v_add_f32 v49, v49, v56
    v_fmac_f32 v53, v22, v22
    v_fmac_f32 v53, v23, v23
    v_add_f32 v50, v24, v25
    v_mul_f32 v54, v24, v24
    v_add_f32 v56, v26, v27
    v_fmac_f32 v54, v25, v25
    v_add_f32 v50, v50, v56
    v_mfma_f32_16x16x32_bf16 v[40:43], v[236:239], v[184:187], v[40:43]
    v_fmac_f32 v54, v26, v26
    v_fmac_f32 v54, v27, v27
    v_add_f32 v51, v28, v29
    v_mul_f32 v55, v28, v28
    v_add_f32 v56, v30, v31
    v_fmac_f32 v55, v29, v29
    v_add_f32 v51, v51, v56
    v_fmac_f32 v55, v30, v30
    v_fmac_f32 v55, v31, v31
    v_permlane16_swap_b32 v48, v49
    v_permlane16_swap_b32 v50, v51
    v_mfma_f32_16x16x32_bf16 v[44:47], v[236:239], v[188:191], v[44:47]
    v_add_f32 v48, v48, v49
    v_add_f32 v50, v50, v51
    v_permlane16_swap_b32 v52, v53
    v_permlane16_swap_b32 v54, v55
    v_add_f32 v52, v52, v53
    v_add_f32 v54, v54, v55
    v_permlane32_swap_b32 v48, v50
    s_nop 0
    v_permlane32_swap_b32 v52, v54
    v_add_f32 v58, v48, v50
    v_add_f32 v59, v52, v54
    ds_write_b64 v5, v[58:59]
    s_waitcnt vmcnt(11)
    v_mfma_f32_16x16x32_bf16 v[32:35], v[240:243], v[64:67], v[32:35]
    s_waitcnt lgkmcnt(0)
    s_barrier
    v_mfma_f32_16x16x32_bf16 v[36:39], v[240:243], v[68:71], v[36:39]
    v_mfma_f32_16x16x32_bf16 v[40:43], v[240:243], v[72:75], v[40:43]
    v_mfma_f32_16x16x32_bf16 v[44:47], v[240:243], v[76:79], v[44:47]
    s_waitcnt vmcnt(10)
    v_mfma_f32_16x16x32_bf16 v[32:35], v[244:247], v[80:83], v[32:35]
    v_mfma_f32_16x16x32_bf16 v[36:39], v[244:247], v[84:87], v[36:39]
    v_mfma_f32_16x16x32_bf16 v[40:43], v[244:247], v[88:91], v[40:43]
    v_mfma_f32_16x16x32_bf16 v[44:47], v[244:247], v[92:95], v[44:47]
    s_waitcnt vmcnt(9)
    v_mfma_f32_16x16x32_bf16 v[32:35], v[248:251], v[96:99], v[32:35]
    v_mfma_f32_16x16x32_bf16 v[36:39], v[248:251], v[100:103], v[36:39]
    v_mfma_f32_16x16x32_bf16 v[40:43], v[248:251], v[104:107], v[40:43]
    v_mfma_f32_16x16x32_bf16 v[44:47], v[248:251], v[108:111], v[44:47]
    s_waitcnt vmcnt(8)
    v_mfma_f32_16x16x32_bf16 v[32:35], v[252:255], v[112:115], v[32:35]
    v_mfma_f32_16x16x32_bf16 v[36:39], v[252:255], v[116:119], v[36:39]
    v_mfma_f32_16x16x32_bf16 v[40:43], v[252:255], v[120:123], v[40:43]
    v_mfma_f32_16x16x32_bf16 v[44:47], v[252:255], v[124:127], v[44:47]
    v_and_b32 v6, 15, v2
    v_lshlrev_b32 v6, 4, v6
    v_lshrrev_b32 v7, 5, v2
    v_lshl_add_u32 v8, v7, 9, v6
    v_bfe_u32 v9, v2, 4, 1
    v_lshl_add_u32 v8, v9, 8, v8
    s_mul_i32 s17, s14, 114688
    s_lshl_b32 s19, s18, 10
    s_add_u32 s17, s17, s19
    s_add_u32 s17, s17, 37748736
    s_add_u32 s19, s17, 57344
    v_cvt_pk_bf16_f32 v64, v32, v33
    v_cvt_pk_bf16_f32 v65, v34, v35
    v_cvt_pk_bf16_f32 v66, v36, v37
    v_cvt_pk_bf16_f32 v67, v38, v39
    s_nop 0
    v_permlane16_swap_b32 v64, v66
    v_permlane16_swap_b32 v65, v67
    buffer_store_dwordx4 v[64:67], v8, s[4:7], s17 offen sc1
    v_cvt_pk_bf16_f32 v68, v40, v41
    v_cvt_pk_bf16_f32 v69, v42, v43
    v_cvt_pk_bf16_f32 v70, v44, v45
    v_cvt_pk_bf16_f32 v71, v46, v47
    s_nop 0
    v_permlane16_swap_b32 v68, v70
    v_permlane16_swap_b32 v69, v71
    buffer_store_dwordx4 v[68:71], v8, s[4:7], s19 offen sc1
    s_mul_i32 s17, s12, 2560
    s_add_u32 s17, s17, 65536
    v_and_b32 v10, 15, v2
    v_lshrrev_b32 v11, 4, v2
    v_mul_u32_u24 v12, 40, v10
    v_lshl_add_u32 v12, v11, 3, v12
    v_add_u32 v12, s17, v12
    v_bfe_u32 v13, v2, 2, 2
    v_lshl_add_u32 v13, v11, 3, v13
    v_mul_u32_u24 v13, 40, v13
    v_and_b32 v14, 1, v2
    v_lshl_add_u32 v13, v14, 4, v13
    v_bfe_u32 v14, v2, 1, 1
    v_lshl_add_u32 v13, v14, 3, v13
    v_add_u32 v13, s17, v13
    v_lshlrev_b32 v10, 3, v10
    v_add_u32 v10, 87552, v10
    v_lshl_add_u32 v6, v11, 9, v6
    s_lshr_b32 s17, s18, 1
    s_lshl_b32 s17, s17, 17
    s_and_b32 s19, s18, 1
    s_lshl_b32 s19, s19, 8
    s_add_u32 s17, s17, s19
    s_lshl_b32 s19, s14, 12
    s_add_u32 s17, s17, s19
    s_add_u32 s17, s17, 41943040
    s_barrier
    ds_read_b64 v[48:49], v10 offset:0
    ds_read_b64 v[50:51], v10 offset:128
    ds_read_b64 v[52:53], v10 offset:256
    ds_read_b64 v[54:55], v10 offset:384
    s_waitcnt lgkmcnt(3)
    v_sub_f32 v16, v16, v48
    v_sub_f32 v17, v17, v48
    v_sub_f32 v18, v18, v48
    v_sub_f32 v19, v19, v48
    v_mul_f32 v16, v16, v49
    v_mul_f32 v17, v17, v49
    v_mul_f32 v18, v18, v49
    v_mul_f32 v19, v19, v49
    v_cvt_pk_bf16_f32 v72, v16, v17
    v_cvt_pk_bf16_f32 v73, v18, v19
    ds_write_b64 v12, v[72:73] offset:0
    s_waitcnt lgkmcnt(3)
    v_sub_f32 v20, v20, v50
    v_sub_f32 v21, v21, v50
    v_sub_f32 v22, v22, v50
    v_sub_f32 v23, v23, v50
    v_mul_f32 v20, v20, v51
    v_mul_f32 v21, v21, v51
    v_mul_f32 v22, v22, v51
    v_mul_f32 v23, v23, v51
    v_cvt_pk_bf16_f32 v74, v20, v21
    v_cvt_pk_bf16_f32 v75, v22, v23
    ds_write_b64 v12, v[74:75] offset:640
    s_waitcnt lgkmcnt(3)
    v_sub_f32 v24, v24, v52
    v_sub_f32 v25, v25, v52
    v_sub_f32 v26, v26, v52
    v_sub_f32 v27, v27, v52
    v_mul_f32 v24, v24, v53
    v_mul_f32 v25, v25, v53
    v_mul_f32 v26, v26, v53
    v_mul_f32 v27, v27, v53
    v_cvt_pk_bf16_f32 v76, v24, v25
    v_cvt_pk_bf16_f32 v77, v26, v27
    ds_write_b64 v12, v[76:77] offset:1280
    s_waitcnt lgkmcnt(3)
    v_sub_f32 v28, v28, v54
    v_sub_f32 v29, v29, v54
    v_sub_f32 v30, v30, v54
    v_sub_f32 v31, v31, v54
    v_mul_f32 v28, v28, v55
    v_mul_f32 v29, v29, v55
    v_mul_f32 v30, v30, v55
    v_mul_f32 v31, v31, v55
    v_cvt_pk_bf16_f32 v78, v28, v29
    v_cvt_pk_bf16_f32 v79, v30, v31
    ds_write_b64 v12, v[78:79] offset:1920
    s_waitcnt lgkmcnt(0)
    ds_read_b64_tr_b16 v[80:81], v13 offset:0
    ds_read_b64_tr_b16 v[82:83], v13 offset:160
    ds_read_b64_tr_b16 v[84:85], v13 offset:1280
    ds_read_b64_tr_b16 v[86:87], v13 offset:1440
    s_waitcnt lgkmcnt(2)
    buffer_store_dwordx4 v[80:83], v6, s[4:7], s17 offen offset:0 sc1
    s_waitcnt lgkmcnt(0)
    buffer_store_dwordx4 v[84:87], v6, s[4:7], s17 offen offset:2048 sc1
    s_branch L_p5
L_k4_helper:
    s_setprio 3
    s_waitcnt vmcnt(0)
    v_lshlrev_b32 v5, 6, v2
    v_add_u32 v5, 83456, v5
    v_lshlrev_b32 v6, 3, v2
    s_lshl_b32 s23, s14, 12
    s_add_u32 s23, s23, 50331648
    s_lshl_b32 s19, s13, 9
    s_add_u32 s19, s19, s23
    v_mov_b32 v7, 0x7fc00000
    s_add_u32 m0, s43, 98304
    s_add_u32 s44, s42, 0
    buffer_load_dwordx4 v15, s[36:39], s44 offen lds
    s_add_u32 m0, s43, 106496
    s_add_u32 s44, s42, 2048
    buffer_load_dwordx4 v15, s[36:39], s44 offen lds
    s_add_u32 m0, s43, 114688
    s_add_u32 s44, s42, 128
    buffer_load_dwordx4 v15, s[36:39], s44 offen lds
    s_add_u32 m0, s43, 122880
    s_add_u32 s44, s42, 2176
    buffer_load_dwordx4 v15, s[36:39], s44 offen lds
    s_add_u32 m0, s43, 131072
    s_add_u32 s44, s42, 256
    buffer_load_dwordx4 v15, s[36:39], s44 offen lds
    s_add_u32 m0, s43, 139264
    s_add_u32 s44, s42, 2304
    buffer_load_dwordx4 v15, s[36:39], s44 offen lds
    s_add_u32 m0, s43, 147456
    s_add_u32 s44, s42, 384
    buffer_load_dwordx4 v15, s[36:39], s44 offen lds
    s_add_u32 m0, s43, 155648
    s_add_u32 s44, s42, 2432
    buffer_load_dwordx4 v15, s[36:39], s44 offen lds
    s_barrier
    ds_read_b128 v[64:67], v5 offset:0
    ds_read_b128 v[68:71], v5 offset:16
    ds_read_b128 v[72:75], v5 offset:32
    ds_read_b64 v[76:77], v5 offset:48
    s_waitcnt lgkmcnt(3)
    v_add_f32 v64, v64, v66
    v_add_f32 v65, v65, v67
    s_waitcnt lgkmcnt(2)
    v_add_f32 v64, v64, v68
    v_add_f32 v65, v65, v69
    v_add_f32 v64, v64, v70
    v_add_f32 v65, v65, v71
    s_waitcnt lgkmcnt(1)
    v_add_f32 v64, v64, v72
    v_add_f32 v65, v65, v73
    v_add_f32 v64, v64, v74
    v_add_f32 v65, v65, v75
    s_waitcnt lgkmcnt(0)
    v_add_f32 v64, v64, v76
    v_add_f32 v65, v65, v77
    v_cmp_eq_u32 vcc, -1, v64
    s_nop 1
    v_cndmask_b32 v64, v64, v7, vcc
    v_cmp_eq_u32 vcc, -1, v65
    s_nop 1
    v_cndmask_b32 v65, v65, v7, vcc
    buffer_store_dwordx2 v[64:65], v6, s[4:7], s19 offen sc1
    s_mov_b32 s22, 0
L_k4_poll:
    buffer_load_dwordx2 v[66:67], v6, s[4:7], s23 offen offset:0 sc1
    buffer_load_dwordx2 v[68:69], v6, s[4:7], s23 offen offset:512 sc1
    buffer_load_dwordx2 v[70:71], v6, s[4:7], s23 offen offset:1024 sc1
    buffer_load_dwordx2 v[72:73], v6, s[4:7], s23 offen offset:1536 sc1
    buffer_load_dwordx2 v[74:75], v6, s[4:7], s23 offen offset:2048 sc1
    buffer_load_dwordx2 v[76:77], v6, s[4:7], s23 offen offset:2560 sc1
    buffer_load_dwordx2 v[78:79], v6, s[4:7], s23 offen offset:3072 sc1
    buffer_load_dwordx2 v[80:81], v6, s[4:7], s23 offen offset:3584 sc1
    s_waitcnt vmcnt(7)
    v_cmp_ne_u32 vcc, -1, v66
    v_cmp_ne_u32 s[24:25], -1, v67
    s_nop 0
    s_and_b64 vcc, vcc, s[24:25]
    s_waitcnt vmcnt(6)
    v_cmp_ne_u32 s[24:25], -1, v68
    s_nop 0
    s_and_b64 vcc, vcc, s[24:25]
    v_cmp_ne_u32 s[24:25], -1, v69
    s_nop 0
    s_and_b64 vcc, vcc, s[24:25]
    s_waitcnt vmcnt(5)
    v_cmp_ne_u32 s[24:25], -1, v70
    s_nop 0
    s_and_b64 vcc, vcc, s[24:25]
    v_cmp_ne_u32 s[24:25], -1, v71
    s_nop 0
    s_and_b64 vcc, vcc, s[24:25]
    s_waitcnt vmcnt(4)
    v_cmp_ne_u32 s[24:25], -1, v72
    s_nop 0
    s_and_b64 vcc, vcc, s[24:25]
    v_cmp_ne_u32 s[24:25], -1, v73
    s_nop 0
    s_and_b64 vcc, vcc, s[24:25]
    s_waitcnt vmcnt(3)
    v_cmp_ne_u32 s[24:25], -1, v74
    s_nop 0
    s_and_b64 vcc, vcc, s[24:25]
    v_cmp_ne_u32 s[24:25], -1, v75
    s_nop 0
    s_and_b64 vcc, vcc, s[24:25]
    s_waitcnt vmcnt(2)
    v_cmp_ne_u32 s[24:25], -1, v76
    s_nop 0
    s_and_b64 vcc, vcc, s[24:25]
    v_cmp_ne_u32 s[24:25], -1, v77
    s_nop 0
    s_and_b64 vcc, vcc, s[24:25]
    s_waitcnt vmcnt(1)
    v_cmp_ne_u32 s[24:25], -1, v78
    s_nop 0
    s_and_b64 vcc, vcc, s[24:25]
    v_cmp_ne_u32 s[24:25], -1, v79
    s_nop 0
    s_and_b64 vcc, vcc, s[24:25]
    s_waitcnt vmcnt(0)
    v_cmp_ne_u32 s[24:25], -1, v80
    s_nop 0
    s_and_b64 vcc, vcc, s[24:25]
    v_cmp_ne_u32 s[24:25], -1, v81
    s_nop 0
    s_and_b64 vcc, vcc, s[24:25]
    s_cmp_eq_u64 vcc, -1
    s_cbranch_scc1 L_k4_got
    s_add_u32 s22, s22, 1
    s_cmp_lt_u32 s22, 0x100000
    s_sleep 1
    s_cbranch_scc1 L_k4_poll
L_k4_got:
    v_add_f32 v66, v66, v68
    v_add_f32 v67, v67, v69
    v_add_f32 v66, v66, v70
    v_add_f32 v67, v67, v71
    v_add_f32 v66, v66, v72
    v_add_f32 v67, v67, v73
    v_add_f32 v66, v66, v74
    v_add_f32 v67, v67, v75
    v_add_f32 v66, v66, v76
    v_add_f32 v67, v67, v77
    v_add_f32 v66, v66, v78
    v_add_f32 v67, v67, v79
    v_add_f32 v66, v66, v80
    v_add_f32 v67, v67, v81
    s_mov_b32 s22, 0x3a924925
    v_mul_f32 v66, s22, v66
    v_mul_f32 v67, s22, v67
    v_fma_f32 v67, -v66, v66, v67
    v_max_f32 v67, 0, v67
    v_add_f32 v67, 0x3727c5ac, v67
    v_rsq_f32 v67, v67
    v_add_u32 v6, 87552, v6
    ds_write_b64 v6, v[66:67]
    s_waitcnt lgkmcnt(0)
    s_barrier
L_p5:
    s_setprio 0
    s_waitcnt vmcnt(0) lgkmcnt(0)
    s_barrier
    s_cmp_eq_u32 s12, 7
    s_cbranch_scc1 L_g_sync
    s_barrier
L_g_mid:
    s_add_u32 m0, s43, 0
    s_add_u32 s44, s42, 512
    buffer_load_dwordx4 v15, s[36:39], s44 offen lds
    s_add_u32 m0, s43, 8192
    s_add_u32 s44, s42, 2560
    buffer_load_dwordx4 v15, s[36:39], s44 offen lds
    s_add_u32 m0, s43, 16384
    s_add_u32 s44, s42, 640
    buffer_load_dwordx4 v15, s[36:39], s44 offen lds
    s_add_u32 m0, s43, 24576
    s_add_u32 s44, s42, 2688
    buffer_load_dwordx4 v15, s[36:39], s44 offen lds
    s_add_u32 m0, s43, 32768
    s_add_u32 s44, s42, 768
    buffer_load_dwordx4 v15, s[36:39], s44 offen lds
    s_add_u32 m0, s43, 40960
    s_add_u32 s44, s42, 2816
    buffer_load_dwordx4 v15, s[36:39], s44 offen lds
    s_add_u32 m0, s43, 49152
    s_add_u32 s44, s42, 896
    buffer_load_dwordx4 v15, s[36:39], s44 offen lds
    s_add_u32 m0, s43, 57344
    s_add_u32 s44, s42, 2944
    buffer_load_dwordx4 v15, s[36:39], s44 offen lds
    s_load_dwordx2 s[28:29], s[0:1], 64
    s_mov_b32 s30, 4096
    s_mov_b32 s31, 0x20000
    s_load_dwordx2 s[8:9], s[0:1], 96
    s_mov_b32 s10, 2097152
    s_mov_b32 s11, 0x20000
    v_lshrrev_b32 v2, 4, v1
    s_and_b32 s17, s12, 3
    s_lshr_b32 s18, s12, 2
    s_lshl_b32 s19, s41, 2
    s_add_u32 s19, s19, s17
    s_mul_i32 s20, s41, 7
    s_lshl_b32 s21, s17, 1
    s_add_u32 s20, s20, s21
    s_lshl_b32 s23, s18, 16
    s_add_u32 s23, s23, 41943040
    v_bfe_u32 v13, v2, 4, 1
    v_add_u32 v13, s20, v13
    v_lshrrev_b32 v0, 1, v13
    v_lshlrev_b32 v0, 17, v0
    v_and_b32 v13, 1, v13
    v_lshl_add_u32 v0, v13, 8, v0
    v_and_b32 v13, 0x2f0, v1
    v_add_u32 v0, v0, v13
    s_cmp_eq_u32 s17, 3
    s_cselect_b32 s21, 268435456, 0
    v_bfe_u32 v13, v2, 4, 1
    v_mul_lo_u32 v13, v13, s21
    v_add_u32 v0, v0, v13
    v_and_b32 v13, 31, v2
    v_lshrrev_b32 v14, 5, v2
    v_bfe_u32 v12, v2, 1, 3
    v_xor_b32 v12, v12, v14
    v_lshlrev_b32 v12, 4, v12
    v_lshl_add_u32 v12, v13, 7, v12
    s_lshl_b32 s24, s18, 13
    s_add_u32 s24, s24, 98304
    s_lshl_b32 s25, s18, 12
    s_add_u32 s26, s24, s25
    s_sub_u32 s25, 4096, s25
    s_add_u32 s25, s25, s24
    v_xor_b32 v14, 0, v12
    v_add_u32 v4, s26, v14
    v_add_u32 v8, s25, v14
    v_xor_b32 v14, 32, v12
    v_add_u32 v5, s26, v14
    v_add_u32 v9, s25, v14
    v_xor_b32 v14, 64, v12
    v_add_u32 v6, s26, v14
    v_add_u32 v10, s25, v14
    v_xor_b32 v14, 96, v12
    v_add_u32 v7, s26, v14
    v_add_u32 v11, s25, v14
    v_mov_b32 v3, 98304
    s_mov_b32 s27, 0xffff0000
    s_mov_b32 s34, 0xbdd2d3e8
    v_mov_b32 v91, 0xc0135761
    s_mul_i32 s45, s17, 28672
    s_mul_i32 s46, s18, 14336
    s_add_u32 s45, s45, s46
    s_mul_i32 s47, s40, 114688
    s_add_u32 s47, s47, s45
    s_add_u32 s47, s47, 46137344
    s_mul_i32 s48, s19, 28672
    s_add_u32 s48, s48, s46
    s_add_u32 s48, s48, 11534336
    s_lshl_b32 s49, s40, 16
    s_lshl_b32 s24, s18, 15
    s_add_u32 s49, s49, s24
    s_lshl_b32 s24, s19, 5
    s_add_u32 s49, s49, s24
    s_add_u32 s50, s49, 16384
    buffer_load_dwordx4 v[136:139], v1, s[4:7], s48 offen offset:0 sc1
    buffer_load_dwordx4 v[140:143], v1, s[4:7], s48 offen offset:1024 sc1
    buffer_load_dwordx4 v[144:147], v1, s[4:7], s48 offen offset:2048 sc1
    buffer_load_dwordx4 v[148:151], v1, s[4:7], s48 offen offset:3072 sc1
    s_add_u32 s48, s48, 4096
    buffer_load_dwordx4 v[152:155], v1, s[4:7], s48 offen offset:0 sc1
    buffer_load_dwordx4 v[156:159], v1, s[4:7], s48 offen offset:1024 sc1
    buffer_load_dwordx4 v[160:163], v1, s[4:7], s48 offen offset:2048 sc1
    buffer_load_dwordx4 v[164:167], v1, s[4:7], s48 offen offset:3072 sc1
    s_add_u32 s48, s48, 4096
    buffer_load_dwordx4 v[168:171], v1, s[4:7], s48 offen offset:0 sc1
    buffer_load_dwordx4 v[172:175], v1, s[4:7], s48 offen offset:1024 sc1
    buffer_load_dwordx4 v[176:179], v1, s[4:7], s48 offen offset:2048 sc1
    buffer_load_dwordx4 v[180:183], v1, s[4:7], s48 offen offset:3072 sc1
    s_add_u32 s48, s48, 4096
    buffer_load_dwordx4 v[184:187], v1, s[4:7], s48 offen offset:0 sc1
    buffer_load_dwordx4 v[188:191], v1, s[4:7], s48 offen offset:1024 sc1
    s_cmp_eq_u32 s12, 7
    s_cbranch_scc1 L_g_poll0
L_g_back:
    s_setprio 0
    s_waitcnt lgkmcnt(0)
    s_barrier
    buffer_load_dwordx4 v[192:195], v0, s[4:7], s23 offen offset:0 sc1
    buffer_load_dwordx4 v[196:199], v0, s[4:7], s23 offen offset:1024 sc1
    buffer_load_dwordx4 v[200:203], v0, s[4:7], s23 offen offset:2048 sc1
    buffer_load_dwordx4 v[204:207], v0, s[4:7], s23 offen offset:3072 sc1
    s_add_u32 s23, s23, 4096
    buffer_load_dwordx4 v[208:211], v0, s[4:7], s23 offen offset:0 sc1
    buffer_load_dwordx4 v[212:215], v0, s[4:7], s23 offen offset:1024 sc1
    ds_read_b128 v[48:51], v4 offset:0
    ds_read_b128 v[52:55], v8 offset:0
    ds_read_b128 v[56:59], v5 offset:0
    ds_read_b128 v[60:63], v9 offset:0
    ds_read_b128 v[64:67], v6 offset:0
    ds_read_b128 v[68:71], v10 offset:0
    s_waitcnt vmcnt(5) lgkmcnt(5)
    v_mfma_f32_32x32x16_bf16 v[16:31], v[192:195], v[48:51], 0
    ds_read_b128 v[72:75], v7 offset:0
    buffer_load_dwordx4 v[216:219], v0, s[4:7], s23 offen offset:2048 sc1
    s_waitcnt lgkmcnt(5)
    v_mfma_f32_32x32x16_bf16 v[32:47], v[192:195], v[52:55], 0
    ds_read_b128 v[76:79], v11 offset:0
    buffer_load_dwordx4 v[220:223], v0, s[4:7], s23 offen offset:3072 sc1
    s_waitcnt vmcnt(6) lgkmcnt(5)
    v_mfma_f32_32x32x16_bf16 v[16:31], v[196:199], v[56:59], v[16:31]
    ds_read_b128 v[48:51], v4 offset:16384
    s_add_u32 s23, s23, 4096
    buffer_load_dwordx4 v[224:227], v0, s[4:7], s23 offen offset:0 sc1
    s_waitcnt lgkmcnt(5)
    v_mfma_f32_32x32x16_bf16 v[32:47], v[196:199], v[60:63], v[32:47]
    ds_read_b128 v[52:55], v8 offset:16384
    buffer_load_dwordx4 v[228:231], v0, s[4:7], s23 offen offset:1024 sc1
    s_waitcnt vmcnt(7) lgkmcnt(5)
    v_mfma_f32_32x32x16_bf16 v[16:31], v[200:203], v[64:67], v[16:31]
    ds_read_b128 v[56:59], v5 offset:16384
    buffer_load_dwordx4 v[232:235], v0, s[4:7], s23 offen offset:2048 sc1
    s_waitcnt lgkmcnt(5)
    v_mfma_f32_32x32x16_bf16 v[32:47], v[200:203], v[68:71], v[32:47]
    ds_read_b128 v[60:63], v9 offset:16384
    buffer_load_dwordx4 v[236:239], v0, s[4:7], s23 offen offset:3072 sc1
    s_waitcnt vmcnt(8) lgkmcnt(5)
    v_mfma_f32_32x32x16_bf16 v[16:31], v[204:207], v[72:75], v[16:31]
    ds_read_b128 v[64:67], v6 offset:16384
    s_add_u32 s23, s23, 4096
    buffer_load_dwordx4 v[192:195], v0, s[4:7], s23 offen offset:0 sc1
    s_waitcnt lgkmcnt(5)
    v_mfma_f32_32x32x16_bf16 v[32:47], v[204:207], v[76:79], v[32:47]
    ds_read_b128 v[68:71], v10 offset:16384
    buffer_load_dwordx4 v[196:199], v0, s[4:7], s23 offen offset:1024 sc1
    s_waitcnt vmcnt(9) lgkmcnt(5)
    v_mfma_f32_32x32x16_bf16 v[16:31], v[208:211], v[48:51], v[16:31]
    ds_read_b128 v[72:75], v7 offset:16384
    buffer_load_dwordx4 v[200:203], v0, s[4:7], s23 offen offset:2048 sc1
    s_waitcnt lgkmcnt(5)
    v_mfma_f32_32x32x16_bf16 v[32:47], v[208:211], v[52:55], v[32:47]
    ds_read_b128 v[76:79], v11 offset:16384
    s_waitcnt vmcnt(9) lgkmcnt(5)
    v_mfma_f32_32x32x16_bf16 v[16:31], v[212:215], v[56:59], v[16:31]
    buffer_load_dwordx4 v[204:207], v0, s[4:7], s23 offen offset:3072 sc1
    s_waitcnt lgkmcnt(4)
    v_mfma_f32_32x32x16_bf16 v[32:47], v[212:215], v[60:63], v[32:47]
    s_waitcnt vmcnt(9) lgkmcnt(3)
    v_mfma_f32_32x32x16_bf16 v[16:31], v[216:219], v[64:67], v[16:31]
    s_waitcnt lgkmcnt(0)
    s_barrier
    ds_read_b128 v[48:51], v4 offset:32768
    ds_read_b128 v[52:55], v8 offset:32768
    ds_read_b128 v[56:59], v5 offset:32768
    s_add_u32 s23, s23, 4096
    buffer_load_dwordx4 v[208:211], v0, s[4:7], s23 offen offset:0 sc1
    v_mfma_f32_32x32x16_bf16 v[32:47], v[216:219], v[68:71], v[32:47]
    ds_read_b128 v[60:63], v9 offset:32768
    s_waitcnt vmcnt(9)
    v_mfma_f32_32x32x16_bf16 v[16:31], v[220:223], v[72:75], v[16:31]
    ds_read_b128 v[64:67], v6 offset:32768
    buffer_load_dwordx4 v[212:215], v0, s[4:7], s23 offen offset:1024 sc1
    v_mfma_f32_32x32x16_bf16 v[32:47], v[220:223], v[76:79], v[32:47]
    ds_read_b128 v[68:71], v10 offset:32768
    s_waitcnt vmcnt(9) lgkmcnt(5)
    v_mfma_f32_32x32x16_bf16 v[16:31], v[224:227], v[48:51], v[16:31]
    ds_read_b128 v[72:75], v7 offset:32768
    s_add_u32 m0, s43, 98304
    s_add_u32 s44, s42, 1024
    buffer_load_dwordx4 v15, s[36:39], s44 offen lds
    buffer_load_dwordx4 v[216:219], v0, s[4:7], s23 offen offset:2048 sc1
    s_waitcnt lgkmcnt(5)
    v_mfma_f32_32x32x16_bf16 v[32:47], v[224:227], v[52:55], v[32:47]
    ds_read_b128 v[76:79], v11 offset:32768
    s_waitcnt vmcnt(10) lgkmcnt(5)
    v_mfma_f32_32x32x16_bf16 v[16:31], v[228:231], v[56:59], v[16:31]
    ds_read_b128 v[48:51], v4 offset:49152
    buffer_load_dwordx4 v[220:223], v0, s[4:7], s23 offen offset:3072 sc1
    s_waitcnt lgkmcnt(5)
    v_mfma_f32_32x32x16_bf16 v[32:47], v[228:231], v[60:63], v[32:47]
    ds_read_b128 v[52:55], v8 offset:49152
    s_waitcnt vmcnt(10) lgkmcnt(5)
    v_mfma_f32_32x32x16_bf16 v[16:31], v[232:235], v[64:67], v[16:31]
    ds_read_b128 v[56:59], v5 offset:49152
    s_add_u32 m0, s43, 106496
    s_add_u32 s44, s42, 3072
    buffer_load_dwordx4 v15, s[36:39], s44 offen lds
    s_add_u32 s23, s23, 4096
    buffer_load_dwordx4 v[224:227], v0, s[4:7], s23 offen offset:0 sc1
    s_waitcnt lgkmcnt(5)
    v_mfma_f32_32x32x16_bf16 v[32:47], v[232:235], v[68:71], v[32:47]
    ds_read_b128 v[60:63], v9 offset:49152
    s_waitcnt vmcnt(11) lgkmcnt(5)
    v_mfma_f32_32x32x16_bf16 v[16:31], v[236:239], v[72:75], v[16:31]
    ds_read_b128 v[64:67], v6 offset:49152
    buffer_load_dwordx4 v[228:231], v0, s[4:7], s23 offen offset:1024 sc1
    s_waitcnt lgkmcnt(5)
    v_mfma_f32_32x32x16_bf16 v[32:47], v[236:239], v[76:79], v[32:47]
    ds_read_b128 v[68:71], v10 offset:49152
    s_waitcnt vmcnt(11) lgkmcnt(5)
    v_mfma_f32_32x32x16_bf16 v[16:31], v[192:195], v[48:51], v[16:31]
    ds_read_b128 v[72:75], v7 offset:49152
    s_add_u32 m0, s43, 114688
    s_add_u32 s44, s42, 1152
    buffer_load_dwordx4 v15, s[36:39], s44 offen lds
    buffer_load_dwordx4 v[232:235], v0, s[4:7], s23 offen offset:2048 sc1
    s_waitcnt lgkmcnt(5)
    v_mfma_f32_32x32x16_bf16 v[32:47], v[192:195], v[52:55], v[32:47]
    ds_read_b128 v[76:79], v11 offset:49152
    s_waitcnt vmcnt(12) lgkmcnt(5)
    v_mfma_f32_32x32x16_bf16 v[16:31], v[196:199], v[56:59], v[16:31]
    buffer_load_dwordx4 v[236:239], v0, s[4:7], s23 offen offset:3072 sc1
    s_waitcnt lgkmcnt(4)
    v_mfma_f32_32x32x16_bf16 v[32:47], v[196:199], v[60:63], v[32:47]
    s_waitcnt vmcnt(12) lgkmcnt(3)
    v_mfma_f32_32x32x16_bf16 v[16:31], v[200:203], v[64:67], v[16:31]
    s_waitcnt lgkmcnt(0)
    s_barrier
    v_sub_u32 v4, v4, v3
    v_sub_u32 v5, v5, v3
    v_sub_u32 v6, v6, v3
    v_sub_u32 v7, v7, v3
    v_sub_u32 v8, v8, v3
    v_sub_u32 v9, v9, v3
    v_sub_u32 v10, v10, v3
    v_sub_u32 v11, v11, v3
    ds_read_b128 v[48:51], v4 offset:0
    ds_read_b128 v[52:55], v8 offset:0
    ds_read_b128 v[56:59], v5 offset:0
    s_add_u32 m0, s43, 122880
    s_add_u32 s44, s42, 3200
    buffer_load_dwordx4 v15, s[36:39], s44 offen lds
    s_add_u32 s23, s23, 4096
    buffer_load_dwordx4 v[192:195], v0, s[4:7], s23 offen offset:0 sc1
    v_mfma_f32_32x32x16_bf16 v[32:47], v[200:203], v[68:71], v[32:47]
    ds_read_b128 v[60:63], v9 offset:0
    s_waitcnt vmcnt(13)
    v_mfma_f32_32x32x16_bf16 v[16:31], v[204:207], v[72:75], v[16:31]
    ds_read_b128 v[64:67], v6 offset:0
    buffer_load_dwordx4 v[196:199], v0, s[4:7], s23 offen offset:1024 sc1
    v_mfma_f32_32x32x16_bf16 v[32:47], v[204:207], v[76:79], v[32:47]
    ds_read_b128 v[68:71], v10 offset:0
    s_waitcnt vmcnt(13) lgkmcnt(5)
    v_mfma_f32_32x32x16_bf16 v[16:31], v[208:211], v[48:51], v[16:31]
    ds_read_b128 v[72:75], v7 offset:0
    s_add_u32 m0, s43, 131072
    s_add_u32 s44, s42, 1280
    buffer_load_dwordx4 v15, s[36:39], s44 offen lds
    buffer_load_dwordx4 v[200:203], v0, s[4:7], s23 offen offset:2048 sc1
    s_waitcnt lgkmcnt(5)
    v_mfma_f32_32x32x16_bf16 v[32:47], v[208:211], v[52:55], v[32:47]
    ds_read_b128 v[76:79], v11 offset:0
    s_waitcnt vmcnt(14) lgkmcnt(5)
    v_mfma_f32_32x32x16_bf16 v[16:31], v[212:215], v[56:59], v[16:31]
    ds_read_b128 v[48:51], v4 offset:16384
    buffer_load_dwordx4 v[204:207], v0, s[4:7], s23 offen offset:3072 sc1
    s_waitcnt lgkmcnt(5)
    v_mfma_f32_32x32x16_bf16 v[32:47], v[212:215], v[60:63], v[32:47]
    ds_read_b128 v[52:55], v8 offset:16384
    s_waitcnt vmcnt(13) lgkmcnt(5)
    v_mfma_f32_32x32x16_bf16 v[16:31], v[216:219], v[64:67], v[16:31]
    ds_read_b128 v[56:59], v5 offset:16384
    s_add_u32 m0, s43, 139264
    s_add_u32 s44, s42, 3328
    buffer_load_dwordx4 v15, s[36:39], s44 offen lds
    s_add_u32 s23, s23, 4096
    buffer_load_dwordx4 v[208:211], v0, s[4:7], s23 offen offset:0 sc1
    s_waitcnt lgkmcnt(5)
    v_mfma_f32_32x32x16_bf16 v[32:47], v[216:219], v[68:71], v[32:47]
    ds_read_b128 v[60:63], v9 offset:16384
    s_waitcnt vmcnt(14) lgkmcnt(5)
    v_mfma_f32_32x32x16_bf16 v[16:31], v[220:223], v[72:75], v[16:31]
    ds_read_b128 v[64:67], v6 offset:16384
    buffer_load_dwordx4 v[212:215], v0, s[4:7], s23 offen offset:1024 sc1
    s_waitcnt lgkmcnt(5)
    v_mfma_f32_32x32x16_bf16 v[32:47], v[220:223], v[76:79], v[32:47]
    ds_read_b128 v[68:71], v10 offset:16384
    s_waitcnt vmcnt(13) lgkmcnt(5)
    v_mfma_f32_32x32x16_bf16 v[16:31], v[224:227], v[48:51], v[16:31]
    ds_read_b128 v[72:75], v7 offset:16384
    s_add_u32 m0, s43, 147456
    s_add_u32 s44, s42, 1408
    buffer_load_dwordx4 v15, s[36:39], s44 offen lds
    buffer_load_dwordx4 v[216:219], v0, s[4:7], s23 offen offset:2048 sc1
    s_waitcnt lgkmcnt(5)
    v_mfma_f32_32x32x16_bf16 v[32:47], v[224:227], v[52:55], v[32:47]
    ds_read_b128 v[76:79], v11 offset:16384
    s_waitcnt vmcnt(14) lgkmcnt(5)
    v_mfma_f32_32x32x16_bf16 v[16:31], v[228:231], v[56:59], v[16:31]
    buffer_load_dwordx4 v[220:223], v0, s[4:7], s23 offen offset:3072 sc1
    s_waitcnt lgkmcnt(4)
    v_mfma_f32_32x32x16_bf16 v[32:47], v[228:231], v[60:63], v[32:47]
    s_waitcnt vmcnt(13) lgkmcnt(3)
    v_mfma_f32_32x32x16_bf16 v[16:31], v[232:235], v[64:67], v[16:31]
    s_waitcnt lgkmcnt(0)
    s_barrier
    ds_read_b128 v[48:51], v4 offset:32768
    ds_read_b128 v[52:55], v8 offset:32768
    ds_read_b128 v[56:59], v5 offset:32768
    s_add_u32 m0, s43, 155648
    s_add_u32 s44, s42, 3456
    buffer_load_dwordx4 v15, s[36:39], s44 offen lds
    s_add_u32 s23, s23, 4096
    buffer_load_dwordx4 v[224:227], v0, s[4:7], s23 offen offset:0 sc1
    v_mfma_f32_32x32x16_bf16 v[32:47], v[232:235], v[68:71], v[32:47]
    ds_read_b128 v[60:63], v9 offset:32768
    s_waitcnt vmcnt(14)
    v_mfma_f32_32x32x16_bf16 v[16:31], v[236:239], v[72:75], v[16:31]
    ds_read_b128 v[64:67], v6 offset:32768
    buffer_load_dwordx4 v[228:231], v0, s[4:7], s23 offen offset:1024 sc1
    v_mfma_f32_32x32x16_bf16 v[32:47], v[236:239], v[76:79], v[32:47]
    ds_read_b128 v[68:71], v10 offset:32768
    s_waitcnt vmcnt(13) lgkmcnt(5)
    v_mfma_f32_32x32x16_bf16 v[16:31], v[192:195], v[48:51], v[16:31]
    ds_read_b128 v[72:75], v7 offset:32768
    s_add_u32 m0, s43, 0
    s_add_u32 s44, s42, 1536
    buffer_load_dwordx4 v15, s[36:39], s44 offen lds
    buffer_load_dwordx4 v[232:235], v0, s[4:7], s23 offen offset:2048 sc1
    s_waitcnt lgkmcnt(5)
    v_mfma_f32_32x32x16_bf16 v[32:47], v[192:195], v[52:55], v[32:47]
    ds_read_b128 v[76:79], v11 offset:32768
    s_lshl_b32 s24, s40, 1
    s_add_u32 s24, s24, s18
    s_mul_i32 s25, s24, 57344
    s_lshl_b32 s26, s20, 10
    s_add_u32 s26, s25, s26
    s_add_u32 s26, s26, 37748736
    s_lshl_b32 s35, s20, 9
    s_add_u32 s25, s25, s35
    s_add_u32 s25, s25, 46137344
    s_lshl_b32 s24, s24, 6
    buffer_load_dwordx4 v[80:83], v1, s[4:7], s26 offen sc1
    buffer_load_dwordx4 v[84:87], v1, s[4:7], s26 offen offset:1024 sc1
    v_lshlrev_b32 v13, 1, v13
    buffer_load_ushort v88, v13, s[28:31], s24 offen
    s_waitcnt vmcnt(17) lgkmcnt(5)
    v_mfma_f32_32x32x16_bf16 v[16:31], v[196:199], v[56:59], v[16:31]
    ds_read_b128 v[48:51], v4 offset:49152
    buffer_load_dwordx4 v[236:239], v0, s[4:7], s23 offen offset:3072 sc1
    s_waitcnt lgkmcnt(5)
    v_mfma_f32_32x32x16_bf16 v[32:47], v[196:199], v[60:63], v[32:47]
    ds_read_b128 v[52:55], v8 offset:49152
    s_waitcnt vmcnt(16) lgkmcnt(5)
    v_mfma_f32_32x32x16_bf16 v[16:31], v[200:203], v[64:67], v[16:31]
    ds_read_b128 v[56:59], v5 offset:49152
    s_add_u32 m0, s43, 8192
    s_add_u32 s44, s42, 3584
    buffer_load_dwordx4 v15, s[36:39], s44 offen lds
    s_add_u32 s23, s23, 4096
    buffer_load_dwordx4 v[192:195], v0, s[4:7], s23 offen offset:0 sc1
    s_waitcnt lgkmcnt(5)
    v_mfma_f32_32x32x16_bf16 v[32:47], v[200:203], v[68:71], v[32:47]
    ds_read_b128 v[60:63], v9 offset:49152
    s_waitcnt vmcnt(17) lgkmcnt(5)
    v_mfma_f32_32x32x16_bf16 v[16:31], v[204:207], v[72:75], v[16:31]
    ds_read_b128 v[64:67], v6 offset:49152
    buffer_load_dwordx4 v[196:199], v0, s[4:7], s23 offen offset:1024 sc1
    s_waitcnt lgkmcnt(5)
    v_mfma_f32_32x32x16_bf16 v[32:47], v[204:207], v[76:79], v[32:47]
    ds_read_b128 v[68:71], v10 offset:49152
    s_waitcnt vmcnt(16) lgkmcnt(5)
    v_mfma_f32_32x32x16_bf16 v[16:31], v[208:211], v[48:51], v[16:31]
    ds_read_b128 v[72:75], v7 offset:49152
    s_add_u32 m0, s43, 16384
    s_add_u32 s44, s42, 1664
    buffer_load_dwordx4 v15, s[36:39], s44 offen lds
    buffer_load_dwordx4 v[200:203], v0, s[4:7], s23 offen offset:2048 sc1
    s_waitcnt lgkmcnt(5)
    v_mfma_f32_32x32x16_bf16 v[32:47], v[208:211], v[52:55], v[32:47]
    ds_read_b128 v[76:79], v11 offset:49152
    s_waitcnt vmcnt(17) lgkmcnt(5)
    v_mfma_f32_32x32x16_bf16 v[16:31], v[212:215], v[56:59], v[16:31]
    buffer_load_dwordx4 v[204:207], v0, s[4:7], s23 offen offset:3072 sc1
    s_waitcnt lgkmcnt(4)
    v_mfma_f32_32x32x16_bf16 v[32:47], v[212:215], v[60:63], v[32:47]
    s_waitcnt vmcnt(16) lgkmcnt(3)
    v_mfma_f32_32x32x16_bf16 v[16:31], v[216:219], v[64:67], v[16:31]
    s_waitcnt lgkmcnt(0)
    s_barrier
    v_add_u32 v4, v4, v3
    v_add_u32 v5, v5, v3
    v_add_u32 v6, v6, v3
    v_add_u32 v7, v7, v3
    v_add_u32 v8, v8, v3
    v_add_u32 v9, v9, v3
    v_add_u32 v10, v10, v3
    v_add_u32 v11, v11, v3
    ds_read_b128 v[48:51], v4 offset:0
    ds_read_b128 v[52:55], v8 offset:0
    ds_read_b128 v[56:59], v5 offset:0
    s_add_u32 m0, s43, 24576
    s_add_u32 s44, s42, 3712
    buffer_load_dwordx4 v15, s[36:39], s44 offen lds
    s_add_u32 s23, s23, 4096
    buffer_load_dwordx4 v[208:211], v0, s[4:7], s23 offen offset:0 sc1
    v_mfma_f32_32x32x16_bf16 v[32:47], v[216:219], v[68:71], v[32:47]
    ds_read_b128 v[60:63], v9 offset:0
    s_waitcnt vmcnt(17)
    v_mfma_f32_32x32x16_bf16 v[16:31], v[220:223], v[72:75], v[16:31]
    ds_read_b128 v[64:67], v6 offset:0
    buffer_load_dwordx4 v[212:215], v0, s[4:7], s23 offen offset:1024 sc1
    v_mfma_f32_32x32x16_bf16 v[32:47], v[220:223], v[76:79], v[32:47]
    ds_read_b128 v[68:71], v10 offset:0
    s_waitcnt vmcnt(16) lgkmcnt(5)
    v_mfma_f32_32x32x16_bf16 v[16:31], v[224:227], v[48:51], v[16:31]
    ds_read_b128 v[72:75], v7 offset:0
    s_add_u32 m0, s43, 32768
    s_add_u32 s44, s42, 1792
    buffer_load_dwordx4 v15, s[36:39], s44 offen lds
    buffer_load_dwordx4 v[216:219], v0, s[4:7], s23 offen offset:2048 sc1
    s_waitcnt lgkmcnt(5)
    v_mfma_f32_32x32x16_bf16 v[32:47], v[224:227], v[52:55], v[32:47]
    ds_read_b128 v[76:79], v11 offset:0
    s_waitcnt vmcnt(17) lgkmcnt(5)
    v_mfma_f32_32x32x16_bf16 v[16:31], v[228:231], v[56:59], v[16:31]
    ds_read_b128 v[48:51], v4 offset:16384
    buffer_load_dwordx4 v[220:223], v0, s[4:7], s23 offen offset:3072 sc1
    s_waitcnt lgkmcnt(5)
    v_mfma_f32_32x32x16_bf16 v[32:47], v[228:231], v[60:63], v[32:47]
    ds_read_b128 v[52:55], v8 offset:16384
    s_waitcnt vmcnt(16) lgkmcnt(5)
    v_mfma_f32_32x32x16_bf16 v[16:31], v[232:235], v[64:67], v[16:31]
    ds_read_b128 v[56:59], v5 offset:16384
    s_add_u32 m0, s43, 40960
    s_add_u32 s44, s42, 3840
    buffer_load_dwordx4 v15, s[36:39], s44 offen lds
    s_add_u32 s23, s23, 4096
    buffer_load_dwordx4 v[224:227], v0, s[4:7], s23 offen offset:0 sc1
    s_waitcnt lgkmcnt(5)
    v_mfma_f32_32x32x16_bf16 v[32:47], v[232:235], v[68:71], v[32:47]
    ds_read_b128 v[60:63], v9 offset:16384
    s_waitcnt vmcnt(14) lgkmcnt(5)
    v_mfma_f32_32x32x16_bf16 v[16:31], v[236:239], v[72:75], v[16:31]
    ds_read_b128 v[64:67], v6 offset:16384
    buffer_load_dwordx4 v[228:231], v0, s[4:7], s23 offen offset:1024 sc1
    s_waitcnt lgkmcnt(5)
    v_mfma_f32_32x32x16_bf16 v[32:47], v[236:239], v[76:79], v[32:47]
    ds_read_b128 v[68:71], v10 offset:16384
    s_waitcnt vmcnt(13) lgkmcnt(5)
    v_mfma_f32_32x32x16_bf16 v[16:31], v[192:195], v[48:51], v[16:31]
    ds_read_b128 v[72:75], v7 offset:16384
    s_add_u32 m0, s43, 49152
    s_add_u32 s44, s42, 1920
    buffer_load_dwordx4 v15, s[36:39], s44 offen lds
    buffer_load_dwordx4 v[232:235], v0, s[4:7], s23 offen offset:2048 sc1
    s_waitcnt lgkmcnt(5)
    v_mfma_f32_32x32x16_bf16 v[32:47], v[192:195], v[52:55], v[32:47]
    ds_read_b128 v[76:79], v11 offset:16384
    s_waitcnt vmcnt(14) lgkmcnt(5)
    v_mfma_f32_32x32x16_bf16 v[16:31], v[196:199], v[56:59], v[16:31]
    buffer_load_dwordx4 v[236:239], v0, s[4:7], s23 offen offset:3072 sc1
    s_waitcnt lgkmcnt(4)
    v_mfma_f32_32x32x16_bf16 v[32:47], v[196:199], v[60:63], v[32:47]
    s_waitcnt vmcnt(13) lgkmcnt(3)
    v_mfma_f32_32x32x16_bf16 v[16:31], v[200:203], v[64:67], v[16:31]
    s_waitcnt lgkmcnt(0)
    s_barrier
    ds_read_b128 v[48:51], v4 offset:32768
    ds_read_b128 v[52:55], v8 offset:32768
    ds_read_b128 v[56:59], v5 offset:32768
    s_add_u32 m0, s43, 57344
    s_add_u32 s44, s42, 3968
    buffer_load_dwordx4 v15, s[36:39], s44 offen lds
    s_add_u32 s23, s23, 4096
    buffer_load_dwordx4 v[192:195], v0, s[4:7], s23 offen offset:0 sc1
    v_mfma_f32_32x32x16_bf16 v[32:47], v[200:203], v[68:71], v[32:47]
    ds_read_b128 v[60:63], v9 offset:32768
    s_waitcnt vmcnt(14)
    v_mfma_f32_32x32x16_bf16 v[16:31], v[204:207], v[72:75], v[16:31]
    ds_read_b128 v[64:67], v6 offset:32768
    buffer_load_dwordx4 v[196:199], v0, s[4:7], s23 offen offset:1024 sc1
    v_mfma_f32_32x32x16_bf16 v[32:47], v[204:207], v[76:79], v[32:47]
    ds_read_b128 v[68:71], v10 offset:32768
    s_waitcnt vmcnt(13) lgkmcnt(5)
    v_mfma_f32_32x32x16_bf16 v[16:31], v[208:211], v[48:51], v[16:31]
    ds_read_b128 v[72:75], v7 offset:32768
    buffer_load_dwordx4 v[200:203], v0, s[4:7], s23 offen offset:2048 sc1
    s_waitcnt lgkmcnt(5)
    v_mfma_f32_32x32x16_bf16 v[32:47], v[208:211], v[52:55], v[32:47]
    ds_read_b128 v[76:79], v11 offset:32768
    s_waitcnt vmcnt(13) lgkmcnt(5)
    v_mfma_f32_32x32x16_bf16 v[16:31], v[212:215], v[56:59], v[16:31]
    ds_read_b128 v[48:51], v4 offset:49152
    buffer_load_dwordx4 v[204:207], v0, s[4:7], s23 offen offset:3072 sc1
    s_waitcnt lgkmcnt(5)
    v_mfma_f32_32x32x16_bf16 v[32:47], v[212:215], v[60:63], v[32:47]
    ds_read_b128 v[52:55], v8 offset:49152
    s_waitcnt vmcnt(12) lgkmcnt(5)
    v_mfma_f32_32x32x16_bf16 v[16:31], v[216:219], v[64:67], v[16:31]
    ds_read_b128 v[56:59], v5 offset:49152
    s_add_u32 s23, s23, 4096
    buffer_load_dwordx4 v[208:211], v0, s[4:7], s23 offen offset:0 sc1
    v_lshlrev_b32 v92, 16, v80
    v_and_b32 v93, s27, v80
    v_lshlrev_b32 v94, 16, v81
    v_and_b32 v95, s27, v81
    s_waitcnt lgkmcnt(5)
    v_mfma_f32_32x32x16_bf16 v[32:47], v[216:219], v[68:71], v[32:47]
    ds_read_b128 v[60:63], v9 offset:49152
    v_lshlrev_b32 v96, 16, v82
    v_and_b32 v97, s27, v82
    v_lshlrev_b32 v98, 16, v83
    v_and_b32 v99, s27, v83
    s_waitcnt vmcnt(12) lgkmcnt(5)
    v_mfma_f32_32x32x16_bf16 v[16:31], v[220:223], v[72:75], v[16:31]
    ds_read_b128 v[64:67], v6 offset:49152
    buffer_load_dwordx4 v[212:215], v0, s[4:7], s23 offen offset:1024 sc1
    v_lshlrev_b32 v100, 16, v84
    v_and_b32 v101, s27, v84
    v_lshlrev_b32 v102, 16, v85
    v_and_b32 v103, s27, v85
    s_waitcnt lgkmcnt(5)
    v_mfma_f32_32x32x16_bf16 v[32:47], v[220:223], v[76:79], v[32:47]
    ds_read_b128 v[68:71], v10 offset:49152
    v_lshlrev_b32 v104, 16, v86
    v_and_b32 v105, s27, v86
    v_lshlrev_b32 v106, 16, v87
    v_and_b32 v107, s27, v87
    s_waitcnt vmcnt(11) lgkmcnt(5)
    v_mfma_f32_32x32x16_bf16 v[16:31], v[224:227], v[48:51], v[16:31]
    ds_read_b128 v[72:75], v7 offset:49152
    buffer_load_dwordx4 v[216:219], v0, s[4:7], s23 offen offset:2048 sc1
    v_mul_f32 v108, v92, v92
    v_mul_f32 v109, v93, v93
    v_mul_f32 v110, v94, v94
    v_mul_f32 v111, v95, v95
    s_waitcnt lgkmcnt(5)
    v_mfma_f32_32x32x16_bf16 v[32:47], v[224:227], v[52:55], v[32:47]
    ds_read_b128 v[76:79], v11 offset:49152
    v_mul_f32 v112, v96, v96
    v_mul_f32 v113, v97, v97
    v_mul_f32 v114, v98, v98
    v_mul_f32 v115, v99, v99
    s_waitcnt vmcnt(11) lgkmcnt(5)
    v_mfma_f32_32x32x16_bf16 v[16:31], v[228:231], v[56:59], v[16:31]
    buffer_load_dwordx4 v[220:223], v0, s[4:7], s23 offen offset:3072 sc1
    v_mul_f32 v116, v100, v100
    v_mul_f32 v117, v101, v101
    v_mul_f32 v118, v102, v102
    v_mul_f32 v119, v103, v103
    s_waitcnt lgkmcnt(4)
    v_mfma_f32_32x32x16_bf16 v[32:47], v[228:231], v[60:63], v[32:47]
    v_mul_f32 v120, v104, v104
    v_mul_f32 v121, v105, v105
    v_mul_f32 v122, v106, v106
    v_mul_f32 v123, v107, v107
    s_waitcnt vmcnt(10) lgkmcnt(3)
    v_mfma_f32_32x32x16_bf16 v[16:31], v[232:235], v[64:67], v[16:31]
    s_waitcnt lgkmcnt(0)
    s_barrier
    v_sub_u32 v4, v4, v3
    v_sub_u32 v5, v5, v3
    v_sub_u32 v6, v6, v3
    v_sub_u32 v7, v7, v3
    v_sub_u32 v8, v8, v3
    v_sub_u32 v9, v9, v3
    v_sub_u32 v10, v10, v3
    v_sub_u32 v11, v11, v3
    ds_read_b128 v[48:51], v4 offset:0
    ds_read_b128 v[52:55], v8 offset:0
    ds_read_b128 v[56:59], v5 offset:0
    s_add_u32 s23, s23, 4096
    buffer_load_dwordx4 v[224:227], v0, s[4:7], s23 offen offset:0 sc1
    v_fma_f32 v108, v108, s34, v91
    v_fma_f32 v109, v109, s34, v91
    v_fma_f32 v110, v110, s34, v91
    v_fma_f32 v111, v111, s34, v91
    v_mfma_f32_32x32x16_bf16 v[32:47], v[232:235], v[68:71], v[32:47]
    ds_read_b128 v[60:63], v9 offset:0
    v_fma_f32 v112, v112, s34, v91
    v_fma_f32 v113, v113, s34, v91
    v_fma_f32 v114, v114, s34, v91
    v_fma_f32 v115, v115, s34, v91
    s_waitcnt vmcnt(10)
    v_mfma_f32_32x32x16_bf16 v[16:31], v[236:239], v[72:75], v[16:31]
    ds_read_b128 v[64:67], v6 offset:0
    buffer_load_dwordx4 v[228:231], v0, s[4:7], s23 offen offset:1024 sc1
    v_fma_f32 v116, v116, s34, v91
    v_fma_f32 v117, v117, s34, v91
    v_fma_f32 v118, v118, s34, v91
    v_fma_f32 v119, v119, s34, v91
    v_mfma_f32_32x32x16_bf16 v[32:47], v[236:239], v[76:79], v[32:47]
    ds_read_b128 v[68:71], v10 offset:0
    v_fma_f32 v120, v120, s34, v91
    v_fma_f32 v121, v121, s34, v91
    v_fma_f32 v122, v122, s34, v91
    v_fma_f32 v123, v123, s34, v91
    s_waitcnt vmcnt(9) lgkmcnt(5)
    v_mfma_f32_32x32x16_bf16 v[16:31], v[192:195], v[48:51], v[16:31]
    ds_read_b128 v[72:75], v7 offset:0
    buffer_load_dwordx4 v[232:235], v0, s[4:7], s23 offen offset:2048 sc1
    v_mul_f32 v108, v108, v92
    v_mul_f32 v109, v109, v93
    v_mul_f32 v110, v110, v94
    v_mul_f32 v111, v111, v95
    s_waitcnt lgkmcnt(5)
    v_mfma_f32_32x32x16_bf16 v[32:47], v[192:195], v[52:55], v[32:47]
    ds_read_b128 v[76:79], v11 offset:0
    v_mul_f32 v112, v112, v96
    v_mul_f32 v113, v113, v97
    v_mul_f32 v114, v114, v98
    v_mul_f32 v115, v115, v99
    s_waitcnt vmcnt(9) lgkmcnt(5)
    v_mfma_f32_32x32x16_bf16 v[16:31], v[196:199], v[56:59], v[16:31]
    ds_read_b128 v[48:51], v4 offset:16384
    buffer_load_dwordx4 v[236:239], v0, s[4:7], s23 offen offset:3072 sc1
    v_mul_f32 v116, v116, v100
    v_mul_f32 v117, v117, v101
    v_mul_f32 v118, v118, v102
    v_mul_f32 v119, v119, v103
    s_waitcnt lgkmcnt(5)
    v_mfma_f32_32x32x16_bf16 v[32:47], v[196:199], v[60:63], v[32:47]
    ds_read_b128 v[52:55], v8 offset:16384
    v_mul_f32 v120, v120, v104
    v_mul_f32 v121, v121, v105
    v_mul_f32 v122, v122, v106
    v_mul_f32 v123, v123, v107
    s_waitcnt vmcnt(9) lgkmcnt(5)
    v_mfma_f32_32x32x16_bf16 v[16:31], v[200:203], v[64:67], v[16:31]
    ds_read_b128 v[56:59], v5 offset:16384
    s_add_u32 s23, s23, 4096
    buffer_load_dwordx4 v[192:195], v0, s[4:7], s23 offen offset:0 sc1
    v_exp_f32 v108, v108
    v_exp_f32 v109, v109
    v_exp_f32 v110, v110
    v_exp_f32 v111, v111
    s_waitcnt lgkmcnt(5)
    v_mfma_f32_32x32x16_bf16 v[32:47], v[200:203], v[68:71], v[32:47]
    ds_read_b128 v[60:63], v9 offset:16384
    v_exp_f32 v112, v112
    v_exp_f32 v113, v113
    v_exp_f32 v114, v114
    v_exp_f32 v115, v115
    s_waitcnt vmcnt(9) lgkmcnt(5)
    v_mfma_f32_32x32x16_bf16 v[16:31], v[204:207], v[72:75], v[16:31]
    ds_read_b128 v[64:67], v6 offset:16384
    buffer_load_dwordx4 v[196:199], v0, s[4:7], s23 offen offset:1024 sc1
    v_exp_f32 v116, v116
    v_exp_f32 v117, v117
    v_exp_f32 v118, v118
    v_exp_f32 v119, v119
    s_waitcnt lgkmcnt(5)
    v_mfma_f32_32x32x16_bf16 v[32:47], v[204:207], v[76:79], v[32:47]
    ds_read_b128 v[68:71], v10 offset:16384
    v_exp_f32 v120, v120
    v_exp_f32 v121, v121
    v_exp_f32 v122, v122
    v_exp_f32 v123, v123
    s_waitcnt vmcnt(9) lgkmcnt(5)
    v_mfma_f32_32x32x16_bf16 v[16:31], v[208:211], v[48:51], v[16:31]
    ds_read_b128 v[72:75], v7 offset:16384
    buffer_load_dwordx4 v[200:203], v0, s[4:7], s23 offen offset:2048 sc1
    v_add_f32 v108, 1.0, v108
    v_add_f32 v109, 1.0, v109
    v_add_f32 v110, 1.0, v110
    v_add_f32 v111, 1.0, v111
    s_waitcnt lgkmcnt(5)
    v_mfma_f32_32x32x16_bf16 v[32:47], v[208:211], v[52:55], v[32:47]
    ds_read_b128 v[76:79], v11 offset:16384
    v_add_f32 v112, 1.0, v112
    v_add_f32 v113, 1.0, v113
    v_add_f32 v114, 1.0, v114
    v_add_f32 v115, 1.0, v115
    s_waitcnt vmcnt(9) lgkmcnt(5)
    v_mfma_f32_32x32x16_bf16 v[16:31], v[212:215], v[56:59], v[16:31]
    buffer_load_dwordx4 v[204:207], v0, s[4:7], s23 offen offset:3072 sc1
    v_add_f32 v116, 1.0, v116
    v_add_f32 v117, 1.0, v117
    v_add_f32 v118, 1.0, v118
    v_add_f32 v119, 1.0, v119
    s_waitcnt lgkmcnt(4)
    v_mfma_f32_32x32x16_bf16 v[32:47], v[212:215], v[60:63], v[32:47]
    v_add_f32 v120, 1.0, v120
    v_add_f32 v121, 1.0, v121
    v_add_f32 v122, 1.0, v122
    v_add_f32 v123, 1.0, v123
    s_waitcnt vmcnt(9) lgkmcnt(3)
    v_mfma_f32_32x32x16_bf16 v[16:31], v[216:219], v[64:67], v[16:31]
    s_waitcnt lgkmcnt(0)
    s_barrier
    ds_read_b128 v[48:51], v4 offset:32768
    ds_read_b128 v[52:55], v8 offset:32768
    ds_read_b128 v[56:59], v5 offset:32768
    v_rcp_f32 v108, v108
    v_rcp_f32 v109, v109
    v_rcp_f32 v110, v110
    v_rcp_f32 v111, v111
    v_mfma_f32_32x32x16_bf16 v[32:47], v[216:219], v[68:71], v[32:47]
    ds_read_b128 v[60:63], v9 offset:32768
    v_rcp_f32 v112, v112
    v_rcp_f32 v113, v113
    v_rcp_f32 v114, v114
    v_rcp_f32 v115, v115
    s_waitcnt vmcnt(8)
    v_mfma_f32_32x32x16_bf16 v[16:31], v[220:223], v[72:75], v[16:31]
    ds_read_b128 v[64:67], v6 offset:32768
    v_rcp_f32 v116, v116
    v_rcp_f32 v117, v117
    v_rcp_f32 v118, v118
    v_rcp_f32 v119, v119
    v_mfma_f32_32x32x16_bf16 v[32:47], v[220:223], v[76:79], v[32:47]
    ds_read_b128 v[68:71], v10 offset:32768
    v_rcp_f32 v120, v120
    v_rcp_f32 v121, v121
    v_rcp_f32 v122, v122
    v_rcp_f32 v123, v123
    s_waitcnt vmcnt(7) lgkmcnt(5)
    v_mfma_f32_32x32x16_bf16 v[16:31], v[224:227], v[48:51], v[16:31]
    ds_read_b128 v[72:75], v7 offset:32768
    v_mul_f32 v92, v92, v108
    v_mul_f32 v93, v93, v109
    v_mul_f32 v94, v94, v110
    v_mul_f32 v95, v95, v111
    s_waitcnt lgkmcnt(5)
    v_mfma_f32_32x32x16_bf16 v[32:47], v[224:227], v[52:55], v[32:47]
    ds_read_b128 v[76:79], v11 offset:32768
    v_mul_f32 v96, v96, v112
    v_mul_f32 v97, v97, v113
    v_mul_f32 v98, v98, v114
    v_mul_f32 v99, v99, v115
    s_waitcnt vmcnt(6) lgkmcnt(5)
    v_mfma_f32_32x32x16_bf16 v[16:31], v[228:231], v[56:59], v[16:31]
    ds_read_b128 v[48:51], v4 offset:49152
    v_and_b32 v132, 15, v2
    v_lshrrev_b32 v133, 4, v2
    v_lshlrev_b32 v132, 10, v132
    v_lshl_add_u32 v132, v133, 3, v132
    v_lshlrev_b32 v133, 4, v133
    s_add_u32 s24, s49, 33554432
    s_add_u32 s33, s50, 33554432
    s_lshl_b32 s32, s19, 6
    s_add_u32 s32, s32, 10240
    buffer_load_dwordx2 v[124:125], v132, s[4:7], s24 offen sc1
    buffer_load_dwordx2 v[126:127], v132, s[4:7], s33 offen sc1
    buffer_load_dwordx4 v[128:131], v133, s[4:7], s32 offen sc1
    v_mul_f32 v100, v100, v116
    v_mul_f32 v101, v101, v117
    v_mul_f32 v102, v102, v118
    v_mul_f32 v103, v103, v119
    s_waitcnt lgkmcnt(5)
    v_mfma_f32_32x32x16_bf16 v[32:47], v[228:231], v[60:63], v[32:47]
    ds_read_b128 v[52:55], v8 offset:49152
    v_mul_f32 v104, v104, v120
    v_mul_f32 v105, v105, v121
    v_mul_f32 v106, v106, v122
    v_mul_f32 v107, v107, v123
    s_waitcnt vmcnt(8) lgkmcnt(5)
    v_mfma_f32_32x32x16_bf16 v[16:31], v[232:235], v[64:67], v[16:31]
    ds_read_b128 v[56:59], v5 offset:49152
    s_waitcnt lgkmcnt(5)
    v_mfma_f32_32x32x16_bf16 v[32:47], v[232:235], v[68:71], v[32:47]
    ds_read_b128 v[60:63], v9 offset:49152
    s_waitcnt vmcnt(7) lgkmcnt(5)
    v_mfma_f32_32x32x16_bf16 v[16:31], v[236:239], v[72:75], v[16:31]
    ds_read_b128 v[64:67], v6 offset:49152
    s_waitcnt lgkmcnt(5)
    v_mfma_f32_32x32x16_bf16 v[32:47], v[236:239], v[76:79], v[32:47]
    ds_read_b128 v[68:71], v10 offset:49152
    s_waitcnt vmcnt(6) lgkmcnt(5)
    v_mfma_f32_32x32x16_bf16 v[16:31], v[192:195], v[48:51], v[16:31]
    ds_read_b128 v[72:75], v7 offset:49152
    s_waitcnt lgkmcnt(5)
    v_mfma_f32_32x32x16_bf16 v[32:47], v[192:195], v[52:55], v[32:47]
    ds_read_b128 v[76:79], v11 offset:49152
    s_waitcnt vmcnt(5) lgkmcnt(5)
    v_mfma_f32_32x32x16_bf16 v[16:31], v[196:199], v[56:59], v[16:31]
    s_waitcnt lgkmcnt(4)
    v_mfma_f32_32x32x16_bf16 v[32:47], v[196:199], v[60:63], v[32:47]
    s_waitcnt vmcnt(4) lgkmcnt(3)
    v_mfma_f32_32x32x16_bf16 v[16:31], v[200:203], v[64:67], v[16:31]
    s_waitcnt lgkmcnt(2)
    v_mfma_f32_32x32x16_bf16 v[32:47], v[200:203], v[68:71], v[32:47]
    s_waitcnt vmcnt(3) lgkmcnt(1)
    v_mfma_f32_32x32x16_bf16 v[16:31], v[204:207], v[72:75], v[16:31]
    s_waitcnt lgkmcnt(0)
    v_mfma_f32_32x32x16_bf16 v[32:47], v[204:207], v[76:79], v[32:47]
    s_lshl_b32 s21, s12, 12
    s_add_u32 s22, s21, 65536
    s_xor_b32 s21, s21, 16384
    s_add_u32 s21, s21, 65536
    v_add_u32 v4, s22, v1
    v_add_u32 v5, s21, v1
    s_nop 5
    ds_write_b128 v4, v[32:35] offset:0
    ds_write_b128 v4, v[36:39] offset:1024
    ds_write_b128 v4, v[40:43] offset:2048
    ds_write_b128 v4, v[44:47] offset:3072
    v_bfe_u32 v6, v2, 4, 1
    v_mul_u32_u24 v6, 28672, v6
    v_lshrrev_b32 v7, 5, v2
    v_lshl_add_u32 v6, v7, 8, v6
    v_and_b32 v7, 15, v2
    v_lshl_add_u32 v6, v7, 4, v6
    v_lshlrev_b32 v88, 16, v88
    v_add_f32 v16, v16, v88
    v_add_f32 v17, v17, v88
    v_add_f32 v18, v18, v88
    v_add_f32 v19, v19, v88
    v_add_f32 v20, v20, v88
    v_add_f32 v21, v21, v88
    v_add_f32 v22, v22, v88
    v_add_f32 v23, v23, v88
    v_add_f32 v24, v24, v88
    v_add_f32 v25, v25, v88
    v_add_f32 v26, v26, v88
    v_add_f32 v27, v27, v88
    v_add_f32 v28, v28, v88
    v_add_f32 v29, v29, v88
    v_add_f32 v30, v30, v88
    v_add_f32 v31, v31, v88
    s_waitcnt lgkmcnt(0)
    s_barrier
    ds_read_b128 v[48:51], v5 offset:0
    ds_read_b128 v[52:55], v5 offset:1024
    ds_read_b128 v[56:59], v5 offset:2048
    ds_read_b128 v[60:63], v5 offset:3072
    s_waitcnt lgkmcnt(3)
    v_add_f32 v16, v16, v48
    v_add_f32 v17, v17, v49
    v_add_f32 v18, v18, v50
    v_add_f32 v19, v19, v51
    s_waitcnt lgkmcnt(2)
    v_add_f32 v20, v20, v52
    v_add_f32 v21, v21, v53
    v_add_f32 v22, v22, v54
    v_add_f32 v23, v23, v55
    s_waitcnt lgkmcnt(1)
    v_add_f32 v24, v24, v56
    v_add_f32 v25, v25, v57
    v_add_f32 v26, v26, v58
    v_add_f32 v27, v27, v59
    s_waitcnt lgkmcnt(0)
    v_add_f32 v28, v28, v60
    v_add_f32 v29, v29, v61
    v_add_f32 v30, v30, v62
    v_add_f32 v31, v31, v63
    v_mul_f32 v16, v16, v92
    v_mul_f32 v17, v17, v93
    v_mul_f32 v18, v18, v94
    v_mul_f32 v19, v19, v95
    v_mul_f32 v20, v20, v96
    v_mul_f32 v21, v21, v97
    v_mul_f32 v22, v22, v98
    v_mul_f32 v23, v23, v99
    v_mul_f32 v24, v24, v100
    v_mul_f32 v25, v25, v101
    v_mul_f32 v26, v26, v102
    v_mul_f32 v27, v27, v103
    v_mul_f32 v28, v28, v104
    v_mul_f32 v29, v29, v105
    v_mul_f32 v30, v30, v106
    v_mul_f32 v31, v31, v107
    v_cvt_pk_bf16_f32 v64, v16, v17
    v_cvt_pk_bf16_f32 v65, v18, v19
    v_cvt_pk_bf16_f32 v66, v20, v21
    v_cvt_pk_bf16_f32 v67, v22, v23
    v_cvt_pk_bf16_f32 v68, v24, v25
    v_cvt_pk_bf16_f32 v69, v26, v27
    v_cvt_pk_bf16_f32 v70, v28, v29
    v_cvt_pk_bf16_f32 v71, v30, v31
    buffer_store_dwordx4 v[64:67], v6, s[4:7], s25 offen sc1
    s_cmp_eq_u32 s17, 3
    s_cselect_b32 s25, 268435456, s25
    buffer_store_dwordx4 v[68:71], v6, s[4:7], s25 offen offset:512 sc1
    s_barrier
    v_add_u32 v3, s45, v1
    s_add_u32 s22, s47, 4096
    s_add_u32 s23, s47, 8192
    s_add_u32 s24, s47, 12288
    s_mov_b32 s25, 0
    s_mul_i32 s28, s18, 57344
    s_add_u32 s29, s28, s46
    s_sub_u32 s28, 57344, s28
    s_add_u32 s28, s28, s46
    v_add_u32 v12, s29, v1
    v_add_u32 v13, s28, v1
    buffer_load_dwordx4 v[16:19], v1, s[4:7], s47 offen offset:0 sc1
    buffer_load_dwordx4 v[20:23], v1, s[4:7], s47 offen offset:1024 sc1
    buffer_load_dwordx4 v[24:27], v1, s[4:7], s47 offen offset:2048 sc1
    buffer_load_dwordx4 v[28:31], v1, s[4:7], s47 offen offset:3072 sc1
    buffer_load_dwordx4 v[32:35], v1, s[4:7], s22 offen offset:0 sc1
    buffer_load_dwordx4 v[36:39], v1, s[4:7], s22 offen offset:1024 sc1
    buffer_load_dwordx4 v[40:43], v1, s[4:7], s22 offen offset:2048 sc1
    s_waitcnt vmcnt(6)
    v_max_u32 v4, v16, v19
    s_waitcnt vmcnt(5)
    v_max3_u32 v4, v4, v20, v23
    s_waitcnt vmcnt(4)
    v_max3_u32 v4, v4, v24, v27
    s_waitcnt vmcnt(3)
    v_max3_u32 v4, v4, v28, v31
    s_waitcnt vmcnt(2)
    v_max3_u32 v4, v4, v32, v35
    s_waitcnt vmcnt(1)
    v_max3_u32 v4, v4, v36, v39
    s_waitcnt vmcnt(0)
    v_max3_u32 v4, v4, v40, v43
    v_cmp_eq_u32 vcc, -1, v4
    s_nop 0
    s_cbranch_vccnz L_u_retry0
L_u_ok0:
    buffer_load_dwordx4 v[44:47], v1, s[4:7], s22 offen offset:3072 sc1
    buffer_load_dwordx4 v[48:51], v1, s[4:7], s23 offen offset:0 sc1
    buffer_load_dwordx4 v[52:55], v1, s[4:7], s23 offen offset:1024 sc1
    buffer_load_dwordx4 v[56:59], v1, s[4:7], s23 offen offset:2048 sc1
    buffer_load_dwordx4 v[60:63], v1, s[4:7], s23 offen offset:3072 sc1
    buffer_load_dwordx4 v[64:67], v1, s[4:7], s24 offen offset:0 sc1
    buffer_load_dwordx4 v[68:71], v1, s[4:7], s24 offen offset:1024 sc1
    ds_write_b128 v3, v[16:19] offset:0
    ds_write_b128 v3, v[20:23] offset:1024
    ds_write_b128 v3, v[24:27] offset:2048
    ds_write_b128 v3, v[28:31] offset:3072
    ds_write_b128 v3, v[32:35] offset:4096
    ds_write_b128 v3, v[36:39] offset:5120
    ds_write_b128 v3, v[40:43] offset:6144
    s_waitcnt lgkmcnt(0)
    s_barrier
    ds_read_b128 v[72:75], v12 offset:0
    ds_read_b128 v[76:79], v12 offset:28672
    ds_read_b128 v[80:83], v13 offset:0
    ds_read_b128 v[84:87], v13 offset:28672
    s_waitcnt lgkmcnt(0)
    v_mfma_f32_16x16x32_bf16 v[104:107], v[136:139], v[72:75], 0
    ds_read_b128 v[88:91], v12 offset:1024
    ds_read_b128 v[92:95], v12 offset:29696
    ds_read_b128 v[96:99], v13 offset:1024
    ds_read_b128 v[100:103], v13 offset:29696
    v_mfma_f32_16x16x32_bf16 v[108:111], v[136:139], v[76:79], 0
    v_mfma_f32_16x16x32_bf16 v[112:115], v[136:139], v[80:83], 0
    v_mfma_f32_16x16x32_bf16 v[116:119], v[136:139], v[84:87], 0
    s_waitcnt lgkmcnt(0)
    v_mfma_f32_16x16x32_bf16 v[104:107], v[140:143], v[88:91], v[104:107]
    ds_read_b128 v[72:75], v12 offset:2048
    ds_read_b128 v[76:79], v12 offset:30720
    ds_read_b128 v[80:83], v13 offset:2048
    ds_read_b128 v[84:87], v13 offset:30720
    v_mfma_f32_16x16x32_bf16 v[108:111], v[140:143], v[92:95], v[108:111]
    v_mfma_f32_16x16x32_bf16 v[112:115], v[140:143], v[96:99], v[112:115]
    v_mfma_f32_16x16x32_bf16 v[116:119], v[140:143], v[100:103], v[116:119]
    s_waitcnt lgkmcnt(0)
    v_mfma_f32_16x16x32_bf16 v[104:107], v[144:147], v[72:75], v[104:107]
    ds_read_b128 v[88:91], v12 offset:3072
    ds_read_b128 v[92:95], v12 offset:31744
    ds_read_b128 v[96:99], v13 offset:3072
    ds_read_b128 v[100:103], v13 offset:31744
    v_mfma_f32_16x16x32_bf16 v[108:111], v[144:147], v[76:79], v[108:111]
    v_mfma_f32_16x16x32_bf16 v[112:115], v[144:147], v[80:83], v[112:115]
    v_mfma_f32_16x16x32_bf16 v[116:119], v[144:147], v[84:87], v[116:119]
    s_waitcnt lgkmcnt(0)
    v_mfma_f32_16x16x32_bf16 v[104:107], v[148:151], v[88:91], v[104:107]
    v_mfma_f32_16x16x32_bf16 v[108:111], v[148:151], v[92:95], v[108:111]
    v_mfma_f32_16x16x32_bf16 v[112:115], v[148:151], v[96:99], v[112:115]
    v_mfma_f32_16x16x32_bf16 v[116:119], v[148:151], v[100:103], v[116:119]
    s_waitcnt vmcnt(6)
    v_max_u32 v4, v44, v47
    s_waitcnt vmcnt(5)
    v_max3_u32 v4, v4, v48, v51
    s_waitcnt vmcnt(4)
    v_max3_u32 v4, v4, v52, v55
    s_waitcnt vmcnt(3)
    v_max3_u32 v4, v4, v56, v59
    s_waitcnt vmcnt(2)
    v_max3_u32 v4, v4, v60, v63
    s_waitcnt vmcnt(1)
    v_max3_u32 v4, v4, v64, v67
    s_waitcnt vmcnt(0)
    v_max3_u32 v4, v4, v68, v71
    v_cmp_eq_u32 vcc, -1, v4
    s_nop 0
    s_cbranch_vccnz L_u_retry1
L_u_ok1:
    ds_read_b128 v[72:75], v12 offset:4096
    ds_read_b128 v[76:79], v12 offset:32768
    ds_read_b128 v[80:83], v13 offset:4096
    ds_read_b128 v[84:87], v13 offset:32768
    s_waitcnt lgkmcnt(0)
    v_mfma_f32_16x16x32_bf16 v[104:107], v[152:155], v[72:75], v[104:107]
    ds_read_b128 v[88:91], v12 offset:5120
    ds_read_b128 v[92:95], v12 offset:33792
    ds_read_b128 v[96:99], v13 offset:5120
    ds_read_b128 v[100:103], v13 offset:33792
    v_mfma_f32_16x16x32_bf16 v[108:111], v[152:155], v[76:79], v[108:111]
    v_mfma_f32_16x16x32_bf16 v[112:115], v[152:155], v[80:83], v[112:115]
    ds_write_b128 v3, v[44:47] offset:7168
    ds_write_b128 v3, v[48:51] offset:8192
    ds_write_b128 v3, v[52:55] offset:9216
    v_mfma_f32_16x16x32_bf16 v[116:119], v[152:155], v[84:87], v[116:119]
    s_waitcnt lgkmcnt(3)
    v_mfma_f32_16x16x32_bf16 v[104:107], v[156:159], v[88:91], v[104:107]
    ds_read_b128 v[72:75], v12 offset:6144
    ds_read_b128 v[76:79], v12 offset:34816
    ds_read_b128 v[80:83], v13 offset:6144
    ds_read_b128 v[84:87], v13 offset:34816
    v_mfma_f32_16x16x32_bf16 v[108:111], v[156:159], v[92:95], v[108:111]
    v_mfma_f32_16x16x32_bf16 v[112:115], v[156:159], v[96:99], v[112:115]
    ds_write_b128 v3, v[56:59] offset:10240
    ds_write_b128 v3, v[60:63] offset:11264
    ds_write_b128 v3, v[64:67] offset:12288
    v_mfma_f32_16x16x32_bf16 v[116:119], v[156:159], v[100:103], v[116:119]
    s_waitcnt lgkmcnt(3)
    v_mfma_f32_16x16x32_bf16 v[104:107], v[160:163], v[72:75], v[104:107]
    v_mfma_f32_16x16x32_bf16 v[108:111], v[160:163], v[76:79], v[108:111]
    v_mfma_f32_16x16x32_bf16 v[112:115], v[160:163], v[80:83], v[112:115]
    ds_write_b128 v3, v[68:71] offset:13312
    v_mfma_f32_16x16x32_bf16 v[116:119], v[160:163], v[84:87], v[116:119]
    s_waitcnt lgkmcnt(0)
    s_barrier
    ds_read_b128 v[88:91], v12 offset:7168
    ds_read_b128 v[92:95], v12 offset:35840
    ds_read_b128 v[96:99], v13 offset:7168
    ds_read_b128 v[100:103], v13 offset:35840
    s_waitcnt lgkmcnt(0)
    v_mfma_f32_16x16x32_bf16 v[104:107], v[164:167], v[88:91], v[104:107]
    ds_read_b128 v[72:75], v12 offset:8192
    ds_read_b128 v[76:79], v12 offset:36864
    ds_read_b128 v[80:83], v13 offset:8192
    ds_read_b128 v[84:87], v13 offset:36864
    v_mfma_f32_16x16x32_bf16 v[108:111], v[164:167], v[92:95], v[108:111]
    v_mfma_f32_16x16x32_bf16 v[112:115], v[164:167], v[96:99], v[112:115]
    v_mfma_f32_16x16x32_bf16 v[116:119], v[164:167], v[100:103], v[116:119]
    s_waitcnt lgkmcnt(0)
    v_mfma_f32_16x16x32_bf16 v[104:107], v[168:171], v[72:75], v[104:107]
    ds_read_b128 v[88:91], v12 offset:9216
    ds_read_b128 v[92:95], v12 offset:37888
    ds_read_b128 v[96:99], v13 offset:9216
    ds_read_b128 v[100:103], v13 offset:37888
    v_mfma_f32_16x16x32_bf16 v[108:111], v[168:171], v[76:79], v[108:111]
    v_mfma_f32_16x16x32_bf16 v[112:115], v[168:171], v[80:83], v[112:115]
    v_mfma_f32_16x16x32_bf16 v[116:119], v[168:171], v[84:87], v[116:119]
    s_waitcnt lgkmcnt(0)
    v_mfma_f32_16x16x32_bf16 v[104:107], v[172:175], v[88:91], v[104:107]
    ds_read_b128 v[72:75], v12 offset:10240
    ds_read_b128 v[76:79], v12 offset:38912
    ds_read_b128 v[80:83], v13 offset:10240
    ds_read_b128 v[84:87], v13 offset:38912
    v_mfma_f32_16x16x32_bf16 v[108:111], v[172:175], v[92:95], v[108:111]
    v_mfma_f32_16x16x32_bf16 v[112:115], v[172:175], v[96:99], v[112:115]
    v_mfma_f32_16x16x32_bf16 v[116:119], v[172:175], v[100:103], v[116:119]
    s_waitcnt lgkmcnt(0)
    v_mfma_f32_16x16x32_bf16 v[104:107], v[176:179], v[72:75], v[104:107]
    ds_read_b128 v[88:91], v12 offset:11264
    ds_read_b128 v[92:95], v12 offset:39936
    ds_read_b128 v[96:99], v13 offset:11264
    ds_read_b128 v[100:103], v13 offset:39936
    v_mfma_f32_16x16x32_bf16 v[108:111], v[176:179], v[76:79], v[108:111]
    v_mfma_f32_16x16x32_bf16 v[112:115], v[176:179], v[80:83], v[112:115]
    v_mfma_f32_16x16x32_bf16 v[116:119], v[176:179], v[84:87], v[116:119]
    s_waitcnt lgkmcnt(0)
    v_mfma_f32_16x16x32_bf16 v[104:107], v[180:183], v[88:91], v[104:107]
    ds_read_b128 v[72:75], v12 offset:12288
    ds_read_b128 v[76:79], v12 offset:40960
    ds_read_b128 v[80:83], v13 offset:12288
    ds_read_b128 v[84:87], v13 offset:40960
    v_mfma_f32_16x16x32_bf16 v[108:111], v[180:183], v[92:95], v[108:111]
    v_mfma_f32_16x16x32_bf16 v[112:115], v[180:183], v[96:99], v[112:115]
    v_mfma_f32_16x16x32_bf16 v[116:119], v[180:183], v[100:103], v[116:119]
    s_waitcnt lgkmcnt(0)
    v_mfma_f32_16x16x32_bf16 v[104:107], v[184:187], v[72:75], v[104:107]
    ds_read_b128 v[88:91], v12 offset:13312
    ds_read_b128 v[92:95], v12 offset:41984
    ds_read_b128 v[96:99], v13 offset:13312
    ds_read_b128 v[100:103], v13 offset:41984
    v_mfma_f32_16x16x32_bf16 v[108:111], v[184:187], v[76:79], v[108:111]
    v_mfma_f32_16x16x32_bf16 v[112:115], v[184:187], v[80:83], v[112:115]
    v_mfma_f32_16x16x32_bf16 v[116:119], v[184:187], v[84:87], v[116:119]
    s_waitcnt lgkmcnt(0)
    v_mfma_f32_16x16x32_bf16 v[104:107], v[188:191], v[88:91], v[104:107]
    v_mfma_f32_16x16x32_bf16 v[108:111], v[188:191], v[92:95], v[108:111]
    v_mfma_f32_16x16x32_bf16 v[112:115], v[188:191], v[96:99], v[112:115]
    v_mfma_f32_16x16x32_bf16 v[116:119], v[188:191], v[100:103], v[116:119]
    s_lshl_b32 s22, s12, 11
    s_add_u32 s28, s22, 114688
    s_xor_b32 s22, s22, 8192
    s_add_u32 s22, s22, 114688
    v_add_u32 v6, s28, v1
    v_add_u32 v7, s22, v1
    s_nop 0
    ds_write_b128 v6, v[112:115] offset:0
    ds_write_b128 v6, v[116:119] offset:1024
    v_lshlrev_b32 v40, 16, v124
    v_and_b32 v41, s27, v124
    v_lshlrev_b32 v42, 16, v125
    v_and_b32 v43, s27, v125
    v_lshlrev_b32 v44, 16, v126
    v_and_b32 v45, s27, v126
    v_lshlrev_b32 v46, 16, v127
    v_and_b32 v47, s27, v127
    s_waitcnt lgkmcnt(0)
    s_barrier
    ds_read_b128 v[48:51], v7 offset:0
    ds_read_b128 v[52:55], v7 offset:1024
    s_waitcnt lgkmcnt(1)
    v_add_f32 v104, v104, v48
    v_add_f32 v105, v105, v49
    v_add_f32 v106, v106, v50
    v_add_f32 v107, v107, v51
    s_waitcnt lgkmcnt(0)
    v_add_f32 v108, v108, v52
    v_add_f32 v109, v109, v53
    v_add_f32 v110, v110, v54
    v_add_f32 v111, v111, v55
    v_fmac_f32 v40, v104, v128
    v_fmac_f32 v41, v105, v129
    v_fmac_f32 v42, v106, v130
    v_fmac_f32 v43, v107, v131
    v_fmac_f32 v44, v108, v128
    v_fmac_f32 v45, v109, v129
    v_fmac_f32 v46, v110, v130
    v_fmac_f32 v47, v111, v131
    v_cvt_pk_bf16_f32 v56, v40, v41
    v_cvt_pk_bf16_f32 v57, v42, v43
    v_cvt_pk_bf16_f32 v58, v44, v45
    v_cvt_pk_bf16_f32 v59, v46, v47
    buffer_store_dwordx2 v[56:57], v132, s[8:11], s49 offen
    buffer_store_dwordx2 v[58:59], v132, s[8:11], s50 offen
    s_add_u32 s24, s100, 1
    v_mov_b32 v4, s24
    v_mov_b32 v5, 0
    s_or_b32 s24, s2, s12
    s_mov_b32 s25, 51511296
    s_cmp_eq_u32 s24, 0
    s_cselect_b32 s24, s25, 268435456
    s_mov_b64 exec, 1
    buffer_store_dword v4, v5, s[4:7], s24 offen
    s_mov_b64 exec, -1
    s_endpgm
L_g_sync:
    s_setprio 3
    s_lshl_b32 s24, s13, 8
    s_add_u32 s24, s24, s14
    s_lshl_b32 s24, s24, 4
    s_add_u32 s24, s24, 51609600
    v_lshlrev_b32 v2, 5, v1
    v_cmp_lt_u32 vcc, 127, v1
    v_mov_b32 v3, 268435456
    s_nop 0
    v_cndmask_b32 v2, v2, v3, vcc
    v_mov_b32 v3, s51
    buffer_store_dword v3, v2, s[4:7], s24 offen sc1
    s_barrier
    s_branch L_g_mid
L_g_poll0:
    s_lshl_b32 s24, s41, 3
    s_lshr_b32 s59, s40, 2
    s_add_u32 s24, s24, s59
    s_lshl_b32 s24, s24, 9
    s_add_u32 s24, s24, 51609600
    s_mov_b32 s25, 0
    v_and_b32 v17, 0x1f0, v1
L_g_poll:
    buffer_load_dword v16, v17, s[4:7], s24 offen sc1
    s_waitcnt vmcnt(0)
    v_cmp_eq_u32 vcc, s51, v16
    s_nop 0
    s_cmp_eq_u64 vcc, -1
    s_cbranch_scc1 L_g_back
    s_add_u32 s25, s25, 1
    s_cmp_lt_u32 s25, 0x100000
    s_sleep 2
    s_cbranch_scc1 L_g_poll
    s_branch L_g_back
L_u_retry0:
    buffer_load_dwordx4 v[16:19], v1, s[4:7], s47 offen offset:0 sc1
    buffer_load_dwordx4 v[40:43], v1, s[4:7], s22 offen offset:2048 sc1
    s_waitcnt vmcnt(1)
    v_max_u32 v4, v16, v19
    s_waitcnt vmcnt(0)
    v_max3_u32 v4, v4, v40, v43
    v_cmp_eq_u32 vcc, -1, v4
    s_add_u32 s25, s25, 1
    s_cmp_ge_u32 s25, 0x40000
    s_cbranch_scc1 L_u_ok0
    s_cbranch_vccz L_u_retry0_all
    s_sleep 1
    s_branch L_u_retry0
L_u_retry0_all:
    buffer_load_dwordx4 v[20:23], v1, s[4:7], s47 offen offset:1024 sc1
    buffer_load_dwordx4 v[24:27], v1, s[4:7], s47 offen offset:2048 sc1
    buffer_load_dwordx4 v[28:31], v1, s[4:7], s47 offen offset:3072 sc1
    buffer_load_dwordx4 v[32:35], v1, s[4:7], s22 offen offset:0 sc1
    buffer_load_dwordx4 v[36:39], v1, s[4:7], s22 offen offset:1024 sc1
    s_waitcnt vmcnt(4)
    v_max_u32 v4, v20, v23
    s_waitcnt vmcnt(3)
    v_max3_u32 v4, v4, v24, v27
    s_waitcnt vmcnt(2)
    v_max3_u32 v4, v4, v28, v31
    s_waitcnt vmcnt(1)
    v_max3_u32 v4, v4, v32, v35
    s_waitcnt vmcnt(0)
    v_max3_u32 v4, v4, v36, v39
    v_cmp_eq_u32 vcc, -1, v4
    s_nop 0
    s_cbranch_vccz L_u_ok0
    s_branch L_u_retry0
L_u_retry1:
    buffer_load_dwordx4 v[44:47], v1, s[4:7], s22 offen offset:3072 sc1
    buffer_load_dwordx4 v[68:71], v1, s[4:7], s24 offen offset:1024 sc1
    s_waitcnt vmcnt(1)
    v_max_u32 v4, v44, v47
    s_waitcnt vmcnt(0)
    v_max3_u32 v4, v4, v68, v71
    v_cmp_eq_u32 vcc, -1, v4
    s_add_u32 s25, s25, 1
    s_cmp_ge_u32 s25, 0x40000
    s_cbranch_scc1 L_u_ok1
    s_cbranch_vccz L_u_retry1_all
    s_sleep 1
    s_branch L_u_retry1
L_u_retry1_all:
    buffer_load_dwordx4 v[48:51], v1, s[4:7], s23 offen offset:0 sc1
    buffer_load_dwordx4 v[52:55], v1, s[4:7], s23 offen offset:1024 sc1
    buffer_load_dwordx4 v[56:59], v1, s[4:7], s23 offen offset:2048 sc1
    buffer_load_dwordx4 v[60:63], v1, s[4:7], s23 offen offset:3072 sc1
    buffer_load_dwordx4 v[64:67], v1, s[4:7], s24 offen offset:0 sc1
    s_waitcnt vmcnt(4)
    v_max_u32 v4, v48, v51
    s_waitcnt vmcnt(3)
    v_max3_u32 v4, v4, v52, v55
    s_waitcnt vmcnt(2)
    v_max3_u32 v4, v4, v56, v59
    s_waitcnt vmcnt(1)
    v_max3_u32 v4, v4, v60, v63
    s_waitcnt vmcnt(0)
    v_max3_u32 v4, v4, v64, v67
    v_cmp_eq_u32 vcc, -1, v4
    s_nop 0
    s_cbranch_vccz L_u_ok1
    s_branch L_u_retry1
L_h1_sync:
    s_lshl_b32 s24, s14, 11
    s_add_u32 s24, s24, 51380224
    s_lshl_b32 s25, s13, 2
    s_add_u32 s25, s25, s24
    v_mov_b32 v2, s51
    v_mov_b32 v3, 0
    v_lshrrev_b32 v4, 2, v1
    v_min_u32 v4, 28, v4
    s_setprio 3
    s_mov_b64 exec, 1
    buffer_store_dword v2, v3, s[4:7], s25 offen sc1
    s_mov_b64 exec, -1
    s_mov_b32 s25, 0
    s_barrier
    s_branch L_h1_mid
L_h1_poll0:
L_h1_poll:
    buffer_load_dword v2, v4, s[4:7], s24 offen sc1
    s_waitcnt vmcnt(0)
    v_cmp_eq_u32 vcc, s51, v2
    s_nop 0
    s_cmp_eq_u64 vcc, -1
    s_cbranch_scc1 L_h1_back
    s_add_u32 s25, s25, 1
    s_cmp_lt_u32 s25, 0x100000
    s_sleep 1
    s_cbranch_scc1 L_h1_poll
    s_branch L_h1_back
L_h2_spin:
    buffer_load_dwordx4 v[92:95], v1, s[4:7], s20 offen offset:3072 sc1
    s_waitcnt vmcnt(0)
    v_max_u32 v8, v92, v95
    v_cmp_eq_u32 vcc, -1, v8
    s_add_u32 s25, s25, 1
    s_cmp_ge_u32 s25, 0x40000
    s_cbranch_scc1 L_h2_got
    s_cbranch_vccz L_h2_poll
    s_sleep 1
    s_branch L_h2_spin
L_k2_end:
    s_endpgm
L_p0_pub:
    v_lshrrev_b32 v3, 2, v1
    v_add_u32 v3, 135168, v3
    ds_read_b32 v64, v3 offset:0
    ds_read_b32 v65, v3 offset:256
    ds_read_b32 v66, v3 offset:512
    ds_read_b32 v67, v3 offset:768
    ds_read_b32 v68, v3 offset:1024
    ds_read_b32 v69, v3 offset:1280
    ds_read_b32 v70, v3 offset:1536
    ds_read_b32 v71, v3 offset:1792
    s_waitcnt lgkmcnt(6)
    v_add_f32 v64, v64, v65
    s_waitcnt lgkmcnt(5)
    v_add_f32 v64, v64, v66
    s_waitcnt lgkmcnt(4)
    v_add_f32 v64, v64, v67
    s_waitcnt lgkmcnt(3)
    v_add_f32 v64, v64, v68
    s_waitcnt lgkmcnt(2)
    v_add_f32 v64, v64, v69
    s_waitcnt lgkmcnt(1)
    v_add_f32 v64, v64, v70
    s_waitcnt lgkmcnt(0)
    v_add_f32 v64, v64, v71
    v_mov_b32 v65, s51
    v_lshrrev_b32 v3, 1, v1
    s_mul_i32 s33, s26, 24576
    s_lshl_b32 s34, s27, 9
    s_add_u32 s33, s33, s34
    s_add_u32 s33, s33, 131072
    s_cmp_lt_u32 s2, 192
    s_cselect_b32 s33, s33, 268435456
    buffer_store_dwordx2 v[64:65], v3, s[4:7], s33 offen sc1
    s_branch L_p0_pubd
L_p0_f1:
    s_waitcnt vmcnt(0)
L_p0_f1c:
    v_cmp_ne_u32 vcc, s51, v86
    s_add_u32 s59, s59, 1
    s_cbranch_vccz L_p0_f1d
    s_cmp_ge_u32 s59, 0x100000
    s_cbranch_scc1 L_p0_f1d
    s_sleep 1
    buffer_load_dword v86, v87, s[4:7], s58 offen sc1
    s_waitcnt vmcnt(0)
    s_branch L_p0_f1c
L_p0_gre:
    buffer_load_dwordx4 v[48:51], v1, s[4:7], s33 offen sc1
    buffer_load_dwordx4 v[52:55], v1, s[4:7], s34 offen sc1
    buffer_load_dwordx4 v[56:59], v1, s[4:7], s35 offen sc1
    buffer_load_dwordx4 v[60:63], v1, s[4:7], s32 offen sc1
    s_waitcnt vmcnt(3)
    v_xor_b32 v80, s51, v49
    v_xor_b32 v81, s51, v51
    v_or_b32 v80, v80, v81
    s_waitcnt vmcnt(2)
    v_xor_b32 v81, s51, v53
    v_or_b32 v80, v80, v81
    v_xor_b32 v81, s51, v55
    v_or_b32 v80, v80, v81
    s_waitcnt vmcnt(1)
    v_xor_b32 v81, s51, v57
    v_or_b32 v80, v80, v81
    v_xor_b32 v81, s51, v59
    v_or_b32 v80, v80, v81
    s_waitcnt vmcnt(0)
    v_xor_b32 v81, s51, v61
    v_or_b32 v80, v80, v81
    v_xor_b32 v81, s51, v63
    v_or_b32 v80, v80, v81
    v_cmp_ne_u32 vcc, 0, v80
    s_add_u32 s59, s59, 1
    s_cbranch_vccz L_p0_got
    s_cmp_lt_u32 s59, 0x40000
    s_sleep 2
    s_cbranch_scc1 L_p0_gre
    s_branch L_p0_got
L_p0_w7:
    s_mov_b32 s59, 0
    s_cmp_ge_u32 s2, 32
    s_cbranch_scc1 L_p0_w7d
    s_lshl_b32 s33, s2, 9
    s_add_u32 s33, s33, 139264
    s_add_u32 s34, s33, 24576
    s_add_u32 s35, s33, 49152
    s_add_u32 s24, s33, 73728
    v_lshrrev_b32 v68, 1, v1
L_p0_fin:
    buffer_load_dwordx2 v[70:71], v68, s[4:7], s33 offen sc1
    buffer_load_dwordx2 v[72:73], v68, s[4:7], s34 offen sc1
    buffer_load_dwordx2 v[74:75], v68, s[4:7], s35 offen sc1
    buffer_load_dwordx2 v[76:77], v68, s[4:7], s24 offen sc1
    s_waitcnt vmcnt(3)
    v_xor_b32 v78, s51, v71
    s_waitcnt vmcnt(2)
    v_xor_b32 v79, s51, v73
    v_or_b32 v78, v78, v79
    s_waitcnt vmcnt(1)
    v_xor_b32 v79, s51, v75
    v_or_b32 v78, v78, v79
    s_waitcnt vmcnt(0)
    v_xor_b32 v79, s51, v77
    v_or_b32 v78, v78, v79
    v_cmp_ne_u32 vcc, 0, v78
    s_add_u32 s59, s59, 1
    s_cbranch_vccz L_p0_fin2
    s_cmp_lt_u32 s59, 0x40000
    s_sleep 1
    s_cbranch_scc1 L_p0_fin
L_p0_fin2:
    s_lshr_b32 s33, s2, 3
    s_cmp_eq_u32 s33, 2
    s_cselect_b32 s33, 1.0, 0
    v_add_f32 v70, v70, v72
    v_add_f32 v74, v74, v76
    v_add_f32 v70, v70, v74
    v_cvt_pk_bf16_f32 v70, v70, v70
    v_and_b32 v70, s28, v70
    v_add_f32 v70, s33, v70
    v_cvt_pk_bf16_f32 v70, v70, v70
    v_and_b32 v70, s28, v70
    v_lshrrev_b32 v68, 2, v1
    s_lshl_b32 s33, s2, 8
    s_add_u32 s33, s33, 4096
    buffer_store_dword v70, v68, s[4:7], s33 offen sc1
    v_lshrrev_b32 v68, 3, v1
    s_lshl_b32 s33, s2, 7
    s_add_u32 s33, s33, 18432
    buffer_store_short_d16_hi v70, v68, s[4:7], s33 offen sc1
    s_branch L_p0_w7d
L_f2_spin:
    s_mov_b32 s35, 0
L_f2_loop:
    buffer_load_dwordx4 v[252:255], v1, s[4:7], s3 offen sc1
    s_waitcnt vmcnt(0)
    v_xor_b32 v252, s51, v252
    v_xor_b32 v253, s51, v253
    v_xor_b32 v254, s51, v254
    v_xor_b32 v255, s51, v255
    v_or3_b32 v252, v252, v253, v254
    v_or_b32 v252, v252, v255
    v_cmp_ne_u32 vcc, 0, v252
    s_add_u32 s35, s35, 1
    s_cbranch_vccz L_f2_ok
    s_cmp_lt_u32 s35, 0x100000
    s_sleep 2
    s_cbranch_scc1 L_f2_loop
    s_branch L_f2_ok
L_fix1:
    s_nop 15
    v_mov_b32 v9, v8
    s_nop 1
    v_permlane32_swap_b32 v8, v9
    v_max_f32 v8, v8, v9
    v_add_f32 v8, s31, v8
    v_ceil_f32 v8, v8
    v_max_f32 v8, 0, v8
    v_min_f32 v9, 0x43800000, v8
    v_cvt_i32_f32 v9, v9
    v_sub_u32 v9, 0, v9
    v_ldexp_f32 v6, v6, v9
    v_ldexp_f32 v7, v7, v9
    v_lshlrev_b32 v10, 16, v160
    v_and_b32 v160, s28, v160
    v_ldexp_f32 v10, v10, v9
    v_ldexp_f32 v160, v160, v9
    v_cvt_pk_bf16_f32 v160, v10, v160
    v_lshlrev_b32 v10, 16, v161
    v_and_b32 v161, s28, v161
    v_ldexp_f32 v10, v10, v9
    v_ldexp_f32 v161, v161, v9
    v_cvt_pk_bf16_f32 v161, v10, v161
    v_lshlrev_b32 v10, 16, v162
    v_and_b32 v162, s28, v162
    v_ldexp_f32 v10, v10, v9
    v_ldexp_f32 v162, v162, v9
    v_cvt_pk_bf16_f32 v162, v10, v162
    v_lshlrev_b32 v10, 16, v163
    v_and_b32 v163, s28, v163
    v_ldexp_f32 v10, v10, v9
    v_ldexp_f32 v163, v163, v9
    v_cvt_pk_bf16_f32 v163, v10, v163
    v_lshlrev_b32 v10, 16, v164
    v_and_b32 v164, s28, v164
    v_ldexp_f32 v10, v10, v9
    v_ldexp_f32 v164, v164, v9
    v_cvt_pk_bf16_f32 v164, v10, v164
    v_lshlrev_b32 v10, 16, v165
    v_and_b32 v165, s28, v165
    v_ldexp_f32 v10, v10, v9
    v_ldexp_f32 v165, v165, v9
    v_cvt_pk_bf16_f32 v165, v10, v165
    v_lshlrev_b32 v10, 16, v166
    v_and_b32 v166, s28, v166
    v_ldexp_f32 v10, v10, v9
    v_ldexp_f32 v166, v166, v9
    v_cvt_pk_bf16_f32 v166, v10, v166
    v_lshlrev_b32 v10, 16, v167
    v_and_b32 v167, s28, v167
    v_ldexp_f32 v10, v10, v9
    v_ldexp_f32 v167, v167, v9
    v_cvt_pk_bf16_f32 v167, v10, v167
    v_sub_f32 v176, v176, v8
    v_sub_f32 v177, v177, v8
    v_sub_f32 v178, v178, v8
    v_sub_f32 v179, v179, v8
    v_sub_f32 v180, v180, v8
    v_sub_f32 v181, v181, v8
    v_sub_f32 v182, v182, v8
    v_sub_f32 v183, v183, v8
    v_sub_f32 v184, v184, v8
    v_sub_f32 v185, v185, v8
    v_sub_f32 v186, v186, v8
    v_sub_f32 v187, v187, v8
    v_sub_f32 v188, v188, v8
    v_sub_f32 v189, v189, v8
    v_sub_f32 v190, v190, v8
    v_sub_f32 v191, v191, v8
    v_sub_f32 v192, v192, v8
    v_sub_f32 v193, v193, v8
    v_sub_f32 v194, v194, v8
    v_sub_f32 v195, v195, v8
    v_sub_f32 v196, v196, v8
    v_sub_f32 v197, v197, v8
    v_sub_f32 v198, v198, v8
    v_sub_f32 v199, v199, v8
    v_sub_f32 v200, v200, v8
    v_sub_f32 v201, v201, v8
    v_sub_f32 v202, v202, v8
    v_sub_f32 v203, v203, v8
    v_sub_f32 v204, v204, v8
    v_sub_f32 v205, v205, v8
    v_sub_f32 v206, v206, v8
    v_sub_f32 v207, v207, v8
    v_sub_f32 v48, v48, v8
    v_sub_f32 v49, v49, v8
    v_sub_f32 v50, v50, v8
    v_sub_f32 v51, v51, v8
    v_sub_f32 v52, v52, v8
    v_sub_f32 v53, v53, v8
    v_sub_f32 v54, v54, v8
    v_sub_f32 v55, v55, v8
    v_sub_f32 v56, v56, v8
    v_sub_f32 v57, v57, v8
    v_sub_f32 v58, v58, v8
    v_sub_f32 v59, v59, v8
    v_sub_f32 v60, v60, v8
    v_sub_f32 v61, v61, v8
    v_sub_f32 v62, v62, v8
    v_sub_f32 v63, v63, v8
    s_nop 1
    s_branch L_ret1
L_fix2:
    s_nop 15
    v_mov_b32 v9, v8
    s_nop 1
    v_permlane32_swap_b32 v8, v9
    v_max_f32 v8, v8, v9
    v_add_f32 v8, s31, v8
    v_ceil_f32 v8, v8
    v_max_f32 v8, 0, v8
    v_min_f32 v9, 0x43800000, v8
    v_cvt_i32_f32 v9, v9
    v_sub_u32 v9, 0, v9
    v_ldexp_f32 v96, v96, v9
    v_ldexp_f32 v97, v97, v9
    v_ldexp_f32 v98, v98, v9
    v_ldexp_f32 v99, v99, v9
    v_ldexp_f32 v100, v100, v9
    v_ldexp_f32 v101, v101, v9
    v_ldexp_f32 v102, v102, v9
    v_ldexp_f32 v103, v103, v9
    v_ldexp_f32 v104, v104, v9
    v_ldexp_f32 v105, v105, v9
    v_ldexp_f32 v106, v106, v9
    v_ldexp_f32 v107, v107, v9
    v_ldexp_f32 v108, v108, v9
    v_ldexp_f32 v109, v109, v9
    v_ldexp_f32 v110, v110, v9
    v_ldexp_f32 v111, v111, v9
    v_ldexp_f32 v112, v112, v9
    v_ldexp_f32 v113, v113, v9
    v_ldexp_f32 v114, v114, v9
    v_ldexp_f32 v115, v115, v9
    v_ldexp_f32 v116, v116, v9
    v_ldexp_f32 v117, v117, v9
    v_ldexp_f32 v118, v118, v9
    v_ldexp_f32 v119, v119, v9
    v_ldexp_f32 v120, v120, v9
    v_ldexp_f32 v121, v121, v9
    v_ldexp_f32 v122, v122, v9
    v_ldexp_f32 v123, v123, v9
    v_ldexp_f32 v124, v124, v9
    v_ldexp_f32 v125, v125, v9
    v_ldexp_f32 v126, v126, v9
    v_ldexp_f32 v127, v127, v9
    v_ldexp_f32 v128, v128, v9
    v_ldexp_f32 v129, v129, v9
    v_ldexp_f32 v130, v130, v9
    v_ldexp_f32 v131, v131, v9
    v_ldexp_f32 v132, v132, v9
    v_ldexp_f32 v133, v133, v9
    v_ldexp_f32 v134, v134, v9
    v_ldexp_f32 v135, v135, v9
    v_ldexp_f32 v136, v136, v9
    v_ldexp_f32 v137, v137, v9
    v_ldexp_f32 v138, v138, v9
    v_ldexp_f32 v139, v139, v9
    v_ldexp_f32 v140, v140, v9
    v_ldexp_f32 v141, v141, v9
    v_ldexp_f32 v142, v142, v9
    v_ldexp_f32 v143, v143, v9
    v_ldexp_f32 v144, v144, v9
    v_ldexp_f32 v145, v145, v9
    v_ldexp_f32 v146, v146, v9
    v_ldexp_f32 v147, v147, v9
    v_ldexp_f32 v148, v148, v9
    v_ldexp_f32 v149, v149, v9
    v_ldexp_f32 v150, v150, v9
    v_ldexp_f32 v151, v151, v9
    v_ldexp_f32 v152, v152, v9
    v_ldexp_f32 v153, v153, v9
    v_ldexp_f32 v154, v154, v9
    v_ldexp_f32 v155, v155, v9
    v_ldexp_f32 v156, v156, v9
    v_ldexp_f32 v157, v157, v9
    v_ldexp_f32 v158, v158, v9
    v_ldexp_f32 v159, v159, v9
    v_ldexp_f32 v6, v6, v9
    v_ldexp_f32 v7, v7, v9
    v_lshlrev_b32 v10, 16, v176
    v_and_b32 v176, s28, v176
    v_ldexp_f32 v10, v10, v9
    v_ldexp_f32 v176, v176, v9
    v_cvt_pk_bf16_f32 v176, v10, v176
    v_lshlrev_b32 v10, 16, v177
    v_and_b32 v177, s28, v177
    v_ldexp_f32 v10, v10, v9
    v_ldexp_f32 v177, v177, v9
    v_cvt_pk_bf16_f32 v177, v10, v177
    v_lshlrev_b32 v10, 16, v178
    v_and_b32 v178, s28, v178
    v_ldexp_f32 v10, v10, v9
    v_ldexp_f32 v178, v178, v9
    v_cvt_pk_bf16_f32 v178, v10, v178
    v_lshlrev_b32 v10, 16, v179
    v_and_b32 v179, s28, v179
    v_ldexp_f32 v10, v10, v9
    v_ldexp_f32 v179, v179, v9
    v_cvt_pk_bf16_f32 v179, v10, v179
    v_lshlrev_b32 v10, 16, v180
    v_and_b32 v180, s28, v180
    v_ldexp_f32 v10, v10, v9
    v_ldexp_f32 v180, v180, v9
    v_cvt_pk_bf16_f32 v180, v10, v180
    v_lshlrev_b32 v10, 16, v181
    v_and_b32 v181, s28, v181
    v_ldexp_f32 v10, v10, v9
    v_ldexp_f32 v181, v181, v9
    v_cvt_pk_bf16_f32 v181, v10, v181
    v_lshlrev_b32 v10, 16, v182
    v_and_b32 v182, s28, v182
    v_ldexp_f32 v10, v10, v9
    v_ldexp_f32 v182, v182, v9
    v_cvt_pk_bf16_f32 v182, v10, v182
    v_lshlrev_b32 v10, 16, v183
    v_and_b32 v183, s28, v183
    v_ldexp_f32 v10, v10, v9
    v_ldexp_f32 v183, v183, v9
    v_cvt_pk_bf16_f32 v183, v10, v183
    v_sub_f32 v192, v192, v8
    v_sub_f32 v193, v193, v8
    v_sub_f32 v194, v194, v8
    v_sub_f32 v195, v195, v8
    v_sub_f32 v196, v196, v8
    v_sub_f32 v197, v197, v8
    v_sub_f32 v198, v198, v8
    v_sub_f32 v199, v199, v8
    v_sub_f32 v200, v200, v8
    v_sub_f32 v201, v201, v8
    v_sub_f32 v202, v202, v8
    v_sub_f32 v203, v203, v8
    v_sub_f32 v204, v204, v8
    v_sub_f32 v205, v205, v8
    v_sub_f32 v206, v206, v8
    v_sub_f32 v207, v207, v8
    v_sub_f32 v208, v208, v8
    v_sub_f32 v209, v209, v8
    v_sub_f32 v210, v210, v8
    v_sub_f32 v211, v211, v8
    v_sub_f32 v212, v212, v8
    v_sub_f32 v213, v213, v8
    v_sub_f32 v214, v214, v8
    v_sub_f32 v215, v215, v8
    v_sub_f32 v216, v216, v8
    v_sub_f32 v217, v217, v8
    v_sub_f32 v218, v218, v8
    v_sub_f32 v219, v219, v8
    v_sub_f32 v220, v220, v8
    v_sub_f32 v221, v221, v8
    v_sub_f32 v222, v222, v8
    v_sub_f32 v223, v223, v8
    v_sub_f32 v48, v48, v8
    v_sub_f32 v49, v49, v8
    v_sub_f32 v50, v50, v8
    v_sub_f32 v51, v51, v8
    v_sub_f32 v52, v52, v8
    v_sub_f32 v53, v53, v8
    v_sub_f32 v54, v54, v8
    v_sub_f32 v55, v55, v8
    v_sub_f32 v56, v56, v8
    v_sub_f32 v57, v57, v8
    v_sub_f32 v58, v58, v8
    v_sub_f32 v59, v59, v8
    v_sub_f32 v60, v60, v8
    v_sub_f32 v61, v61, v8
    v_sub_f32 v62, v62, v8
    v_sub_f32 v63, v63, v8
    s_nop 1
    s_branch L_ret2
L_fix3:
    s_nop 15
    v_mov_b32 v9, v8
    s_nop 1
    v_permlane32_swap_b32 v8, v9
    v_max_f32 v8, v8, v9
    v_add_f32 v8, s31, v8
    v_ceil_f32 v8, v8
    v_max_f32 v8, 0, v8
    v_min_f32 v9, 0x43800000, v8
    v_cvt_i32_f32 v9, v9
    v_sub_u32 v9, 0, v9
    v_ldexp_f32 v96, v96, v9
    v_ldexp_f32 v97, v97, v9
    v_ldexp_f32 v98, v98, v9
    v_ldexp_f32 v99, v99, v9
    v_ldexp_f32 v100, v100, v9
    v_ldexp_f32 v101, v101, v9
    v_ldexp_f32 v102, v102, v9
    v_ldexp_f32 v103, v103, v9
    v_ldexp_f32 v104, v104, v9
    v_ldexp_f32 v105, v105, v9
    v_ldexp_f32 v106, v106, v9
    v_ldexp_f32 v107, v107, v9
    v_ldexp_f32 v108, v108, v9
    v_ldexp_f32 v109, v109, v9
    v_ldexp_f32 v110, v110, v9
    v_ldexp_f32 v111, v111, v9
    v_ldexp_f32 v112, v112, v9
    v_ldexp_f32 v113, v113, v9
    v_ldexp_f32 v114, v114, v9
    v_ldexp_f32 v115, v115, v9
    v_ldexp_f32 v116, v116, v9
    v_ldexp_f32 v117, v117, v9
    v_ldexp_f32 v118, v118, v9
    v_ldexp_f32 v119, v119, v9
    v_ldexp_f32 v120, v120, v9
    v_ldexp_f32 v121, v121, v9
    v_ldexp_f32 v122, v122, v9
    v_ldexp_f32 v123, v123, v9
    v_ldexp_f32 v124, v124, v9
    v_ldexp_f32 v125, v125, v9
    v_ldexp_f32 v126, v126, v9
    v_ldexp_f32 v127, v127, v9
    v_ldexp_f32 v128, v128, v9
    v_ldexp_f32 v129, v129, v9
    v_ldexp_f32 v130, v130, v9
    v_ldexp_f32 v131, v131, v9
    v_ldexp_f32 v132, v132, v9
    v_ldexp_f32 v133, v133, v9
    v_ldexp_f32 v134, v134, v9
    v_ldexp_f32 v135, v135, v9
    v_ldexp_f32 v136, v136, v9
    v_ldexp_f32 v137, v137, v9
    v_ldexp_f32 v138, v138, v9
    v_ldexp_f32 v139, v139, v9
    v_ldexp_f32 v140, v140, v9
    v_ldexp_f32 v141, v141, v9
    v_ldexp_f32 v142, v142, v9
    v_ldexp_f32 v143, v143, v9
    v_ldexp_f32 v144, v144, v9
    v_ldexp_f32 v145, v145, v9
    v_ldexp_f32 v146, v146, v9
    v_ldexp_f32 v147, v147, v9
    v_ldexp_f32 v148, v148, v9
    v_ldexp_f32 v149, v149, v9
    v_ldexp_f32 v150, v150, v9
    v_ldexp_f32 v151, v151, v9
    v_ldexp_f32 v152, v152, v9
    v_ldexp_f32 v153, v153, v9
    v_ldexp_f32 v154, v154, v9
    v_ldexp_f32 v155, v155, v9
    v_ldexp_f32 v156, v156, v9
    v_ldexp_f32 v157, v157, v9
    v_ldexp_f32 v158, v158, v9
    v_ldexp_f32 v159, v159, v9
    v_ldexp_f32 v6, v6, v9
    v_ldexp_f32 v7, v7, v9
    v_lshlrev_b32 v10, 16, v192
    v_and_b32 v192, s28, v192
    v_ldexp_f32 v10, v10, v9
    v_ldexp_f32 v192, v192, v9
    v_cvt_pk_bf16_f32 v192, v10, v192
    v_lshlrev_b32 v10, 16, v193
    v_and_b32 v193, s28, v193
    v_ldexp_f32 v10, v10, v9
    v_ldexp_f32 v193, v193, v9
    v_cvt_pk_bf16_f32 v193, v10, v193
    v_lshlrev_b32 v10, 16, v194
    v_and_b32 v194, s28, v194
    v_ldexp_f32 v10, v10, v9
    v_ldexp_f32 v194, v194, v9
    v_cvt_pk_bf16_f32 v194, v10, v194
    v_lshlrev_b32 v10, 16, v195
    v_and_b32 v195, s28, v195
    v_ldexp_f32 v10, v10, v9
    v_ldexp_f32 v195, v195, v9
    v_cvt_pk_bf16_f32 v195, v10, v195
    v_lshlrev_b32 v10, 16, v196
    v_and_b32 v196, s28, v196
    v_ldexp_f32 v10, v10, v9
    v_ldexp_f32 v196, v196, v9
    v_cvt_pk_bf16_f32 v196, v10, v196
    v_lshlrev_b32 v10, 16, v197
    v_and_b32 v197, s28, v197
    v_ldexp_f32 v10, v10, v9
    v_ldexp_f32 v197, v197, v9
    v_cvt_pk_bf16_f32 v197, v10, v197
    v_lshlrev_b32 v10, 16, v198
    v_and_b32 v198, s28, v198
    v_ldexp_f32 v10, v10, v9
    v_ldexp_f32 v198, v198, v9
    v_cvt_pk_bf16_f32 v198, v10, v198
    v_lshlrev_b32 v10, 16, v199
    v_and_b32 v199, s28, v199
    v_ldexp_f32 v10, v10, v9
    v_ldexp_f32 v199, v199, v9
    v_cvt_pk_bf16_f32 v199, v10, v199
    v_sub_f32 v208, v208, v8
    v_sub_f32 v209, v209, v8
    v_sub_f32 v210, v210, v8
    v_sub_f32 v211, v211, v8
    v_sub_f32 v212, v212, v8
    v_sub_f32 v213, v213, v8
    v_sub_f32 v214, v214, v8
    v_sub_f32 v215, v215, v8
    v_sub_f32 v216, v216, v8
    v_sub_f32 v217, v217, v8
    v_sub_f32 v218, v218, v8
    v_sub_f32 v219, v219, v8
    v_sub_f32 v220, v220, v8
    v_sub_f32 v221, v221, v8
    v_sub_f32 v222, v222, v8
    v_sub_f32 v223, v223, v8
    v_sub_f32 v160, v160, v8
    v_sub_f32 v161, v161, v8
    v_sub_f32 v162, v162, v8
    v_sub_f32 v163, v163, v8
    v_sub_f32 v164, v164, v8
    v_sub_f32 v165, v165, v8
    v_sub_f32 v166, v166, v8
    v_sub_f32 v167, v167, v8
    v_sub_f32 v168, v168, v8
    v_sub_f32 v169, v169, v8
    v_sub_f32 v170, v170, v8
    v_sub_f32 v171, v171, v8
    v_sub_f32 v172, v172, v8
    v_sub_f32 v173, v173, v8
    v_sub_f32 v174, v174, v8
    v_sub_f32 v175, v175, v8
    v_sub_f32 v48, v48, v8
    v_sub_f32 v49, v49, v8
    v_sub_f32 v50, v50, v8
    v_sub_f32 v51, v51, v8
    v_sub_f32 v52, v52, v8
    v_sub_f32 v53, v53, v8
    v_sub_f32 v54, v54, v8
    v_sub_f32 v55, v55, v8
    v_sub_f32 v56, v56, v8
    v_sub_f32 v57, v57, v8
    v_sub_f32 v58, v58, v8
    v_sub_f32 v59, v59, v8
    v_sub_f32 v60, v60, v8
    v_sub_f32 v61, v61, v8
    v_sub_f32 v62, v62, v8
    v_sub_f32 v63, v63, v8
    s_nop 1
    s_branch L_ret3
L_fix4:
    s_nop 15
    v_mov_b32 v9, v8
    s_nop 1
    v_permlane32_swap_b32 v8, v9
    v_max_f32 v8, v8, v9
    v_add_f32 v8, s31, v8
    v_ceil_f32 v8, v8
    v_max_f32 v8, 0, v8
    v_min_f32 v9, 0x43800000, v8
    v_cvt_i32_f32 v9, v9
    v_sub_u32 v9, 0, v9
    v_ldexp_f32 v96, v96, v9
    v_ldexp_f32 v97, v97, v9
    v_ldexp_f32 v98, v98, v9
    v_ldexp_f32 v99, v99, v9
    v_ldexp_f32 v100, v100, v9
    v_ldexp_f32 v101, v101, v9
    v_ldexp_f32 v102, v102, v9
    v_ldexp_f32 v103, v103, v9
    v_ldexp_f32 v104, v104, v9
    v_ldexp_f32 v105, v105, v9
    v_ldexp_f32 v106, v106, v9
    v_ldexp_f32 v107, v107, v9
    v_ldexp_f32 v108, v108, v9
    v_ldexp_f32 v109, v109, v9
    v_ldexp_f32 v110, v110, v9
    v_ldexp_f32 v111, v111, v9
    v_ldexp_f32 v112, v112, v9
    v_ldexp_f32 v113, v113, v9
    v_ldexp_f32 v114, v114, v9
    v_ldexp_f32 v115, v115, v9
    v_ldexp_f32 v116, v116, v9
    v_ldexp_f32 v117, v117, v9
    v_ldexp_f32 v118, v118, v9
    v_ldexp_f32 v119, v119, v9
    v_ldexp_f32 v120, v120, v9
    v_ldexp_f32 v121, v121, v9
    v_ldexp_f32 v122, v122, v9
    v_ldexp_f32 v123, v123, v9
    v_ldexp_f32 v124, v124, v9
    v_ldexp_f32 v125, v125, v9
    v_ldexp_f32 v126, v126, v9
    v_ldexp_f32 v127, v127, v9
    v_ldexp_f32 v128, v128, v9
    v_ldexp_f32 v129, v129, v9
    v_ldexp_f32 v130, v130, v9
    v_ldexp_f32 v131, v131, v9
    v_ldexp_f32 v132, v132, v9
    v_ldexp_f32 v133, v133, v9
    v_ldexp_f32 v134, v134, v9
    v_ldexp_f32 v135, v135, v9
    v_ldexp_f32 v136, v136, v9
    v_ldexp_f32 v137, v137, v9
    v_ldexp_f32 v138, v138, v9
    v_ldexp_f32 v139, v139, v9
    v_ldexp_f32 v140, v140, v9
    v_ldexp_f32 v141, v141, v9
    v_ldexp_f32 v142, v142, v9
    v_ldexp_f32 v143, v143, v9
    v_ldexp_f32 v144, v144, v9
    v_ldexp_f32 v145, v145, v9
    v_ldexp_f32 v146, v146, v9
    v_ldexp_f32 v147, v147, v9
    v_ldexp_f32 v148, v148, v9
    v_ldexp_f32 v149, v149, v9
    v_ldexp_f32 v150, v150, v9
    v_ldexp_f32 v151, v151, v9
    v_ldexp_f32 v152, v152, v9
    v_ldexp_f32 v153, v153, v9
    v_ldexp_f32 v154, v154, v9
    v_ldexp_f32 v155, v155, v9
    v_ldexp_f32 v156, v156, v9
    v_ldexp_f32 v157, v157, v9
    v_ldexp_f32 v158, v158, v9
    v_ldexp_f32 v159, v159, v9
    v_ldexp_f32 v6, v6, v9
    v_ldexp_f32 v7, v7, v9
    v_lshlrev_b32 v10, 16, v208
    v_and_b32 v208, s28, v208
    v_ldexp_f32 v10, v10, v9
    v_ldexp_f32 v208, v208, v9
    v_cvt_pk_bf16_f32 v208, v10, v208
    v_lshlrev_b32 v10, 16, v209
    v_and_b32 v209, s28, v209
    v_ldexp_f32 v10, v10, v9
    v_ldexp_f32 v209, v209, v9
    v_cvt_pk_bf16_f32 v209, v10, v209
    v_lshlrev_b32 v10, 16, v210
    v_and_b32 v210, s28, v210
    v_ldexp_f32 v10, v10, v9
    v_ldexp_f32 v210, v210, v9
    v_cvt_pk_bf16_f32 v210, v10, v210
    v_lshlrev_b32 v10, 16, v211
    v_and_b32 v211, s28, v211
    v_ldexp_f32 v10, v10, v9
    v_ldexp_f32 v211, v211, v9
    v_cvt_pk_bf16_f32 v211, v10, v211
    v_lshlrev_b32 v10, 16, v212
    v_and_b32 v212, s28, v212
    v_ldexp_f32 v10, v10, v9
    v_ldexp_f32 v212, v212, v9
    v_cvt_pk_bf16_f32 v212, v10, v212
    v_lshlrev_b32 v10, 16, v213
    v_and_b32 v213, s28, v213
    v_ldexp_f32 v10, v10, v9
    v_ldexp_f32 v213, v213, v9
    v_cvt_pk_bf16_f32 v213, v10, v213
    v_lshlrev_b32 v10, 16, v214
    v_and_b32 v214, s28, v214
    v_ldexp_f32 v10, v10, v9
    v_ldexp_f32 v214, v214, v9
    v_cvt_pk_bf16_f32 v214, v10, v214
    v_lshlrev_b32 v10, 16, v215
    v_and_b32 v215, s28, v215
    v_ldexp_f32 v10, v10, v9
    v_ldexp_f32 v215, v215, v9
    v_cvt_pk_bf16_f32 v215, v10, v215
    v_sub_f32 v160, v160, v8
    v_sub_f32 v161, v161, v8
    v_sub_f32 v162, v162, v8
    v_sub_f32 v163, v163, v8
    v_sub_f32 v164, v164, v8
    v_sub_f32 v165, v165, v8
    v_sub_f32 v166, v166, v8
    v_sub_f32 v167, v167, v8
    v_sub_f32 v168, v168, v8
    v_sub_f32 v169, v169, v8
    v_sub_f32 v170, v170, v8
    v_sub_f32 v171, v171, v8
    v_sub_f32 v172, v172, v8
    v_sub_f32 v173, v173, v8
    v_sub_f32 v174, v174, v8
    v_sub_f32 v175, v175, v8
    v_sub_f32 v176, v176, v8
    v_sub_f32 v177, v177, v8
    v_sub_f32 v178, v178, v8
    v_sub_f32 v179, v179, v8
    v_sub_f32 v180, v180, v8
    v_sub_f32 v181, v181, v8
    v_sub_f32 v182, v182, v8
    v_sub_f32 v183, v183, v8
    v_sub_f32 v184, v184, v8
    v_sub_f32 v185, v185, v8
    v_sub_f32 v186, v186, v8
    v_sub_f32 v187, v187, v8
    v_sub_f32 v188, v188, v8
    v_sub_f32 v189, v189, v8
    v_sub_f32 v190, v190, v8
    v_sub_f32 v191, v191, v8
    v_sub_f32 v48, v48, v8
    v_sub_f32 v49, v49, v8
    v_sub_f32 v50, v50, v8
    v_sub_f32 v51, v51, v8
    v_sub_f32 v52, v52, v8
    v_sub_f32 v53, v53, v8
    v_sub_f32 v54, v54, v8
    v_sub_f32 v55, v55, v8
    v_sub_f32 v56, v56, v8
    v_sub_f32 v57, v57, v8
    v_sub_f32 v58, v58, v8
    v_sub_f32 v59, v59, v8
    v_sub_f32 v60, v60, v8
    v_sub_f32 v61, v61, v8
    v_sub_f32 v62, v62, v8
    v_sub_f32 v63, v63, v8
    s_nop 1
    s_branch L_ret4
L_fix5:
    s_nop 15
    v_mov_b32 v9, v8
    s_nop 1
    v_permlane32_swap_b32 v8, v9
    v_max_f32 v8, v8, v9
    v_add_f32 v8, s31, v8
    v_ceil_f32 v8, v8
    v_max_f32 v8, 0, v8
    v_min_f32 v9, 0x43800000, v8
    v_cvt_i32_f32 v9, v9
    v_sub_u32 v9, 0, v9
    v_ldexp_f32 v96, v96, v9
    v_ldexp_f32 v97, v97, v9
    v_ldexp_f32 v98, v98, v9
    v_ldexp_f32 v99, v99, v9
    v_ldexp_f32 v100, v100, v9
    v_ldexp_f32 v101, v101, v9
    v_ldexp_f32 v102, v102, v9
    v_ldexp_f32 v103, v103, v9
    v_ldexp_f32 v104, v104, v9
    v_ldexp_f32 v105, v105, v9
    v_ldexp_f32 v106, v106, v9
    v_ldexp_f32 v107, v107, v9
    v_ldexp_f32 v108, v108, v9
    v_ldexp_f32 v109, v109, v9
    v_ldexp_f32 v110, v110, v9
    v_ldexp_f32 v111, v111, v9
    v_ldexp_f32 v112, v112, v9
    v_ldexp_f32 v113, v113, v9
    v_ldexp_f32 v114, v114, v9
    v_ldexp_f32 v115, v115, v9
    v_ldexp_f32 v116, v116, v9
    v_ldexp_f32 v117, v117, v9
    v_ldexp_f32 v118, v118, v9
    v_ldexp_f32 v119, v119, v9
    v_ldexp_f32 v120, v120, v9
    v_ldexp_f32 v121, v121, v9
    v_ldexp_f32 v122, v122, v9
    v_ldexp_f32 v123, v123, v9
    v_ldexp_f32 v124, v124, v9
    v_ldexp_f32 v125, v125, v9
    v_ldexp_f32 v126, v126, v9
    v_ldexp_f32 v127, v127, v9
    v_ldexp_f32 v128, v128, v9
    v_ldexp_f32 v129, v129, v9
    v_ldexp_f32 v130, v130, v9
    v_ldexp_f32 v131, v131, v9
    v_ldexp_f32 v132, v132, v9
    v_ldexp_f32 v133, v133, v9
    v_ldexp_f32 v134, v134, v9
    v_ldexp_f32 v135, v135, v9
    v_ldexp_f32 v136, v136, v9
    v_ldexp_f32 v137, v137, v9
    v_ldexp_f32 v138, v138, v9
    v_ldexp_f32 v139, v139, v9
    v_ldexp_f32 v140, v140, v9
    v_ldexp_f32 v141, v141, v9
    v_ldexp_f32 v142, v142, v9
    v_ldexp_f32 v143, v143, v9
    v_ldexp_f32 v144, v144, v9
    v_ldexp_f32 v145, v145, v9
    v_ldexp_f32 v146, v146, v9
    v_ldexp_f32 v147, v147, v9
    v_ldexp_f32 v148, v148, v9
    v_ldexp_f32 v149, v149, v9
    v_ldexp_f32 v150, v150, v9
    v_ldexp_f32 v151, v151, v9
    v_ldexp_f32 v152, v152, v9
    v_ldexp_f32 v153, v153, v9
    v_ldexp_f32 v154, v154, v9
    v_ldexp_f32 v155, v155, v9
    v_ldexp_f32 v156, v156, v9
    v_ldexp_f32 v157, v157, v9
    v_ldexp_f32 v158, v158, v9
    v_ldexp_f32 v159, v159, v9
    v_ldexp_f32 v6, v6, v9
    v_ldexp_f32 v7, v7, v9
    v_lshlrev_b32 v10, 16, v160
    v_and_b32 v160, s28, v160
    v_ldexp_f32 v10, v10, v9
    v_ldexp_f32 v160, v160, v9
    v_cvt_pk_bf16_f32 v160, v10, v160
    v_lshlrev_b32 v10, 16, v161
    v_and_b32 v161, s28, v161
    v_ldexp_f32 v10, v10, v9
    v_ldexp_f32 v161, v161, v9
    v_cvt_pk_bf16_f32 v161, v10, v161
    v_lshlrev_b32 v10, 16, v162
    v_and_b32 v162, s28, v162
    v_ldexp_f32 v10, v10, v9
    v_ldexp_f32 v162, v162, v9
    v_cvt_pk_bf16_f32 v162, v10, v162
    v_lshlrev_b32 v10, 16, v163
    v_and_b32 v163, s28, v163
    v_ldexp_f32 v10, v10, v9
    v_ldexp_f32 v163, v163, v9
    v_cvt_pk_bf16_f32 v163, v10, v163
    v_lshlrev_b32 v10, 16, v164
    v_and_b32 v164, s28, v164
    v_ldexp_f32 v10, v10, v9
    v_ldexp_f32 v164, v164, v9
    v_cvt_pk_bf16_f32 v164, v10, v164
    v_lshlrev_b32 v10, 16, v165
    v_and_b32 v165, s28, v165
    v_ldexp_f32 v10, v10, v9
    v_ldexp_f32 v165, v165, v9
    v_cvt_pk_bf16_f32 v165, v10, v165
    v_lshlrev_b32 v10, 16, v166
    v_and_b32 v166, s28, v166
    v_ldexp_f32 v10, v10, v9
    v_ldexp_f32 v166, v166, v9
    v_cvt_pk_bf16_f32 v166, v10, v166
    v_lshlrev_b32 v10, 16, v167
    v_and_b32 v167, s28, v167
    v_ldexp_f32 v10, v10, v9
    v_ldexp_f32 v167, v167, v9
    v_cvt_pk_bf16_f32 v167, v10, v167
    v_sub_f32 v176, v176, v8
    v_sub_f32 v177, v177, v8
    v_sub_f32 v178, v178, v8
    v_sub_f32 v179, v179, v8
    v_sub_f32 v180, v180, v8
    v_sub_f32 v181, v181, v8
    v_sub_f32 v182, v182, v8
    v_sub_f32 v183, v183, v8
    v_sub_f32 v184, v184, v8
    v_sub_f32 v185, v185, v8
    v_sub_f32 v186, v186, v8
    v_sub_f32 v187, v187, v8
    v_sub_f32 v188, v188, v8
    v_sub_f32 v189, v189, v8
    v_sub_f32 v190, v190, v8
    v_sub_f32 v191, v191, v8
    v_sub_f32 v192, v192, v8
    v_sub_f32 v193, v193, v8
    v_sub_f32 v194, v194, v8
    v_sub_f32 v195, v195, v8
    v_sub_f32 v196, v196, v8
    v_sub_f32 v197, v197, v8
    v_sub_f32 v198, v198, v8
    v_sub_f32 v199, v199, v8
    v_sub_f32 v200, v200, v8
    v_sub_f32 v201, v201, v8
    v_sub_f32 v202, v202, v8
    v_sub_f32 v203, v203, v8
    v_sub_f32 v204, v204, v8
    v_sub_f32 v205, v205, v8
    v_sub_f32 v206, v206, v8
    v_sub_f32 v207, v207, v8
    v_sub_f32 v48, v48, v8
    v_sub_f32 v49, v49, v8
    v_sub_f32 v50, v50, v8
    v_sub_f32 v51, v51, v8
    v_sub_f32 v52, v52, v8
    v_sub_f32 v53, v53, v8
    v_sub_f32 v54, v54, v8
    v_sub_f32 v55, v55, v8
    v_sub_f32 v56, v56, v8
    v_sub_f32 v57, v57, v8
    v_sub_f32 v58, v58, v8
    v_sub_f32 v59, v59, v8
    v_sub_f32 v60, v60, v8
    v_sub_f32 v61, v61, v8
    v_sub_f32 v62, v62, v8
    v_sub_f32 v63, v63, v8
    s_nop 1
    s_branch L_ret5
L_fix6:
    s_nop 15
    v_mov_b32 v9, v8
    s_nop 1
    v_permlane32_swap_b32 v8, v9
    v_max_f32 v8, v8, v9
    v_add_f32 v8, s31, v8
    v_ceil_f32 v8, v8
    v_max_f32 v8, 0, v8
    v_min_f32 v9, 0x43800000, v8
    v_cvt_i32_f32 v9, v9
    v_sub_u32 v9, 0, v9
    v_ldexp_f32 v96, v96, v9
    v_ldexp_f32 v97, v97, v9
    v_ldexp_f32 v98, v98, v9
    v_ldexp_f32 v99, v99, v9
    v_ldexp_f32 v100, v100, v9
    v_ldexp_f32 v101, v101, v9
    v_ldexp_f32 v102, v102, v9
    v_ldexp_f32 v103, v103, v9
    v_ldexp_f32 v104, v104, v9
    v_ldexp_f32 v105, v105, v9
    v_ldexp_f32 v106, v106, v9
    v_ldexp_f32 v107, v107, v9
    v_ldexp_f32 v108, v108, v9
    v_ldexp_f32 v109, v109, v9
    v_ldexp_f32 v110, v110, v9
    v_ldexp_f32 v111, v111, v9
    v_ldexp_f32 v112, v112, v9
    v_ldexp_f32 v113, v113, v9
    v_ldexp_f32 v114, v114, v9
    v_ldexp_f32 v115, v115, v9
    v_ldexp_f32 v116, v116, v9
    v_ldexp_f32 v117, v117, v9
    v_ldexp_f32 v118, v118, v9
    v_ldexp_f32 v119, v119, v9
    v_ldexp_f32 v120, v120, v9
    v_ldexp_f32 v121, v121, v9
    v_ldexp_f32 v122, v122, v9
    v_ldexp_f32 v123, v123, v9
    v_ldexp_f32 v124, v124, v9
    v_ldexp_f32 v125, v125, v9
    v_ldexp_f32 v126, v126, v9
    v_ldexp_f32 v127, v127, v9
    v_ldexp_f32 v128, v128, v9
    v_ldexp_f32 v129, v129, v9
    v_ldexp_f32 v130, v130, v9
    v_ldexp_f32 v131, v131, v9
    v_ldexp_f32 v132, v132, v9
    v_ldexp_f32 v133, v133, v9
    v_ldexp_f32 v134, v134, v9
    v_ldexp_f32 v135, v135, v9
    v_ldexp_f32 v136, v136, v9
    v_ldexp_f32 v137, v137, v9
    v_ldexp_f32 v138, v138, v9
    v_ldexp_f32 v139, v139, v9
    v_ldexp_f32 v140, v140, v9
    v_ldexp_f32 v141, v141, v9
    v_ldexp_f32 v142, v142, v9
    v_ldexp_f32 v143, v143, v9
    v_ldexp_f32 v144, v144, v9
    v_ldexp_f32 v145, v145, v9
    v_ldexp_f32 v146, v146, v9
    v_ldexp_f32 v147, v147, v9
    v_ldexp_f32 v148, v148, v9
    v_ldexp_f32 v149, v149, v9
    v_ldexp_f32 v150, v150, v9
    v_ldexp_f32 v151, v151, v9
    v_ldexp_f32 v152, v152, v9
    v_ldexp_f32 v153, v153, v9
    v_ldexp_f32 v154, v154, v9
    v_ldexp_f32 v155, v155, v9
    v_ldexp_f32 v156, v156, v9
    v_ldexp_f32 v157, v157, v9
    v_ldexp_f32 v158, v158, v9
    v_ldexp_f32 v159, v159, v9
    v_ldexp_f32 v6, v6, v9
    v_ldexp_f32 v7, v7, v9
    v_lshlrev_b32 v10, 16, v176
    v_and_b32 v176, s28, v176
    v_ldexp_f32 v10, v10, v9
    v_ldexp_f32 v176, v176, v9
    v_cvt_pk_bf16_f32 v176, v10, v176
    v_lshlrev_b32 v10, 16, v177
    v_and_b32 v177, s28, v177
    v_ldexp_f32 v10, v10, v9
    v_ldexp_f32 v177, v177, v9
    v_cvt_pk_bf16_f32 v177, v10, v177
    v_lshlrev_b32 v10, 16, v178
    v_and_b32 v178, s28, v178
    v_ldexp_f32 v10, v10, v9
    v_ldexp_f32 v178, v178, v9
    v_cvt_pk_bf16_f32 v178, v10, v178
    v_lshlrev_b32 v10, 16, v179
    v_and_b32 v179, s28, v179
    v_ldexp_f32 v10, v10, v9
    v_ldexp_f32 v179, v179, v9
    v_cvt_pk_bf16_f32 v179, v10, v179
    v_lshlrev_b32 v10, 16, v180
    v_and_b32 v180, s28, v180
    v_ldexp_f32 v10, v10, v9
    v_ldexp_f32 v180, v180, v9
    v_cvt_pk_bf16_f32 v180, v10, v180
    v_lshlrev_b32 v10, 16, v181
    v_and_b32 v181, s28, v181
    v_ldexp_f32 v10, v10, v9
    v_ldexp_f32 v181, v181, v9
    v_cvt_pk_bf16_f32 v181, v10, v181
    v_lshlrev_b32 v10, 16, v182
    v_and_b32 v182, s28, v182
    v_ldexp_f32 v10, v10, v9
    v_ldexp_f32 v182, v182, v9
    v_cvt_pk_bf16_f32 v182, v10, v182
    v_lshlrev_b32 v10, 16, v183
    v_and_b32 v183, s28, v183
    v_ldexp_f32 v10, v10, v9
    v_ldexp_f32 v183, v183, v9
    v_cvt_pk_bf16_f32 v183, v10, v183
    v_sub_f32 v192, v192, v8
    v_sub_f32 v193, v193, v8
    v_sub_f32 v194, v194, v8
    v_sub_f32 v195, v195, v8
    v_sub_f32 v196, v196, v8
    v_sub_f32 v197, v197, v8
    v_sub_f32 v198, v198, v8
    v_sub_f32 v199, v199, v8
    v_sub_f32 v200, v200, v8
    v_sub_f32 v201, v201, v8
    v_sub_f32 v202, v202, v8
    v_sub_f32 v203, v203, v8
    v_sub_f32 v204, v204, v8
    v_sub_f32 v205, v205, v8
    v_sub_f32 v206, v206, v8
    v_sub_f32 v207, v207, v8
    v_sub_f32 v208, v208, v8
    v_sub_f32 v209, v209, v8
    v_sub_f32 v210, v210, v8
    v_sub_f32 v211, v211, v8
    v_sub_f32 v212, v212, v8
    v_sub_f32 v213, v213, v8
    v_sub_f32 v214, v214, v8
    v_sub_f32 v215, v215, v8
    v_sub_f32 v216, v216, v8
    v_sub_f32 v217, v217, v8
    v_sub_f32 v218, v218, v8
    v_sub_f32 v219, v219, v8
    v_sub_f32 v220, v220, v8
    v_sub_f32 v221, v221, v8
    v_sub_f32 v222, v222, v8
    v_sub_f32 v223, v223, v8
    v_sub_f32 v48, v48, v8
    v_sub_f32 v49, v49, v8
    v_sub_f32 v50, v50, v8
    v_sub_f32 v51, v51, v8
    v_sub_f32 v52, v52, v8
    v_sub_f32 v53, v53, v8
    v_sub_f32 v54, v54, v8
    v_sub_f32 v55, v55, v8
    v_sub_f32 v56, v56, v8
    v_sub_f32 v57, v57, v8
    v_sub_f32 v58, v58, v8
    v_sub_f32 v59, v59, v8
    v_sub_f32 v60, v60, v8
    v_sub_f32 v61, v61, v8
    v_sub_f32 v62, v62, v8
    v_sub_f32 v63, v63, v8
    s_nop 1
    s_branch L_ret6
L_fix7:
    s_nop 15
    v_mov_b32 v9, v8
    s_nop 1
    v_permlane32_swap_b32 v8, v9
    v_max_f32 v8, v8, v9
    v_add_f32 v8, s31, v8
    v_ceil_f32 v8, v8
    v_max_f32 v8, 0, v8
    v_min_f32 v9, 0x43800000, v8
    v_cvt_i32_f32 v9, v9
    v_sub_u32 v9, 0, v9
    v_ldexp_f32 v96, v96, v9
    v_ldexp_f32 v97, v97, v9
    v_ldexp_f32 v98, v98, v9
    v_ldexp_f32 v99, v99, v9
    v_ldexp_f32 v100, v100, v9
    v_ldexp_f32 v101, v101, v9
    v_ldexp_f32 v102, v102, v9
    v_ldexp_f32 v103, v103, v9
    v_ldexp_f32 v104, v104, v9
    v_ldexp_f32 v105, v105, v9
    v_ldexp_f32 v106, v106, v9
    v_ldexp_f32 v107, v107, v9
    v_ldexp_f32 v108, v108, v9
    v_ldexp_f32 v109, v109, v9
    v_ldexp_f32 v110, v110, v9
    v_ldexp_f32 v111, v111, v9
    v_ldexp_f32 v112, v112, v9
    v_ldexp_f32 v113, v113, v9
    v_ldexp_f32 v114, v114, v9
    v_ldexp_f32 v115, v115, v9
    v_ldexp_f32 v116, v116, v9
    v_ldexp_f32 v117, v117, v9
    v_ldexp_f32 v118, v118, v9
    v_ldexp_f32 v119, v119, v9
    v_ldexp_f32 v120, v120, v9
    v_ldexp_f32 v121, v121, v9
    v_ldexp_f32 v122, v122, v9
    v_ldexp_f32 v123, v123, v9
    v_ldexp_f32 v124, v124, v9
    v_ldexp_f32 v125, v125, v9
    v_ldexp_f32 v126, v126, v9
    v_ldexp_f32 v127, v127, v9
    v_ldexp_f32 v128, v128, v9
    v_ldexp_f32 v129, v129, v9
    v_ldexp_f32 v130, v130, v9
    v_ldexp_f32 v131, v131, v9
    v_ldexp_f32 v132, v132, v9
    v_ldexp_f32 v133, v133, v9
    v_ldexp_f32 v134, v134, v9
    v_ldexp_f32 v135, v135, v9
    v_ldexp_f32 v136, v136, v9
    v_ldexp_f32 v137, v137, v9
    v_ldexp_f32 v138, v138, v9
    v_ldexp_f32 v139, v139, v9
    v_ldexp_f32 v140, v140, v9
    v_ldexp_f32 v141, v141, v9
    v_ldexp_f32 v142, v142, v9
    v_ldexp_f32 v143, v143, v9
    v_ldexp_f32 v144, v144, v9
    v_ldexp_f32 v145, v145, v9
    v_ldexp_f32 v146, v146, v9
    v_ldexp_f32 v147, v147, v9
    v_ldexp_f32 v148, v148, v9
    v_ldexp_f32 v149, v149, v9
    v_ldexp_f32 v150, v150, v9
    v_ldexp_f32 v151, v151, v9
    v_ldexp_f32 v152, v152, v9
    v_ldexp_f32 v153, v153, v9
    v_ldexp_f32 v154, v154, v9
    v_ldexp_f32 v155, v155, v9
    v_ldexp_f32 v156, v156, v9
    v_ldexp_f32 v157, v157, v9
    v_ldexp_f32 v158, v158, v9
    v_ldexp_f32 v159, v159, v9
    v_ldexp_f32 v6, v6, v9
    v_ldexp_f32 v7, v7, v9
    v_lshlrev_b32 v10, 16, v192
    v_and_b32 v192, s28, v192
    v_ldexp_f32 v10, v10, v9
    v_ldexp_f32 v192, v192, v9
    v_cvt_pk_bf16_f32 v192, v10, v192
    v_lshlrev_b32 v10, 16, v193
    v_and_b32 v193, s28, v193
    v_ldexp_f32 v10, v10, v9
    v_ldexp_f32 v193, v193, v9
    v_cvt_pk_bf16_f32 v193, v10, v193
    v_lshlrev_b32 v10, 16, v194
    v_and_b32 v194, s28, v194
    v_ldexp_f32 v10, v10, v9
    v_ldexp_f32 v194, v194, v9
    v_cvt_pk_bf16_f32 v194, v10, v194
    v_lshlrev_b32 v10, 16, v195
    v_and_b32 v195, s28, v195
    v_ldexp_f32 v10, v10, v9
    v_ldexp_f32 v195, v195, v9
    v_cvt_pk_bf16_f32 v195, v10, v195
    v_lshlrev_b32 v10, 16, v196
    v_and_b32 v196, s28, v196
    v_ldexp_f32 v10, v10, v9
    v_ldexp_f32 v196, v196, v9
    v_cvt_pk_bf16_f32 v196, v10, v196
    v_lshlrev_b32 v10, 16, v197
    v_and_b32 v197, s28, v197
    v_ldexp_f32 v10, v10, v9
    v_ldexp_f32 v197, v197, v9
    v_cvt_pk_bf16_f32 v197, v10, v197
    v_lshlrev_b32 v10, 16, v198
    v_and_b32 v198, s28, v198
    v_ldexp_f32 v10, v10, v9
    v_ldexp_f32 v198, v198, v9
    v_cvt_pk_bf16_f32 v198, v10, v198
    v_lshlrev_b32 v10, 16, v199
    v_and_b32 v199, s28, v199
    v_ldexp_f32 v10, v10, v9
    v_ldexp_f32 v199, v199, v9
    v_cvt_pk_bf16_f32 v199, v10, v199
    v_sub_f32 v208, v208, v8
    v_sub_f32 v209, v209, v8
    v_sub_f32 v210, v210, v8
    v_sub_f32 v211, v211, v8
    v_sub_f32 v212, v212, v8
    v_sub_f32 v213, v213, v8
    v_sub_f32 v214, v214, v8
    v_sub_f32 v215, v215, v8
    v_sub_f32 v216, v216, v8
    v_sub_f32 v217, v217, v8
    v_sub_f32 v218, v218, v8
    v_sub_f32 v219, v219, v8
    v_sub_f32 v220, v220, v8
    v_sub_f32 v221, v221, v8
    v_sub_f32 v222, v222, v8
    v_sub_f32 v223, v223, v8
    v_sub_f32 v160, v160, v8
    v_sub_f32 v161, v161, v8
    v_sub_f32 v162, v162, v8
    v_sub_f32 v163, v163, v8
    v_sub_f32 v164, v164, v8
    v_sub_f32 v165, v165, v8
    v_sub_f32 v166, v166, v8
    v_sub_f32 v167, v167, v8
    v_sub_f32 v168, v168, v8
    v_sub_f32 v169, v169, v8
    v_sub_f32 v170, v170, v8
    v_sub_f32 v171, v171, v8
    v_sub_f32 v172, v172, v8
    v_sub_f32 v173, v173, v8
    v_sub_f32 v174, v174, v8
    v_sub_f32 v175, v175, v8
    v_sub_f32 v48, v48, v8
    v_sub_f32 v49, v49, v8
    v_sub_f32 v50, v50, v8
    v_sub_f32 v51, v51, v8
    v_sub_f32 v52, v52, v8
    v_sub_f32 v53, v53, v8
    v_sub_f32 v54, v54, v8
    v_sub_f32 v55, v55, v8
    v_sub_f32 v56, v56, v8
    v_sub_f32 v57, v57, v8
    v_sub_f32 v58, v58, v8
    v_sub_f32 v59, v59, v8
    v_sub_f32 v60, v60, v8
    v_sub_f32 v61, v61, v8
    v_sub_f32 v62, v62, v8
    v_sub_f32 v63, v63, v8
    s_nop 1
    s_branch L_ret7
L_fix8:
    s_nop 15
    v_mov_b32 v9, v8
    s_nop 1
    v_permlane32_swap_b32 v8, v9
    v_max_f32 v8, v8, v9
    v_add_f32 v8, s31, v8
    v_ceil_f32 v8, v8
    v_max_f32 v8, 0, v8
    v_min_f32 v9, 0x43800000, v8
    v_cvt_i32_f32 v9, v9
    v_sub_u32 v9, 0, v9
    v_ldexp_f32 v96, v96, v9
    v_ldexp_f32 v97, v97, v9
    v_ldexp_f32 v98, v98, v9
    v_ldexp_f32 v99, v99, v9
    v_ldexp_f32 v100, v100, v9
    v_ldexp_f32 v101, v101, v9
    v_ldexp_f32 v102, v102, v9
    v_ldexp_f32 v103, v103, v9
    v_ldexp_f32 v104, v104, v9
    v_ldexp_f32 v105, v105, v9
    v_ldexp_f32 v106, v106, v9
    v_ldexp_f32 v107, v107, v9
    v_ldexp_f32 v108, v108, v9
    v_ldexp_f32 v109, v109, v9
    v_ldexp_f32 v110, v110, v9
    v_ldexp_f32 v111, v111, v9
    v_ldexp_f32 v112, v112, v9
    v_ldexp_f32 v113, v113, v9
    v_ldexp_f32 v114, v114, v9
    v_ldexp_f32 v115, v115, v9
    v_ldexp_f32 v116, v116, v9
    v_ldexp_f32 v117, v117, v9
    v_ldexp_f32 v118, v118, v9
    v_ldexp_f32 v119, v119, v9
    v_ldexp_f32 v120, v120, v9
    v_ldexp_f32 v121, v121, v9
    v_ldexp_f32 v122, v122, v9
    v_ldexp_f32 v123, v123, v9
    v_ldexp_f32 v124, v124, v9
    v_ldexp_f32 v125, v125, v9
    v_ldexp_f32 v126, v126, v9
    v_ldexp_f32 v127, v127, v9
    v_ldexp_f32 v128, v128, v9
    v_ldexp_f32 v129, v129, v9
    v_ldexp_f32 v130, v130, v9
    v_ldexp_f32 v131, v131, v9
    v_ldexp_f32 v132, v132, v9
    v_ldexp_f32 v133, v133, v9
    v_ldexp_f32 v134, v134, v9
    v_ldexp_f32 v135, v135, v9
    v_ldexp_f32 v136, v136, v9
    v_ldexp_f32 v137, v137, v9
    v_ldexp_f32 v138, v138, v9
    v_ldexp_f32 v139, v139, v9
    v_ldexp_f32 v140, v140, v9
    v_ldexp_f32 v141, v141, v9
    v_ldexp_f32 v142, v142, v9
    v_ldexp_f32 v143, v143, v9
    v_ldexp_f32 v144, v144, v9
    v_ldexp_f32 v145, v145, v9
    v_ldexp_f32 v146, v146, v9
    v_ldexp_f32 v147, v147, v9
    v_ldexp_f32 v148, v148, v9
    v_ldexp_f32 v149, v149, v9
    v_ldexp_f32 v150, v150, v9
    v_ldexp_f32 v151, v151, v9
    v_ldexp_f32 v152, v152, v9
    v_ldexp_f32 v153, v153, v9
    v_ldexp_f32 v154, v154, v9
    v_ldexp_f32 v155, v155, v9
    v_ldexp_f32 v156, v156, v9
    v_ldexp_f32 v157, v157, v9
    v_ldexp_f32 v158, v158, v9
    v_ldexp_f32 v159, v159, v9
    v_ldexp_f32 v6, v6, v9
    v_ldexp_f32 v7, v7, v9
    v_lshlrev_b32 v10, 16, v208
    v_and_b32 v208, s28, v208
    v_ldexp_f32 v10, v10, v9
    v_ldexp_f32 v208, v208, v9
    v_cvt_pk_bf16_f32 v208, v10, v208
    v_lshlrev_b32 v10, 16, v209
    v_and_b32 v209, s28, v209
    v_ldexp_f32 v10, v10, v9
    v_ldexp_f32 v209, v209, v9
    v_cvt_pk_bf16_f32 v209, v10, v209
    v_lshlrev_b32 v10, 16, v210
    v_and_b32 v210, s28, v210
    v_ldexp_f32 v10, v10, v9
    v_ldexp_f32 v210, v210, v9
    v_cvt_pk_bf16_f32 v210, v10, v210
    v_lshlrev_b32 v10, 16, v211
    v_and_b32 v211, s28, v211
    v_ldexp_f32 v10, v10, v9
    v_ldexp_f32 v211, v211, v9
    v_cvt_pk_bf16_f32 v211, v10, v211
    v_lshlrev_b32 v10, 16, v212
    v_and_b32 v212, s28, v212
    v_ldexp_f32 v10, v10, v9
    v_ldexp_f32 v212, v212, v9
    v_cvt_pk_bf16_f32 v212, v10, v212
    v_lshlrev_b32 v10, 16, v213
    v_and_b32 v213, s28, v213
    v_ldexp_f32 v10, v10, v9
    v_ldexp_f32 v213, v213, v9
    v_cvt_pk_bf16_f32 v213, v10, v213
    v_lshlrev_b32 v10, 16, v214
    v_and_b32 v214, s28, v214
    v_ldexp_f32 v10, v10, v9
    v_ldexp_f32 v214, v214, v9
    v_cvt_pk_bf16_f32 v214, v10, v214
    v_lshlrev_b32 v10, 16, v215
    v_and_b32 v215, s28, v215
    v_ldexp_f32 v10, v10, v9
    v_ldexp_f32 v215, v215, v9
    v_cvt_pk_bf16_f32 v215, v10, v215
    v_sub_f32 v160, v160, v8
    v_sub_f32 v161, v161, v8
    v_sub_f32 v162, v162, v8
    v_sub_f32 v163, v163, v8
    v_sub_f32 v164, v164, v8
    v_sub_f32 v165, v165, v8
    v_sub_f32 v166, v166, v8
    v_sub_f32 v167, v167, v8
    v_sub_f32 v168, v168, v8
    v_sub_f32 v169, v169, v8
    v_sub_f32 v170, v170, v8
    v_sub_f32 v171, v171, v8
    v_sub_f32 v172, v172, v8
    v_sub_f32 v173, v173, v8
    v_sub_f32 v174, v174, v8
    v_sub_f32 v175, v175, v8
    v_sub_f32 v176, v176, v8
    v_sub_f32 v177, v177, v8
    v_sub_f32 v178, v178, v8
    v_sub_f32 v179, v179, v8
    v_sub_f32 v180, v180, v8
    v_sub_f32 v181, v181, v8
    v_sub_f32 v182, v182, v8
    v_sub_f32 v183, v183, v8
    v_sub_f32 v184, v184, v8
    v_sub_f32 v185, v185, v8
    v_sub_f32 v186, v186, v8
    v_sub_f32 v187, v187, v8
    v_sub_f32 v188, v188, v8
    v_sub_f32 v189, v189, v8
    v_sub_f32 v190, v190, v8
    v_sub_f32 v191, v191, v8
    v_sub_f32 v48, v48, v8
    v_sub_f32 v49, v49, v8
    v_sub_f32 v50, v50, v8
    v_sub_f32 v51, v51, v8
    v_sub_f32 v52, v52, v8
    v_sub_f32 v53, v53, v8
    v_sub_f32 v54, v54, v8
    v_sub_f32 v55, v55, v8
    v_sub_f32 v56, v56, v8
    v_sub_f32 v57, v57, v8
    v_sub_f32 v58, v58, v8
    v_sub_f32 v59, v59, v8
    v_sub_f32 v60, v60, v8
    v_sub_f32 v61, v61, v8
    v_sub_f32 v62, v62, v8
    v_sub_f32 v63, v63, v8
    s_nop 1
    s_branch L_ret8
L_fix9:
    s_nop 15
    v_mov_b32 v9, v8
    s_nop 1
    v_permlane32_swap_b32 v8, v9
    v_max_f32 v8, v8, v9
    v_add_f32 v8, s31, v8
    v_ceil_f32 v8, v8
    v_max_f32 v8, 0, v8
    v_min_f32 v9, 0x43800000, v8
    v_cvt_i32_f32 v9, v9
    v_sub_u32 v9, 0, v9
    v_ldexp_f32 v96, v96, v9
    v_ldexp_f32 v97, v97, v9
    v_ldexp_f32 v98, v98, v9
    v_ldexp_f32 v99, v99, v9
    v_ldexp_f32 v100, v100, v9
    v_ldexp_f32 v101, v101, v9
    v_ldexp_f32 v102, v102, v9
    v_ldexp_f32 v103, v103, v9
    v_ldexp_f32 v104, v104, v9
    v_ldexp_f32 v105, v105, v9
    v_ldexp_f32 v106, v106, v9
    v_ldexp_f32 v107, v107, v9
    v_ldexp_f32 v108, v108, v9
    v_ldexp_f32 v109, v109, v9
    v_ldexp_f32 v110, v110, v9
    v_ldexp_f32 v111, v111, v9
    v_ldexp_f32 v112, v112, v9
    v_ldexp_f32 v113, v113, v9
    v_ldexp_f32 v114, v114, v9
    v_ldexp_f32 v115, v115, v9
    v_ldexp_f32 v116, v116, v9
    v_ldexp_f32 v117, v117, v9
    v_ldexp_f32 v118, v118, v9
    v_ldexp_f32 v119, v119, v9
    v_ldexp_f32 v120, v120, v9
    v_ldexp_f32 v121, v121, v9
    v_ldexp_f32 v122, v122, v9
    v_ldexp_f32 v123, v123, v9
    v_ldexp_f32 v124, v124, v9
    v_ldexp_f32 v125, v125, v9
    v_ldexp_f32 v126, v126, v9
    v_ldexp_f32 v127, v127, v9
    v_ldexp_f32 v128, v128, v9
    v_ldexp_f32 v129, v129, v9
    v_ldexp_f32 v130, v130, v9
    v_ldexp_f32 v131, v131, v9
    v_ldexp_f32 v132, v132, v9
    v_ldexp_f32 v133, v133, v9
    v_ldexp_f32 v134, v134, v9
    v_ldexp_f32 v135, v135, v9
    v_ldexp_f32 v136, v136, v9
    v_ldexp_f32 v137, v137, v9
    v_ldexp_f32 v138, v138, v9
    v_ldexp_f32 v139, v139, v9
    v_ldexp_f32 v140, v140, v9
    v_ldexp_f32 v141, v141, v9
    v_ldexp_f32 v142, v142, v9
    v_ldexp_f32 v143, v143, v9
    v_ldexp_f32 v144, v144, v9
    v_ldexp_f32 v145, v145, v9
    v_ldexp_f32 v146, v146, v9
    v_ldexp_f32 v147, v147, v9
    v_ldexp_f32 v148, v148, v9
    v_ldexp_f32 v149, v149, v9
    v_ldexp_f32 v150, v150, v9
    v_ldexp_f32 v151, v151, v9
    v_ldexp_f32 v152, v152, v9
    v_ldexp_f32 v153, v153, v9
    v_ldexp_f32 v154, v154, v9
    v_ldexp_f32 v155, v155, v9
    v_ldexp_f32 v156, v156, v9
    v_ldexp_f32 v157, v157, v9
    v_ldexp_f32 v158, v158, v9
    v_ldexp_f32 v159, v159, v9
    v_ldexp_f32 v6, v6, v9
    v_ldexp_f32 v7, v7, v9
    v_lshlrev_b32 v10, 16, v160
    v_and_b32 v160, s28, v160
    v_ldexp_f32 v10, v10, v9
    v_ldexp_f32 v160, v160, v9
    v_cvt_pk_bf16_f32 v160, v10, v160
    v_lshlrev_b32 v10, 16, v161
    v_and_b32 v161, s28, v161
    v_ldexp_f32 v10, v10, v9
    v_ldexp_f32 v161, v161, v9
    v_cvt_pk_bf16_f32 v161, v10, v161
    v_lshlrev_b32 v10, 16, v162
    v_and_b32 v162, s28, v162
    v_ldexp_f32 v10, v10, v9
    v_ldexp_f32 v162, v162, v9
    v_cvt_pk_bf16_f32 v162, v10, v162
    v_lshlrev_b32 v10, 16, v163
    v_and_b32 v163, s28, v163
    v_ldexp_f32 v10, v10, v9
    v_ldexp_f32 v163, v163, v9
    v_cvt_pk_bf16_f32 v163, v10, v163
    v_lshlrev_b32 v10, 16, v164
    v_and_b32 v164, s28, v164
    v_ldexp_f32 v10, v10, v9
    v_ldexp_f32 v164, v164, v9
    v_cvt_pk_bf16_f32 v164, v10, v164
    v_lshlrev_b32 v10, 16, v165
    v_and_b32 v165, s28, v165
    v_ldexp_f32 v10, v10, v9
    v_ldexp_f32 v165, v165, v9
    v_cvt_pk_bf16_f32 v165, v10, v165
    v_lshlrev_b32 v10, 16, v166
    v_and_b32 v166, s28, v166
    v_ldexp_f32 v10, v10, v9
    v_ldexp_f32 v166, v166, v9
    v_cvt_pk_bf16_f32 v166, v10, v166
    v_lshlrev_b32 v10, 16, v167
    v_and_b32 v167, s28, v167
    v_ldexp_f32 v10, v10, v9
    v_ldexp_f32 v167, v167, v9
    v_cvt_pk_bf16_f32 v167, v10, v167
    v_sub_f32 v176, v176, v8
    v_sub_f32 v177, v177, v8
    v_sub_f32 v178, v178, v8
    v_sub_f32 v179, v179, v8
    v_sub_f32 v180, v180, v8
    v_sub_f32 v181, v181, v8
    v_sub_f32 v182, v182, v8
    v_sub_f32 v183, v183, v8
    v_sub_f32 v184, v184, v8
    v_sub_f32 v185, v185, v8
    v_sub_f32 v186, v186, v8
    v_sub_f32 v187, v187, v8
    v_sub_f32 v188, v188, v8
    v_sub_f32 v189, v189, v8
    v_sub_f32 v190, v190, v8
    v_sub_f32 v191, v191, v8
    v_sub_f32 v192, v192, v8
    v_sub_f32 v193, v193, v8
    v_sub_f32 v194, v194, v8
    v_sub_f32 v195, v195, v8
    v_sub_f32 v196, v196, v8
    v_sub_f32 v197, v197, v8
    v_sub_f32 v198, v198, v8
    v_sub_f32 v199, v199, v8
    v_sub_f32 v200, v200, v8
    v_sub_f32 v201, v201, v8
    v_sub_f32 v202, v202, v8
    v_sub_f32 v203, v203, v8
    v_sub_f32 v204, v204, v8
    v_sub_f32 v205, v205, v8
    v_sub_f32 v206, v206, v8
    v_sub_f32 v207, v207, v8
    v_sub_f32 v48, v48, v8
    v_sub_f32 v49, v49, v8
    v_sub_f32 v50, v50, v8
    v_sub_f32 v51, v51, v8
    v_sub_f32 v52, v52, v8
    v_sub_f32 v53, v53, v8
    v_sub_f32 v54, v54, v8
    v_sub_f32 v55, v55, v8
    v_sub_f32 v56, v56, v8
    v_sub_f32 v57, v57, v8
    v_sub_f32 v58, v58, v8
    v_sub_f32 v59, v59, v8
    v_sub_f32 v60, v60, v8
    v_sub_f32 v61, v61, v8
    v_sub_f32 v62, v62, v8
    v_sub_f32 v63, v63, v8
    s_nop 1
    s_branch L_ret9
L_fix10:
    s_nop 15
    v_mov_b32 v9, v8
    s_nop 1
    v_permlane32_swap_b32 v8, v9
    v_max_f32 v8, v8, v9
    v_add_f32 v8, s31, v8
    v_ceil_f32 v8, v8
    v_max_f32 v8, 0, v8
    v_min_f32 v9, 0x43800000, v8
    v_cvt_i32_f32 v9, v9
    v_sub_u32 v9, 0, v9
    v_ldexp_f32 v96, v96, v9
    v_ldexp_f32 v97, v97, v9
    v_ldexp_f32 v98, v98, v9
    v_ldexp_f32 v99, v99, v9
    v_ldexp_f32 v100, v100, v9
    v_ldexp_f32 v101, v101, v9
    v_ldexp_f32 v102, v102, v9
    v_ldexp_f32 v103, v103, v9
    v_ldexp_f32 v104, v104, v9
    v_ldexp_f32 v105, v105, v9
    v_ldexp_f32 v106, v106, v9
    v_ldexp_f32 v107, v107, v9
    v_ldexp_f32 v108, v108, v9
    v_ldexp_f32 v109, v109, v9
    v_ldexp_f32 v110, v110, v9
    v_ldexp_f32 v111, v111, v9
    v_ldexp_f32 v112, v112, v9
    v_ldexp_f32 v113, v113, v9
    v_ldexp_f32 v114, v114, v9
    v_ldexp_f32 v115, v115, v9
    v_ldexp_f32 v116, v116, v9
    v_ldexp_f32 v117, v117, v9
    v_ldexp_f32 v118, v118, v9
    v_ldexp_f32 v119, v119, v9
    v_ldexp_f32 v120, v120, v9
    v_ldexp_f32 v121, v121, v9
    v_ldexp_f32 v122, v122, v9
    v_ldexp_f32 v123, v123, v9
    v_ldexp_f32 v124, v124, v9
    v_ldexp_f32 v125, v125, v9
    v_ldexp_f32 v126, v126, v9
    v_ldexp_f32 v127, v127, v9
    v_ldexp_f32 v128, v128, v9
    v_ldexp_f32 v129, v129, v9
    v_ldexp_f32 v130, v130, v9
    v_ldexp_f32 v131, v131, v9
    v_ldexp_f32 v132, v132, v9
    v_ldexp_f32 v133, v133, v9
    v_ldexp_f32 v134, v134, v9
    v_ldexp_f32 v135, v135, v9
    v_ldexp_f32 v136, v136, v9
    v_ldexp_f32 v137, v137, v9
    v_ldexp_f32 v138, v138, v9
    v_ldexp_f32 v139, v139, v9
    v_ldexp_f32 v140, v140, v9
    v_ldexp_f32 v141, v141, v9
    v_ldexp_f32 v142, v142, v9
    v_ldexp_f32 v143, v143, v9
    v_ldexp_f32 v144, v144, v9
    v_ldexp_f32 v145, v145, v9
    v_ldexp_f32 v146, v146, v9
    v_ldexp_f32 v147, v147, v9
    v_ldexp_f32 v148, v148, v9
    v_ldexp_f32 v149, v149, v9
    v_ldexp_f32 v150, v150, v9
    v_ldexp_f32 v151, v151, v9
    v_ldexp_f32 v152, v152, v9
    v_ldexp_f32 v153, v153, v9
    v_ldexp_f32 v154, v154, v9
    v_ldexp_f32 v155, v155, v9
    v_ldexp_f32 v156, v156, v9
    v_ldexp_f32 v157, v157, v9
    v_ldexp_f32 v158, v158, v9
    v_ldexp_f32 v159, v159, v9
    v_ldexp_f32 v6, v6, v9
    v_ldexp_f32 v7, v7, v9
    v_lshlrev_b32 v10, 16, v176
    v_and_b32 v176, s28, v176
    v_ldexp_f32 v10, v10, v9
    v_ldexp_f32 v176, v176, v9
    v_cvt_pk_bf16_f32 v176, v10, v176
    v_lshlrev_b32 v10, 16, v177
    v_and_b32 v177, s28, v177
    v_ldexp_f32 v10, v10, v9
    v_ldexp_f32 v177, v177, v9
    v_cvt_pk_bf16_f32 v177, v10, v177
    v_lshlrev_b32 v10, 16, v178
    v_and_b32 v178, s28, v178
    v_ldexp_f32 v10, v10, v9
    v_ldexp_f32 v178, v178, v9
    v_cvt_pk_bf16_f32 v178, v10, v178
    v_lshlrev_b32 v10, 16, v179
    v_and_b32 v179, s28, v179
    v_ldexp_f32 v10, v10, v9
    v_ldexp_f32 v179, v179, v9
    v_cvt_pk_bf16_f32 v179, v10, v179
    v_lshlrev_b32 v10, 16, v180
    v_and_b32 v180, s28, v180
    v_ldexp_f32 v10, v10, v9
    v_ldexp_f32 v180, v180, v9
    v_cvt_pk_bf16_f32 v180, v10, v180
    v_lshlrev_b32 v10, 16, v181
    v_and_b32 v181, s28, v181
    v_ldexp_f32 v10, v10, v9
    v_ldexp_f32 v181, v181, v9
    v_cvt_pk_bf16_f32 v181, v10, v181
    v_lshlrev_b32 v10, 16, v182
    v_and_b32 v182, s28, v182
    v_ldexp_f32 v10, v10, v9
    v_ldexp_f32 v182, v182, v9
    v_cvt_pk_bf16_f32 v182, v10, v182
    v_lshlrev_b32 v10, 16, v183
    v_and_b32 v183, s28, v183
    v_ldexp_f32 v10, v10, v9
    v_ldexp_f32 v183, v183, v9
    v_cvt_pk_bf16_f32 v183, v10, v183
    v_sub_f32 v192, v192, v8
    v_sub_f32 v193, v193, v8
    v_sub_f32 v194, v194, v8
    v_sub_f32 v195, v195, v8
    v_sub_f32 v196, v196, v8
    v_sub_f32 v197, v197, v8
    v_sub_f32 v198, v198, v8
    v_sub_f32 v199, v199, v8
    v_sub_f32 v200, v200, v8
    v_sub_f32 v201, v201, v8
    v_sub_f32 v202, v202, v8
    v_sub_f32 v203, v203, v8
    v_sub_f32 v204, v204, v8
    v_sub_f32 v205, v205, v8
    v_sub_f32 v206, v206, v8
    v_sub_f32 v207, v207, v8
    v_sub_f32 v208, v208, v8
    v_sub_f32 v209, v209, v8
    v_sub_f32 v210, v210, v8
    v_sub_f32 v211, v211, v8
    v_sub_f32 v212, v212, v8
    v_sub_f32 v213, v213, v8
    v_sub_f32 v214, v214, v8
    v_sub_f32 v215, v215, v8
    v_sub_f32 v216, v216, v8
    v_sub_f32 v217, v217, v8
    v_sub_f32 v218, v218, v8
    v_sub_f32 v219, v219, v8
    v_sub_f32 v220, v220, v8
    v_sub_f32 v221, v221, v8
    v_sub_f32 v222, v222, v8
    v_sub_f32 v223, v223, v8
    v_sub_f32 v48, v48, v8
    v_sub_f32 v49, v49, v8
    v_sub_f32 v50, v50, v8
    v_sub_f32 v51, v51, v8
    v_sub_f32 v52, v52, v8
    v_sub_f32 v53, v53, v8
    v_sub_f32 v54, v54, v8
    v_sub_f32 v55, v55, v8
    v_sub_f32 v56, v56, v8
    v_sub_f32 v57, v57, v8
    v_sub_f32 v58, v58, v8
    v_sub_f32 v59, v59, v8
    v_sub_f32 v60, v60, v8
    v_sub_f32 v61, v61, v8
    v_sub_f32 v62, v62, v8
    v_sub_f32 v63, v63, v8
    s_nop 1
    s_branch L_ret10
L_fix11:
    s_nop 15
    v_mov_b32 v9, v8
    s_nop 1
    v_permlane32_swap_b32 v8, v9
    v_max_f32 v8, v8, v9
    v_add_f32 v8, s31, v8
    v_ceil_f32 v8, v8
    v_max_f32 v8, 0, v8
    v_min_f32 v9, 0x43800000, v8
    v_cvt_i32_f32 v9, v9
    v_sub_u32 v9, 0, v9
    v_ldexp_f32 v96, v96, v9
    v_ldexp_f32 v97, v97, v9
    v_ldexp_f32 v98, v98, v9
    v_ldexp_f32 v99, v99, v9
    v_ldexp_f32 v100, v100, v9
    v_ldexp_f32 v101, v101, v9
    v_ldexp_f32 v102, v102, v9
    v_ldexp_f32 v103, v103, v9
    v_ldexp_f32 v104, v104, v9
    v_ldexp_f32 v105, v105, v9
    v_ldexp_f32 v106, v106, v9
    v_ldexp_f32 v107, v107, v9
    v_ldexp_f32 v108, v108, v9
    v_ldexp_f32 v109, v109, v9
    v_ldexp_f32 v110, v110, v9
    v_ldexp_f32 v111, v111, v9
    v_ldexp_f32 v112, v112, v9
    v_ldexp_f32 v113, v113, v9
    v_ldexp_f32 v114, v114, v9
    v_ldexp_f32 v115, v115, v9
    v_ldexp_f32 v116, v116, v9
    v_ldexp_f32 v117, v117, v9
    v_ldexp_f32 v118, v118, v9
    v_ldexp_f32 v119, v119, v9
    v_ldexp_f32 v120, v120, v9
    v_ldexp_f32 v121, v121, v9
    v_ldexp_f32 v122, v122, v9
    v_ldexp_f32 v123, v123, v9
    v_ldexp_f32 v124, v124, v9
    v_ldexp_f32 v125, v125, v9
    v_ldexp_f32 v126, v126, v9
    v_ldexp_f32 v127, v127, v9
    v_ldexp_f32 v128, v128, v9
    v_ldexp_f32 v129, v129, v9
    v_ldexp_f32 v130, v130, v9
    v_ldexp_f32 v131, v131, v9
    v_ldexp_f32 v132, v132, v9
    v_ldexp_f32 v133, v133, v9
    v_ldexp_f32 v134, v134, v9
    v_ldexp_f32 v135, v135, v9
    v_ldexp_f32 v136, v136, v9
    v_ldexp_f32 v137, v137, v9
    v_ldexp_f32 v138, v138, v9
    v_ldexp_f32 v139, v139, v9
    v_ldexp_f32 v140, v140, v9
    v_ldexp_f32 v141, v141, v9
    v_ldexp_f32 v142, v142, v9
    v_ldexp_f32 v143, v143, v9
    v_ldexp_f32 v144, v144, v9
    v_ldexp_f32 v145, v145, v9
    v_ldexp_f32 v146, v146, v9
    v_ldexp_f32 v147, v147, v9
    v_ldexp_f32 v148, v148, v9
    v_ldexp_f32 v149, v149, v9
    v_ldexp_f32 v150, v150, v9
    v_ldexp_f32 v151, v151, v9
    v_ldexp_f32 v152, v152, v9
    v_ldexp_f32 v153, v153, v9
    v_ldexp_f32 v154, v154, v9
    v_ldexp_f32 v155, v155, v9
    v_ldexp_f32 v156, v156, v9
    v_ldexp_f32 v157, v157, v9
    v_ldexp_f32 v158, v158, v9
    v_ldexp_f32 v159, v159, v9
    v_ldexp_f32 v6, v6, v9
    v_ldexp_f32 v7, v7, v9
    v_lshlrev_b32 v10, 16, v192
    v_and_b32 v192, s28, v192
    v_ldexp_f32 v10, v10, v9
    v_ldexp_f32 v192, v192, v9
    v_cvt_pk_bf16_f32 v192, v10, v192
    v_lshlrev_b32 v10, 16, v193
    v_and_b32 v193, s28, v193
    v_ldexp_f32 v10, v10, v9
    v_ldexp_f32 v193, v193, v9
    v_cvt_pk_bf16_f32 v193, v10, v193
    v_lshlrev_b32 v10, 16, v194
    v_and_b32 v194, s28, v194
    v_ldexp_f32 v10, v10, v9
    v_ldexp_f32 v194, v194, v9
    v_cvt_pk_bf16_f32 v194, v10, v194
    v_lshlrev_b32 v10, 16, v195
    v_and_b32 v195, s28, v195
    v_ldexp_f32 v10, v10, v9
    v_ldexp_f32 v195, v195, v9
    v_cvt_pk_bf16_f32 v195, v10, v195
    v_lshlrev_b32 v10, 16, v196
    v_and_b32 v196, s28, v196
    v_ldexp_f32 v10, v10, v9
    v_ldexp_f32 v196, v196, v9
    v_cvt_pk_bf16_f32 v196, v10, v196
    v_lshlrev_b32 v10, 16, v197
    v_and_b32 v197, s28, v197
    v_ldexp_f32 v10, v10, v9
    v_ldexp_f32 v197, v197, v9
    v_cvt_pk_bf16_f32 v197, v10, v197
    v_lshlrev_b32 v10, 16, v198
    v_and_b32 v198, s28, v198
    v_ldexp_f32 v10, v10, v9
    v_ldexp_f32 v198, v198, v9
    v_cvt_pk_bf16_f32 v198, v10, v198
    v_lshlrev_b32 v10, 16, v199
    v_and_b32 v199, s28, v199
    v_ldexp_f32 v10, v10, v9
    v_ldexp_f32 v199, v199, v9
    v_cvt_pk_bf16_f32 v199, v10, v199
    v_sub_f32 v208, v208, v8
    v_sub_f32 v209, v209, v8
    v_sub_f32 v210, v210, v8
    v_sub_f32 v211, v211, v8
    v_sub_f32 v212, v212, v8
    v_sub_f32 v213, v213, v8
    v_sub_f32 v214, v214, v8
    v_sub_f32 v215, v215, v8
    v_sub_f32 v216, v216, v8
    v_sub_f32 v217, v217, v8
    v_sub_f32 v218, v218, v8
    v_sub_f32 v219, v219, v8
    v_sub_f32 v220, v220, v8
    v_sub_f32 v221, v221, v8
    v_sub_f32 v222, v222, v8
    v_sub_f32 v223, v223, v8
    v_sub_f32 v160, v160, v8
    v_sub_f32 v161, v161, v8
    v_sub_f32 v162, v162, v8
    v_sub_f32 v163, v163, v8
    v_sub_f32 v164, v164, v8
    v_sub_f32 v165, v165, v8
    v_sub_f32 v166, v166, v8
    v_sub_f32 v167, v167, v8
    v_sub_f32 v168, v168, v8
    v_sub_f32 v169, v169, v8
    v_sub_f32 v170, v170, v8
    v_sub_f32 v171, v171, v8
    v_sub_f32 v172, v172, v8
    v_sub_f32 v173, v173, v8
    v_sub_f32 v174, v174, v8
    v_sub_f32 v175, v175, v8
    v_sub_f32 v48, v48, v8
    v_sub_f32 v49, v49, v8
    v_sub_f32 v50, v50, v8
    v_sub_f32 v51, v51, v8
    v_sub_f32 v52, v52, v8
    v_sub_f32 v53, v53, v8
    v_sub_f32 v54, v54, v8
    v_sub_f32 v55, v55, v8
    v_sub_f32 v56, v56, v8
    v_sub_f32 v57, v57, v8
    v_sub_f32 v58, v58, v8
    v_sub_f32 v59, v59, v8
    v_sub_f32 v60, v60, v8
    v_sub_f32 v61, v61, v8
    v_sub_f32 v62, v62, v8
    v_sub_f32 v63, v63, v8
    s_nop 1
    s_branch L_ret11
L_fix12:
    s_nop 15
    v_mov_b32 v9, v8
    s_nop 1
    v_permlane32_swap_b32 v8, v9
    v_max_f32 v8, v8, v9
    v_add_f32 v8, s31, v8
    v_ceil_f32 v8, v8
    v_max_f32 v8, 0, v8
    v_min_f32 v9, 0x43800000, v8
    v_cvt_i32_f32 v9, v9
    v_sub_u32 v9, 0, v9
    v_ldexp_f32 v96, v96, v9
    v_ldexp_f32 v97, v97, v9
    v_ldexp_f32 v98, v98, v9
    v_ldexp_f32 v99, v99, v9
    v_ldexp_f32 v100, v100, v9
    v_ldexp_f32 v101, v101, v9
    v_ldexp_f32 v102, v102, v9
    v_ldexp_f32 v103, v103, v9
    v_ldexp_f32 v104, v104, v9
    v_ldexp_f32 v105, v105, v9
    v_ldexp_f32 v106, v106, v9
    v_ldexp_f32 v107, v107, v9
    v_ldexp_f32 v108, v108, v9
    v_ldexp_f32 v109, v109, v9
    v_ldexp_f32 v110, v110, v9
    v_ldexp_f32 v111, v111, v9
    v_ldexp_f32 v112, v112, v9
    v_ldexp_f32 v113, v113, v9
    v_ldexp_f32 v114, v114, v9
    v_ldexp_f32 v115, v115, v9
    v_ldexp_f32 v116, v116, v9
    v_ldexp_f32 v117, v117, v9
    v_ldexp_f32 v118, v118, v9
    v_ldexp_f32 v119, v119, v9
    v_ldexp_f32 v120, v120, v9
    v_ldexp_f32 v121, v121, v9
    v_ldexp_f32 v122, v122, v9
    v_ldexp_f32 v123, v123, v9
    v_ldexp_f32 v124, v124, v9
    v_ldexp_f32 v125, v125, v9
    v_ldexp_f32 v126, v126, v9
    v_ldexp_f32 v127, v127, v9
    v_ldexp_f32 v128, v128, v9
    v_ldexp_f32 v129, v129, v9
    v_ldexp_f32 v130, v130, v9
    v_ldexp_f32 v131, v131, v9
    v_ldexp_f32 v132, v132, v9
    v_ldexp_f32 v133, v133, v9
    v_ldexp_f32 v134, v134, v9
    v_ldexp_f32 v135, v135, v9
    v_ldexp_f32 v136, v136, v9
    v_ldexp_f32 v137, v137, v9
    v_ldexp_f32 v138, v138, v9
    v_ldexp_f32 v139, v139, v9
    v_ldexp_f32 v140, v140, v9
    v_ldexp_f32 v141, v141, v9
    v_ldexp_f32 v142, v142, v9
    v_ldexp_f32 v143, v143, v9
    v_ldexp_f32 v144, v144, v9
    v_ldexp_f32 v145, v145, v9
    v_ldexp_f32 v146, v146, v9
    v_ldexp_f32 v147, v147, v9
    v_ldexp_f32 v148, v148, v9
    v_ldexp_f32 v149, v149, v9
    v_ldexp_f32 v150, v150, v9
    v_ldexp_f32 v151, v151, v9
    v_ldexp_f32 v152, v152, v9
    v_ldexp_f32 v153, v153, v9
    v_ldexp_f32 v154, v154, v9
    v_ldexp_f32 v155, v155, v9
    v_ldexp_f32 v156, v156, v9
    v_ldexp_f32 v157, v157, v9
    v_ldexp_f32 v158, v158, v9
    v_ldexp_f32 v159, v159, v9
    v_ldexp_f32 v6, v6, v9
    v_ldexp_f32 v7, v7, v9
    v_lshlrev_b32 v10, 16, v208
    v_and_b32 v208, s28, v208
    v_ldexp_f32 v10, v10, v9
    v_ldexp_f32 v208, v208, v9
    v_cvt_pk_bf16_f32 v208, v10, v208
    v_lshlrev_b32 v10, 16, v209
    v_and_b32 v209, s28, v209
    v_ldexp_f32 v10, v10, v9
    v_ldexp_f32 v209, v209, v9
    v_cvt_pk_bf16_f32 v209, v10, v209
    v_lshlrev_b32 v10, 16, v210
    v_and_b32 v210, s28, v210
    v_ldexp_f32 v10, v10, v9
    v_ldexp_f32 v210, v210, v9
    v_cvt_pk_bf16_f32 v210, v10, v210
    v_lshlrev_b32 v10, 16, v211
    v_and_b32 v211, s28, v211
    v_ldexp_f32 v10, v10, v9
    v_ldexp_f32 v211, v211, v9
    v_cvt_pk_bf16_f32 v211, v10, v211
    v_lshlrev_b32 v10, 16, v212
    v_and_b32 v212, s28, v212
    v_ldexp_f32 v10, v10, v9
    v_ldexp_f32 v212, v212, v9
    v_cvt_pk_bf16_f32 v212, v10, v212
    v_lshlrev_b32 v10, 16, v213
    v_and_b32 v213, s28, v213
    v_ldexp_f32 v10, v10, v9
    v_ldexp_f32 v213, v213, v9
    v_cvt_pk_bf16_f32 v213, v10, v213
    v_lshlrev_b32 v10, 16, v214
    v_and_b32 v214, s28, v214
    v_ldexp_f32 v10, v10, v9
    v_ldexp_f32 v214, v214, v9
    v_cvt_pk_bf16_f32 v214, v10, v214
    v_lshlrev_b32 v10, 16, v215
    v_and_b32 v215, s28, v215
    v_ldexp_f32 v10, v10, v9
    v_ldexp_f32 v215, v215, v9
    v_cvt_pk_bf16_f32 v215, v10, v215
    v_sub_f32 v160, v160, v8
    v_sub_f32 v161, v161, v8
    v_sub_f32 v162, v162, v8
    v_sub_f32 v163, v163, v8
    v_sub_f32 v164, v164, v8
    v_sub_f32 v165, v165, v8
    v_sub_f32 v166, v166, v8
    v_sub_f32 v167, v167, v8
    v_sub_f32 v168, v168, v8
    v_sub_f32 v169, v169, v8
    v_sub_f32 v170, v170, v8
    v_sub_f32 v171, v171, v8
    v_sub_f32 v172, v172, v8
    v_sub_f32 v173, v173, v8
    v_sub_f32 v174, v174, v8
    v_sub_f32 v175, v175, v8
    v_sub_f32 v176, v176, v8
    v_sub_f32 v177, v177, v8
    v_sub_f32 v178, v178, v8
    v_sub_f32 v179, v179, v8
    v_sub_f32 v180, v180, v8
    v_sub_f32 v181, v181, v8
    v_sub_f32 v182, v182, v8
    v_sub_f32 v183, v183, v8
    v_sub_f32 v184, v184, v8
    v_sub_f32 v185, v185, v8
    v_sub_f32 v186, v186, v8
    v_sub_f32 v187, v187, v8
    v_sub_f32 v188, v188, v8
    v_sub_f32 v189, v189, v8
    v_sub_f32 v190, v190, v8
    v_sub_f32 v191, v191, v8
    v_sub_f32 v48, v48, v8
    v_sub_f32 v49, v49, v8
    v_sub_f32 v50, v50, v8
    v_sub_f32 v51, v51, v8
    v_sub_f32 v52, v52, v8
    v_sub_f32 v53, v53, v8
    v_sub_f32 v54, v54, v8
    v_sub_f32 v55, v55, v8
    v_sub_f32 v56, v56, v8
    v_sub_f32 v57, v57, v8
    v_sub_f32 v58, v58, v8
    v_sub_f32 v59, v59, v8
    v_sub_f32 v60, v60, v8
    v_sub_f32 v61, v61, v8
    v_sub_f32 v62, v62, v8
    v_sub_f32 v63, v63, v8
    s_nop 1
    s_branch L_ret12
L_fix13:
    s_nop 15
    v_mov_b32 v9, v8
    s_nop 1
    v_permlane32_swap_b32 v8, v9
    v_max_f32 v8, v8, v9
    v_add_f32 v8, s31, v8
    v_ceil_f32 v8, v8
    v_max_f32 v8, 0, v8
    v_min_f32 v9, 0x43800000, v8
    v_cvt_i32_f32 v9, v9
    v_sub_u32 v9, 0, v9
    v_ldexp_f32 v96, v96, v9
    v_ldexp_f32 v97, v97, v9
    v_ldexp_f32 v98, v98, v9
    v_ldexp_f32 v99, v99, v9
    v_ldexp_f32 v100, v100, v9
    v_ldexp_f32 v101, v101, v9
    v_ldexp_f32 v102, v102, v9
    v_ldexp_f32 v103, v103, v9
    v_ldexp_f32 v104, v104, v9
    v_ldexp_f32 v105, v105, v9
    v_ldexp_f32 v106, v106, v9
    v_ldexp_f32 v107, v107, v9
    v_ldexp_f32 v108, v108, v9
    v_ldexp_f32 v109, v109, v9
    v_ldexp_f32 v110, v110, v9
    v_ldexp_f32 v111, v111, v9
    v_ldexp_f32 v112, v112, v9
    v_ldexp_f32 v113, v113, v9
    v_ldexp_f32 v114, v114, v9
    v_ldexp_f32 v115, v115, v9
    v_ldexp_f32 v116, v116, v9
    v_ldexp_f32 v117, v117, v9
    v_ldexp_f32 v118, v118, v9
    v_ldexp_f32 v119, v119, v9
    v_ldexp_f32 v120, v120, v9
    v_ldexp_f32 v121, v121, v9
    v_ldexp_f32 v122, v122, v9
    v_ldexp_f32 v123, v123, v9
    v_ldexp_f32 v124, v124, v9
    v_ldexp_f32 v125, v125, v9
    v_ldexp_f32 v126, v126, v9
    v_ldexp_f32 v127, v127, v9
    v_ldexp_f32 v128, v128, v9
    v_ldexp_f32 v129, v129, v9
    v_ldexp_f32 v130, v130, v9
    v_ldexp_f32 v131, v131, v9
    v_ldexp_f32 v132, v132, v9
    v_ldexp_f32 v133, v133, v9
    v_ldexp_f32 v134, v134, v9
    v_ldexp_f32 v135, v135, v9
    v_ldexp_f32 v136, v136, v9
    v_ldexp_f32 v137, v137, v9
    v_ldexp_f32 v138, v138, v9
    v_ldexp_f32 v139, v139, v9
    v_ldexp_f32 v140, v140, v9
    v_ldexp_f32 v141, v141, v9
    v_ldexp_f32 v142, v142, v9
    v_ldexp_f32 v143, v143, v9
    v_ldexp_f32 v144, v144, v9
    v_ldexp_f32 v145, v145, v9
    v_ldexp_f32 v146, v146, v9
    v_ldexp_f32 v147, v147, v9
    v_ldexp_f32 v148, v148, v9
    v_ldexp_f32 v149, v149, v9
    v_ldexp_f32 v150, v150, v9
    v_ldexp_f32 v151, v151, v9
    v_ldexp_f32 v152, v152, v9
    v_ldexp_f32 v153, v153, v9
    v_ldexp_f32 v154, v154, v9
    v_ldexp_f32 v155, v155, v9
    v_ldexp_f32 v156, v156, v9
    v_ldexp_f32 v157, v157, v9
    v_ldexp_f32 v158, v158, v9
    v_ldexp_f32 v159, v159, v9
    v_ldexp_f32 v6, v6, v9
    v_ldexp_f32 v7, v7, v9
    v_lshlrev_b32 v10, 16, v160
    v_and_b32 v160, s28, v160
    v_ldexp_f32 v10, v10, v9
    v_ldexp_f32 v160, v160, v9
    v_cvt_pk_bf16_f32 v160, v10, v160
    v_lshlrev_b32 v10, 16, v161
    v_and_b32 v161, s28, v161
    v_ldexp_f32 v10, v10, v9
    v_ldexp_f32 v161, v161, v9
    v_cvt_pk_bf16_f32 v161, v10, v161
    v_lshlrev_b32 v10, 16, v162
    v_and_b32 v162, s28, v162
    v_ldexp_f32 v10, v10, v9
    v_ldexp_f32 v162, v162, v9
    v_cvt_pk_bf16_f32 v162, v10, v162
    v_lshlrev_b32 v10, 16, v163
    v_and_b32 v163, s28, v163
    v_ldexp_f32 v10, v10, v9
    v_ldexp_f32 v163, v163, v9
    v_cvt_pk_bf16_f32 v163, v10, v163
    v_lshlrev_b32 v10, 16, v164
    v_and_b32 v164, s28, v164
    v_ldexp_f32 v10, v10, v9
    v_ldexp_f32 v164, v164, v9
    v_cvt_pk_bf16_f32 v164, v10, v164
    v_lshlrev_b32 v10, 16, v165
    v_and_b32 v165, s28, v165
    v_ldexp_f32 v10, v10, v9
    v_ldexp_f32 v165, v165, v9
    v_cvt_pk_bf16_f32 v165, v10, v165
    v_lshlrev_b32 v10, 16, v166
    v_and_b32 v166, s28, v166
    v_ldexp_f32 v10, v10, v9
    v_ldexp_f32 v166, v166, v9
    v_cvt_pk_bf16_f32 v166, v10, v166
    v_lshlrev_b32 v10, 16, v167
    v_and_b32 v167, s28, v167
    v_ldexp_f32 v10, v10, v9
    v_ldexp_f32 v167, v167, v9
    v_cvt_pk_bf16_f32 v167, v10, v167
    v_sub_f32 v176, v176, v8
    v_sub_f32 v177, v177, v8
    v_sub_f32 v178, v178, v8
    v_sub_f32 v179, v179, v8
    v_sub_f32 v180, v180, v8
    v_sub_f32 v181, v181, v8
    v_sub_f32 v182, v182, v8
    v_sub_f32 v183, v183, v8
    v_sub_f32 v184, v184, v8
    v_sub_f32 v185, v185, v8
    v_sub_f32 v186, v186, v8
    v_sub_f32 v187, v187, v8
    v_sub_f32 v188, v188, v8
    v_sub_f32 v189, v189, v8
    v_sub_f32 v190, v190, v8
    v_sub_f32 v191, v191, v8
    v_sub_f32 v192, v192, v8
    v_sub_f32 v193, v193, v8
    v_sub_f32 v194, v194, v8
    v_sub_f32 v195, v195, v8
    v_sub_f32 v196, v196, v8
    v_sub_f32 v197, v197, v8
    v_sub_f32 v198, v198, v8
    v_sub_f32 v199, v199, v8
    v_sub_f32 v200, v200, v8
    v_sub_f32 v201, v201, v8
    v_sub_f32 v202, v202, v8
    v_sub_f32 v203, v203, v8
    v_sub_f32 v204, v204, v8
    v_sub_f32 v205, v205, v8
    v_sub_f32 v206, v206, v8
    v_sub_f32 v207, v207, v8
    v_sub_f32 v48, v48, v8
    v_sub_f32 v49, v49, v8
    v_sub_f32 v50, v50, v8
    v_sub_f32 v51, v51, v8
    v_sub_f32 v52, v52, v8
    v_sub_f32 v53, v53, v8
    v_sub_f32 v54, v54, v8
    v_sub_f32 v55, v55, v8
    v_sub_f32 v56, v56, v8
    v_sub_f32 v57, v57, v8
    v_sub_f32 v58, v58, v8
    v_sub_f32 v59, v59, v8
    v_sub_f32 v60, v60, v8
    v_sub_f32 v61, v61, v8
    v_sub_f32 v62, v62, v8
    v_sub_f32 v63, v63, v8
    s_nop 1
    s_branch L_ret13
L_fix14:
    s_nop 15
    v_mov_b32 v9, v8
    s_nop 1
    v_permlane32_swap_b32 v8, v9
    v_max_f32 v8, v8, v9
    v_add_f32 v8, s31, v8
    v_ceil_f32 v8, v8
    v_max_f32 v8, 0, v8
    v_min_f32 v9, 0x43800000, v8
    v_cvt_i32_f32 v9, v9
    v_sub_u32 v9, 0, v9
    v_ldexp_f32 v96, v96, v9
    v_ldexp_f32 v97, v97, v9
    v_ldexp_f32 v98, v98, v9
    v_ldexp_f32 v99, v99, v9
    v_ldexp_f32 v100, v100, v9
    v_ldexp_f32 v101, v101, v9
    v_ldexp_f32 v102, v102, v9
    v_ldexp_f32 v103, v103, v9
    v_ldexp_f32 v104, v104, v9
    v_ldexp_f32 v105, v105, v9
    v_ldexp_f32 v106, v106, v9
    v_ldexp_f32 v107, v107, v9
    v_ldexp_f32 v108, v108, v9
    v_ldexp_f32 v109, v109, v9
    v_ldexp_f32 v110, v110, v9
    v_ldexp_f32 v111, v111, v9
    v_ldexp_f32 v112, v112, v9
    v_ldexp_f32 v113, v113, v9
    v_ldexp_f32 v114, v114, v9
    v_ldexp_f32 v115, v115, v9
    v_ldexp_f32 v116, v116, v9
    v_ldexp_f32 v117, v117, v9
    v_ldexp_f32 v118, v118, v9
    v_ldexp_f32 v119, v119, v9
    v_ldexp_f32 v120, v120, v9
    v_ldexp_f32 v121, v121, v9
    v_ldexp_f32 v122, v122, v9
    v_ldexp_f32 v123, v123, v9
    v_ldexp_f32 v124, v124, v9
    v_ldexp_f32 v125, v125, v9
    v_ldexp_f32 v126, v126, v9
    v_ldexp_f32 v127, v127, v9
    v_ldexp_f32 v128, v128, v9
    v_ldexp_f32 v129, v129, v9
    v_ldexp_f32 v130, v130, v9
    v_ldexp_f32 v131, v131, v9
    v_ldexp_f32 v132, v132, v9
    v_ldexp_f32 v133, v133, v9
    v_ldexp_f32 v134, v134, v9
    v_ldexp_f32 v135, v135, v9
    v_ldexp_f32 v136, v136, v9
    v_ldexp_f32 v137, v137, v9
    v_ldexp_f32 v138, v138, v9
    v_ldexp_f32 v139, v139, v9
    v_ldexp_f32 v140, v140, v9
    v_ldexp_f32 v141, v141, v9
    v_ldexp_f32 v142, v142, v9
    v_ldexp_f32 v143, v143, v9
    v_ldexp_f32 v144, v144, v9
    v_ldexp_f32 v145, v145, v9
    v_ldexp_f32 v146, v146, v9
    v_ldexp_f32 v147, v147, v9
    v_ldexp_f32 v148, v148, v9
    v_ldexp_f32 v149, v149, v9
    v_ldexp_f32 v150, v150, v9
    v_ldexp_f32 v151, v151, v9
    v_ldexp_f32 v152, v152, v9
    v_ldexp_f32 v153, v153, v9
    v_ldexp_f32 v154, v154, v9
    v_ldexp_f32 v155, v155, v9
    v_ldexp_f32 v156, v156, v9
    v_ldexp_f32 v157, v157, v9
    v_ldexp_f32 v158, v158, v9
    v_ldexp_f32 v159, v159, v9
    v_ldexp_f32 v6, v6, v9
    v_ldexp_f32 v7, v7, v9
    v_lshlrev_b32 v10, 16, v176
    v_and_b32 v176, s28, v176
    v_ldexp_f32 v10, v10, v9
    v_ldexp_f32 v176, v176, v9
    v_cvt_pk_bf16_f32 v176, v10, v176
    v_lshlrev_b32 v10, 16, v177
    v_and_b32 v177, s28, v177
    v_ldexp_f32 v10, v10, v9
    v_ldexp_f32 v177, v177, v9
    v_cvt_pk_bf16_f32 v177, v10, v177
    v_lshlrev_b32 v10, 16, v178
    v_and_b32 v178, s28, v178
    v_ldexp_f32 v10, v10, v9
    v_ldexp_f32 v178, v178, v9
    v_cvt_pk_bf16_f32 v178, v10, v178
    v_lshlrev_b32 v10, 16, v179
    v_and_b32 v179, s28, v179
    v_ldexp_f32 v10, v10, v9
    v_ldexp_f32 v179, v179, v9
    v_cvt_pk_bf16_f32 v179, v10, v179
    v_lshlrev_b32 v10, 16, v180
    v_and_b32 v180, s28, v180
    v_ldexp_f32 v10, v10, v9
    v_ldexp_f32 v180, v180, v9
    v_cvt_pk_bf16_f32 v180, v10, v180
    v_lshlrev_b32 v10, 16, v181
    v_and_b32 v181, s28, v181
    v_ldexp_f32 v10, v10, v9
    v_ldexp_f32 v181, v181, v9
    v_cvt_pk_bf16_f32 v181, v10, v181
    v_lshlrev_b32 v10, 16, v182
    v_and_b32 v182, s28, v182
    v_ldexp_f32 v10, v10, v9
    v_ldexp_f32 v182, v182, v9
    v_cvt_pk_bf16_f32 v182, v10, v182
    v_lshlrev_b32 v10, 16, v183
    v_and_b32 v183, s28, v183
    v_ldexp_f32 v10, v10, v9
    v_ldexp_f32 v183, v183, v9
    v_cvt_pk_bf16_f32 v183, v10, v183
    v_sub_f32 v192, v192, v8
    v_sub_f32 v193, v193, v8
    v_sub_f32 v194, v194, v8
    v_sub_f32 v195, v195, v8
    v_sub_f32 v196, v196, v8
    v_sub_f32 v197, v197, v8
    v_sub_f32 v198, v198, v8
    v_sub_f32 v199, v199, v8
    v_sub_f32 v200, v200, v8
    v_sub_f32 v201, v201, v8
    v_sub_f32 v202, v202, v8
    v_sub_f32 v203, v203, v8
    v_sub_f32 v204, v204, v8
    v_sub_f32 v205, v205, v8
    v_sub_f32 v206, v206, v8
    v_sub_f32 v207, v207, v8
    v_sub_f32 v208, v208, v8
    v_sub_f32 v209, v209, v8
    v_sub_f32 v210, v210, v8
    v_sub_f32 v211, v211, v8
    v_sub_f32 v212, v212, v8
    v_sub_f32 v213, v213, v8
    v_sub_f32 v214, v214, v8
    v_sub_f32 v215, v215, v8
    v_sub_f32 v216, v216, v8
    v_sub_f32 v217, v217, v8
    v_sub_f32 v218, v218, v8
    v_sub_f32 v219, v219, v8
    v_sub_f32 v220, v220, v8
    v_sub_f32 v221, v221, v8
    v_sub_f32 v222, v222, v8
    v_sub_f32 v223, v223, v8
    s_nop 1
    s_branch L_ret14
L_fix15:
    s_nop 15
    v_mov_b32 v9, v8
    s_nop 1
    v_permlane32_swap_b32 v8, v9
    v_max_f32 v8, v8, v9
    v_add_f32 v8, s31, v8
    v_ceil_f32 v8, v8
    v_max_f32 v8, 0, v8
    v_min_f32 v9, 0x43800000, v8
    v_cvt_i32_f32 v9, v9
    v_sub_u32 v9, 0, v9
    v_ldexp_f32 v96, v96, v9
    v_ldexp_f32 v97, v97, v9
    v_ldexp_f32 v98, v98, v9
    v_ldexp_f32 v99, v99, v9
    v_ldexp_f32 v100, v100, v9
    v_ldexp_f32 v101, v101, v9
    v_ldexp_f32 v102, v102, v9
    v_ldexp_f32 v103, v103, v9
    v_ldexp_f32 v104, v104, v9
    v_ldexp_f32 v105, v105, v9
    v_ldexp_f32 v106, v106, v9
    v_ldexp_f32 v107, v107, v9
    v_ldexp_f32 v108, v108, v9
    v_ldexp_f32 v109, v109, v9
    v_ldexp_f32 v110, v110, v9
    v_ldexp_f32 v111, v111, v9
    v_ldexp_f32 v112, v112, v9
    v_ldexp_f32 v113, v113, v9
    v_ldexp_f32 v114, v114, v9
    v_ldexp_f32 v115, v115, v9
    v_ldexp_f32 v116, v116, v9
    v_ldexp_f32 v117, v117, v9
    v_ldexp_f32 v118, v118, v9
    v_ldexp_f32 v119, v119, v9
    v_ldexp_f32 v120, v120, v9
    v_ldexp_f32 v121, v121, v9
    v_ldexp_f32 v122, v122, v9
    v_ldexp_f32 v123, v123, v9
    v_ldexp_f32 v124, v124, v9
    v_ldexp_f32 v125, v125, v9
    v_ldexp_f32 v126, v126, v9
    v_ldexp_f32 v127, v127, v9
    v_ldexp_f32 v128, v128, v9
    v_ldexp_f32 v129, v129, v9
    v_ldexp_f32 v130, v130, v9
    v_ldexp_f32 v131, v131, v9
    v_ldexp_f32 v132, v132, v9
    v_ldexp_f32 v133, v133, v9
    v_ldexp_f32 v134, v134, v9
    v_ldexp_f32 v135, v135, v9
    v_ldexp_f32 v136, v136, v9
    v_ldexp_f32 v137, v137, v9
    v_ldexp_f32 v138, v138, v9
    v_ldexp_f32 v139, v139, v9
    v_ldexp_f32 v140, v140, v9
    v_ldexp_f32 v141, v141, v9
    v_ldexp_f32 v142, v142, v9
    v_ldexp_f32 v143, v143, v9
    v_ldexp_f32 v144, v144, v9
    v_ldexp_f32 v145, v145, v9
    v_ldexp_f32 v146, v146, v9
    v_ldexp_f32 v147, v147, v9
    v_ldexp_f32 v148, v148, v9
    v_ldexp_f32 v149, v149, v9
    v_ldexp_f32 v150, v150, v9
    v_ldexp_f32 v151, v151, v9
    v_ldexp_f32 v152, v152, v9
    v_ldexp_f32 v153, v153, v9
    v_ldexp_f32 v154, v154, v9
    v_ldexp_f32 v155, v155, v9
    v_ldexp_f32 v156, v156, v9
    v_ldexp_f32 v157, v157, v9
    v_ldexp_f32 v158, v158, v9
    v_ldexp_f32 v159, v159, v9
    v_ldexp_f32 v6, v6, v9
    v_ldexp_f32 v7, v7, v9
    v_lshlrev_b32 v10, 16, v192
    v_and_b32 v192, s28, v192
    v_ldexp_f32 v10, v10, v9
    v_ldexp_f32 v192, v192, v9
    v_cvt_pk_bf16_f32 v192, v10, v192
    v_lshlrev_b32 v10, 16, v193
    v_and_b32 v193, s28, v193
    v_ldexp_f32 v10, v10, v9
    v_ldexp_f32 v193, v193, v9
    v_cvt_pk_bf16_f32 v193, v10, v193
    v_lshlrev_b32 v10, 16, v194
    v_and_b32 v194, s28, v194
    v_ldexp_f32 v10, v10, v9
    v_ldexp_f32 v194, v194, v9
    v_cvt_pk_bf16_f32 v194, v10, v194
    v_lshlrev_b32 v10, 16, v195
    v_and_b32 v195, s28, v195
    v_ldexp_f32 v10, v10, v9
    v_ldexp_f32 v195, v195, v9
    v_cvt_pk_bf16_f32 v195, v10, v195
    v_lshlrev_b32 v10, 16, v196
    v_and_b32 v196, s28, v196
    v_ldexp_f32 v10, v10, v9
    v_ldexp_f32 v196, v196, v9
    v_cvt_pk_bf16_f32 v196, v10, v196
    v_lshlrev_b32 v10, 16, v197
    v_and_b32 v197, s28, v197
    v_ldexp_f32 v10, v10, v9
    v_ldexp_f32 v197, v197, v9
    v_cvt_pk_bf16_f32 v197, v10, v197
    v_lshlrev_b32 v10, 16, v198
    v_and_b32 v198, s28, v198
    v_ldexp_f32 v10, v10, v9
    v_ldexp_f32 v198, v198, v9
    v_cvt_pk_bf16_f32 v198, v10, v198
    v_lshlrev_b32 v10, 16, v199
    v_and_b32 v199, s28, v199
    v_ldexp_f32 v10, v10, v9
    v_ldexp_f32 v199, v199, v9
    v_cvt_pk_bf16_f32 v199, v10, v199
    v_sub_f32 v208, v208, v8
    v_sub_f32 v209, v209, v8
    v_sub_f32 v210, v210, v8
    v_sub_f32 v211, v211, v8
    v_sub_f32 v212, v212, v8
    v_sub_f32 v213, v213, v8
    v_sub_f32 v214, v214, v8
    v_sub_f32 v215, v215, v8
    v_sub_f32 v216, v216, v8
    v_sub_f32 v217, v217, v8
    v_sub_f32 v218, v218, v8
    v_sub_f32 v219, v219, v8
    v_sub_f32 v220, v220, v8
    v_sub_f32 v221, v221, v8
    v_sub_f32 v222, v222, v8
    v_sub_f32 v223, v223, v8
    s_nop 1
    s_branch L_ret15
L_code_end:
.section .rodata,"a"
.p2align 6
.amdhsa_kernel adaLN_cond__sliding_block_cached__mixer_gmlp__prompt_kernel
  .amdhsa_next_free_vgpr 256
  .amdhsa_next_free_sgpr 101
  .amdhsa_accum_offset 256
  .amdhsa_group_segment_fixed_size 0
  .amdhsa_kernarg_size 120
  .amdhsa_user_sgpr_count 2
  .amdhsa_user_sgpr_kernarg_segment_ptr 1
  .amdhsa_system_sgpr_workgroup_id_x 1
.end_amdhsa_kernel
```
